```python
import torch

def _softmax(x, axis=-1):
    return torch.softmax(x, dim=axis)
def _gelu(x):
    return torch.nn.functional.gelu(x, approximate="tanh")
def _silu(x):
    return torch.nn.functional.silu(x)
def _sigmoid(x):
    return torch.sigmoid(x)
def _layernorm(x, axis=-1, eps=1e-5):
    m = x.mean(dim=axis, keepdim=True)
    v = x.var(dim=axis, keepdim=True, unbiased=False)
    return (x - m) / torch.sqrt(v + eps)
def _scatter_add(tgt, idx, src, axis=0):
    return tgt.clone().index_add_(axis, idx, src)
def _segment_sum(src, seg, n):
    out = torch.zeros((n,) + src.shape[1:], dtype=src.dtype)
    return out.index_add_(0, seg, src)
def _pad(x, pw):
    flat = tuple(v for pair in reversed(pw) for v in pair)
    return torch.nn.functional.pad(x, flat)

kernel_name = 'gated_mix__sliding_block__sliding_local_dilated__prompt'

def setup_inputs():

    _w = (lambda a: (lambda t: t.to(torch.bfloat16) if t.is_floating_point() else t)(torch.as_tensor(a)))
    def _A_setup():
        B, S, D = 1, 2048, 640
        return {
            "x": _w((lambda *s: torch.randn(*s, dtype=torch.bfloat16) * 0.05)(B, S, D)),
            "wqkv": _w((lambda *s: torch.randn(*s, dtype=torch.bfloat16) * 0.8)(D, 3 * D)),
            "wo": _w((lambda *s: torch.randn(*s, dtype=torch.bfloat16) * 0.05)(D, D)),
        }
    _A_in = _A_setup()

    def _B_setup():
        B, S, D = 1, 2048, 640
        return {
            "x": _w((lambda *s: torch.randn(*s, dtype=torch.bfloat16) * 0.05)(B, S, D)),
            "wqkv": _w((lambda *s: torch.randn(*s, dtype=torch.bfloat16) * 0.8)(D, 3 * D)),
            "wo": _w((lambda *s: torch.randn(*s, dtype=torch.bfloat16) * 0.05)(D, D)),
        }
    _B_in = _B_setup()

    return {
        "A_x": _A_in["x"],
        "A_wqkv": _A_in["wqkv"],
        "A_wo": _A_in["wo"],
        "B_x": _B_in["x"],
        "B_wqkv": _B_in["wqkv"],
        "B_wo": _B_in["wo"],
        "gate_w": _w((lambda *s: torch.randn(*s, dtype=torch.bfloat16) * 0.05)(640) * 16.0),
    }

def reference(A_x, A_wqkv, A_wo, B_x, B_wqkv, B_wo, gate_w):
    def _A_ref(x, wqkv, wo):
        B, S, D = x.shape
        H = 32; Dh = D // H; W = 256
        qkv = (lambda x, *d: x.permute(*d))((x @ wqkv).reshape(B, S, 3, H, Dh), 2, 0, 3, 1, 4)
        q, k, v = qkv[0], qkv[1], qkv[2]
        scores = torch.einsum("bhqd,bhkd->bhqk", q, k) * (Dh ** -0.5)
        idx = torch.arange(S)
        mask = (idx[:, None] - idx[None, :] >= 0) & (idx[:, None] - idx[None, :] < W)
        scores = torch.where(mask[None, None], scores, -1e9)
        p = _softmax(scores, axis=-1)
        o = torch.einsum("bhqk,bhkd->bhqd", p, v)
        return (lambda x, *d: x.permute(*d))(o, 0, 2, 1, 3).reshape(B, S, D) @ wo

    def _B_ref(x, wqkv, wo):
        B, S, D = x.shape
        H = 32; Dh = D // H
        W, dil = 8, 2
        qkv = (lambda x, *d: x.permute(*d))((x @ wqkv).reshape(B, S, 3, H, Dh), 2, 0, 3, 1, 4)
        q, k, v = qkv[0], qkv[1], qkv[2]
        scale = Dh ** -0.5
        pos = torch.arange(S)
        off = torch.arange(W) * dil
        idx = pos[:, None] - off[None, :]
        mask = idx >= 0
        idx_c = torch.where(mask, idx, 0).reshape(-1)
        kg = k[:, :, idx_c, :].reshape(B, H, S, W, Dh)
        vg = v[:, :, idx_c, :].reshape(B, H, S, W, Dh)
        logits = torch.einsum("bhsd,bhswd->bhsw", q, kg) * scale
        logits = torch.where(mask[None, None, :, :], logits, -1e9)
        attn = _softmax(logits, axis=-1)
        o = torch.einsum("bhsw,bhswd->bhsd", attn, vg)
        return (lambda x, *d: x.permute(*d))(o, 0, 2, 1, 3).reshape(B, S, D) @ wo

    x = A_x
    g = _sigmoid((x * gate_w).sum(-1, keepdims=True))
    a = _A_ref(x, A_wqkv, A_wo)
    b = _B_ref(x, B_wqkv, B_wo)
    return g * a + (1 - g) * b
```

```asm
; @launch grid=(256,1,1) block=(512,1,1) lds=163840
.amdgcn_target "amdgcn-amd-amdhsa--gfx950"
.text
.globl gated_mix__sliding_block__sliding_local_dilated__prompt_kernel
.p2align 12
.p2align 8
.type gated_mix__sliding_block__sliding_local_dilated__prompt_kernel,@function
gated_mix__sliding_block__sliding_local_dilated__prompt_kernel:
    s_load_dwordx16 s[36:51], s[0:1], 0
    s_load_dwordx4 s[52:55], s[0:1], 64
    s_cmp_ge_u32 s2, 256
    s_cbranch_scc1 .Lend_1
    s_getpc_b64 s[4:5]
.Lpc_6:
    s_lshr_b32 s3, s2, 3
    v_lshl_add_u32 v4, v0, 5, s3
    v_lshlrev_b32 v4, 7, v4
    v_cmp_gt_u32 vcc, .Lhot_end-.Lpc_6, v4
    s_nop 1
    s_and_saveexec_b64 s[6:7], vcc
    s_cbranch_execz .Lnopf_7
    global_load_dword v253, v4, s[4:5]
.Lnopf_7:
    s_mov_b64 exec, -1
    v_lshrrev_b32 v1, 6, v0
    s_nop 0
    v_readfirstlane_b32 s16, v1
    v_and_b32 v0, 63, v0
    s_andn2_b32 s3, 6, s2
    s_lshl_b32 s3, s3, 1
    s_lshr_b32 s4, s2, 6
    s_add_u32 s24, s3, s4
    s_and_b32 s3, s2, 1
    s_lshl_b32 s3, s3, 3
    s_bfe_u32 s4, s2, 0x30003
    s_add_u32 s23, s3, s4
    s_cmp_eq_u32 s24, 15
    s_cbranch_scc1 .Lspare_2
    s_cmp_lt_u32 s16, 4
    s_cbranch_scc1 .Lg0_5
    s_setprio 2
    s_sub_u32 s91, s16, 4
    s_add_u32 s6, s23, s24
    s_mul_i32 s7, s6, 86
    s_lshr_b32 s7, s7, 8
    s_mul_i32 s7, s7, 3
    s_sub_u32 s6, s6, s7
    s_lshl_b32 s6, s6, 2
    s_lshr_b32 s6, 0x730, s6
    s_and_b32 s25, s6, 15
    s_and_b32 s6, s2, 7
    s_lshl_b32 s6, s6, 2
    s_lshr_b32 s6, 0x31203120, s6
    s_and_b32 s6, s6, 15
    s_add_u32 s6, s6, s25
    s_cmp_ge_u32 s6, 10
    s_cselect_b32 s7, 10, 0
    s_sub_u32 s25, s6, s7
    v_lshrrev_b32 v12, 3, v0
    s_lshl_b32 s6, s91, 3
    v_add_u32 v12, s6, v12
    v_mul_u32_u24 v12, 1280, v12
    v_lshrrev_b32 v13, 4, v0
    s_and_b32 s6, s91, 1
    s_lshl_b32 s6, s6, 2
    v_add_u32 v7, s6, v13
    v_and_b32 v11, 7, v0
    v_xor_b32 v7, v7, v11
    v_lshl_add_u32 v8, v7, 4, v12
    v_and_b32 v12, 32, v0
    v_bfe_u32 v7, v0, 4, 1
    v_lshl_add_u32 v12, v7, 2, v12
    v_add_u32 v12, s91, v12
    v_mul_u32_u24 v12, 3840, v12
    v_and_b32 v7, 15, v0
    v_lshl_add_u32 v9, v7, 4, v12
    s_mul_i32 s84, s23, 163840
    s_lshl_b32 s85, s24, 8
    s_lshl_b32 s86, s91, 10
    s_mul_i32 s87, s91, 2080
    s_add_u32 s3, s25, 0
    s_cmp_ge_u32 s3, 10
    s_cselect_b32 s4, 10, 0
    s_sub_u32 s3, s3, s4
    s_lshl_b32 s4, s3, 7
    s_add_u32 s88, s4, s84
    s_mul_i32 s4, s3, 245760
    s_add_u32 s89, s4, s85
    s_waitcnt lgkmcnt(0)
    s_mov_b32 s72, s38
    s_and_b32 s73, s39, 0xffff
    s_mov_b32 s74, 0x258000
    s_mov_b32 s75, 0x20000
    s_mov_b32 s68, s36
    s_and_b32 s69, s37, 0xffff
    s_mov_b32 s70, 0x280000
    s_mov_b32 s71, 0x20000
    s_add_u32 m0, s87, 0
    s_add_u32 s3, s89, 0
    buffer_load_dwordx4 v9, s[72:75], s3 offen  lds
    s_add_u32 m0, s86, 99840
    s_add_u32 s3, s88, 0
    buffer_load_dwordx4 v8, s[68:71], s3 offen  lds
    s_add_u32 m0, s87, 8320
    s_add_u32 s3, s89, 30720
    buffer_load_dwordx4 v9, s[72:75], s3 offen  lds
    s_add_u32 m0, s86, 103936
    s_add_u32 s3, s88, 40960
    buffer_load_dwordx4 v8, s[68:71], s3 offen  lds
    s_add_u32 m0, s87, 1024
    s_add_u32 s3, s89, 61440
    buffer_load_dwordx4 v9, s[72:75], s3 offen  lds
    s_add_u32 m0, s86, 108032
    s_add_u32 s3, s88, 81920
    buffer_load_dwordx4 v8, s[68:71], s3 offen  lds
    s_add_u32 m0, s87, 9344
    s_add_u32 s3, s89, 92160
    buffer_load_dwordx4 v9, s[72:75], s3 offen  lds
    s_add_u32 m0, s86, 112128
    s_add_u32 s3, s88, 122880
    buffer_load_dwordx4 v8, s[68:71], s3 offen  lds
    s_mov_b32 s76, s44
    s_and_b32 s77, s45, 0xffff
    s_mov_b32 s78, 0x258000
    s_mov_b32 s79, 0x20000
    v_lshlrev_b32 v16, 4, v0
    s_add_u32 s3, s25, 1
    s_cmp_ge_u32 s3, 10
    s_cselect_b32 s4, 10, 0
    s_sub_u32 s3, s3, s4
    s_lshl_b32 s4, s3, 7
    s_add_u32 s88, s4, s84
    s_mul_i32 s4, s3, 245760
    s_add_u32 s89, s4, s85
    s_add_u32 m0, s87, 16640
    s_add_u32 s3, s89, 0
    buffer_load_dwordx4 v9, s[72:75], s3 offen  lds
    s_add_u32 m0, s86, 116480
    s_add_u32 s3, s88, 0
    buffer_load_dwordx4 v8, s[68:71], s3 offen  lds
    s_add_u32 m0, s87, 24960
    s_add_u32 s3, s89, 30720
    buffer_load_dwordx4 v9, s[72:75], s3 offen  lds
    s_add_u32 m0, s86, 120576
    s_add_u32 s3, s88, 40960
    buffer_load_dwordx4 v8, s[68:71], s3 offen  lds
    s_mov_b32 s8, s54
    s_and_b32 s9, s55, 0xffff
    s_mov_b32 s10, 0x2000000
    s_mov_b32 s11, 0x20000
    s_mov_b32 s12, s50
    s_and_b32 s13, s51, 0xffff
    s_mov_b32 s14, 0x280000
    s_mov_b32 s15, 0x20000
    s_mov_b32 s32, s52
    s_and_b32 s33, s53, 0xffff
    s_mov_b32 s34, 0x100
    s_mov_b32 s35, 0x20000
    s_and_b32 s3, s2, 7
    s_lshr_b32 s4, s2, 3
    s_and_b32 s7, s4, 3
    s_lshl_b32 s3, s3, 2
    s_add_u32 s18, s3, s7
    s_lshr_b32 s19, s4, 2
    s_bfe_u32 s3, s2, 0x20001
    s_lshl_b32 s3, s3, 3
    s_and_b32 s6, s4, 7
    s_add_u32 s99, s3, s6
    s_and_b32 s3, s2, 1
    s_lshl_b32 s3, s3, 2
    s_lshr_b32 s6, s4, 3
    s_add_u32 s90, s3, s6
    s_and_b32 s21, s18, 1
    s_lshr_b32 s3, s18, 1
    s_mul_i32 s3, s3, 5
    s_lshl_b32 s6, s21, 1
    s_add_u32 s20, s3, s6
    s_lshl_b32 s3, s19, 3
    s_add_u32 s22, s3, s16
    s_lshl_b32 s3, s2, 3
    s_add_u32 s3, s3, s16
    s_lshl_b32 s3, s3, 7
    s_add_u32 s17, s3, 21315584
    s_mov_b32 s36, 0xffffffff
    s_mov_b32 s37, 0xfffffff0
    s_mov_b32 s38, 0xfffffffe
    s_mov_b32 s39, 0xffffffe0
    s_mov_b32 s40, 0xfffffffc
    s_mov_b32 s41, 0xffffffc0
    s_mov_b32 s42, 0xfffffff8
    s_mov_b32 s43, 0xffffff80
    s_mov_b32 s44, 0xffffff00
    s_mov_b32 s45, 0xfffff000
    s_mov_b32 s46, 0xfffffe00
    s_mov_b32 s47, 0xffffe000
    s_mov_b32 s48, 0xfffffc00
    s_mov_b32 s49, 0xffffc000
    s_mov_b32 s50, 0xfffff800
    s_mov_b32 s51, 0xffff8000
    s_mov_b32 s52, 0xffff0000
    s_mov_b32 s53, 0xfff00000
    s_mov_b32 s54, 0xfffe0000
    s_mov_b32 s55, 0xffe00000
    s_mov_b32 s56, 0xfffc0000
    s_mov_b32 s57, 0xffc00000
    s_mov_b32 s58, 0xfff80000
    s_mov_b32 s59, 0xff800000
    s_mov_b32 s60, 0xff000000
    s_mov_b32 s61, 0xf0000000
    s_mov_b32 s62, 0xfe000000
    s_mov_b32 s63, 0xe0000000
    s_mov_b32 s64, 0xfc000000
    s_mov_b32 s65, 0xc0000000
    s_mov_b32 s66, 0xf8000000
    s_mov_b32 s67, 0x80000000
    v_lshrrev_b32 v20, 4, v0
    v_lshlrev_b32 v20, 5, v20
    v_bfe_u32 v21, v0, 3, 1
    v_lshl_add_u32 v20, v21, 2, v20
    v_add_u32 v20, s91, v20
    v_mul_u32_u24 v20, 3840, v20
    v_and_b32 v21, 7, v0
    v_lshl_add_u32 v10, v21, 4, v20
    v_mov_b32 v30, v10
    v_cmp_gt_u32 vcc, 32, v0
    v_add_u32 v20, 2211840, v10
    v_subrev_u32 v21, 245760, v10
    v_cndmask_b32 v31, v21, v20, vcc
    v_and_b32 v24, 15, v0
    v_lshrrev_b32 v25, 4, v0
    v_lshrrev_b32 v26, 1, v24
    v_xor_b32 v26, v26, v25
    v_lshlrev_b32 v26, 4, v26
    v_lshl_add_u32 v26, v24, 7, v26
    s_lshl_b32 s3, s91, 12
    s_add_u32 s3, s3, 99840
    v_add_u32 v2, s3, v26
    v_xor_b32 v3, 64, v2
    v_bfe_u32 v26, v0, 2, 3
    v_mul_u32_u24 v26, 2080, v26
    v_lshrrev_b32 v27, 5, v0
    v_lshl_add_u32 v26, v27, 10, v26
    v_and_b32 v28, 3, v0
    v_lshl_add_u32 v4, v28, 3, v26
    v_add_u32 v5, 66560, v4
    v_and_b32 v26, 31, v0
    v_lshlrev_b32 v26, 4, v26
    v_lshl_add_u32 v26, v27, 11, v26
    s_lshl_b32 s3, s91, 9
    v_add_u32 v1, s3, v26
    s_lshl_b32 s3, s19, 1
    s_add_u32 s3, s3, s91
    s_sub_u32 s3, s3, 2
    s_max_i32 s80, s3, 0
    s_mul_i32 s92, s80, 491520
    s_lshl_b32 s4, s20, 11
    s_add_u32 s92, s92, s4
    s_lshl_b32 s5, s21, 11
    s_add_u32 s93, s92, s5
    s_cmp_eq_u32 s21, 0
    s_cselect_b32 s6, 4096, 8
    s_cselect_b32 s7, 4096, 0
    s_add_u32 s94, s92, s6
    s_lshl_b32 s3, s19, 1
    s_lshr_b32 s6, s91, 1
    s_add_u32 s3, s3, s6
    s_mul_i32 s3, s3, 491520
    s_and_b32 s6, s91, 1
    s_lshl_b32 s6, s6, 10
    s_add_u32 s3, s3, s6
    s_add_u32 s3, s3, s4
    s_add_u32 s95, s3, s5
    s_add_u32 s96, s3, s7
    s_lshl_b32 s97, s91, 11
    s_lshl_b32 s98, s91, 10
    s_lshl_b32 s3, s91, 3
    s_add_u32 s3, s3, s90
    s_lshl_b32 s3, s3, 8
    s_add_u32 s81, s3, 21299200
    v_and_b32 v20, 3, v0
    s_lshl_b32 s3, s80, 2
    v_add_u32 v21, s3, v20
    v_and_b32 v23, 1, v0
    s_lshl_b32 s3, s19, 3
    s_lshl_b32 s4, s91, 1
    s_add_u32 s3, s3, s4
    v_add_u32 v20, s3, v23
    v_cmp_gt_u32 vcc, 16, v0
    v_lshrrev_b32 v22, 1, v0
    v_and_b32 v22, 2, v22
    v_cndmask_b32 v21, v20, v21, vcc
    v_bfe_u32 v20, v0, 3, 1
    v_mul_u32_u24 v20, 5, v20
    v_add_u32 v20, 5, v20
    v_cndmask_b32 v20, 0, v20, vcc
    v_add_u32 v22, s20, v22
    v_lshrrev_b32 v22, 4, v22
    v_add_u32 v20, v20, v22
    v_lshl_add_u32 v20, v21, 4, v20
    v_lshlrev_b32 v20, 7, v20
    v_add_u32 v20, 21004288, v20
    v_cmp_gt_u32 vcc, 24, v0
    v_and_b32 v22, 2, v0
    v_lshlrev_b32 v22, 12, v22
    v_lshl_add_u32 v22, v23, 7, v22
    v_add_u32 v22, s81, v22
    v_cndmask_b32 v92, v22, v20, vcc
    v_lshrrev_b32 v7, 1, v0
    v_lshlrev_b32 v7, 4, v7
    v_lshl_add_u32 v93, v23, 2, v7
    s_mul_i32 s27, s23, 491520
    s_lshl_b32 s3, s24, 15
    s_add_u32 s27, s27, s3
    s_cmp_lt_u32 s24, 5
    s_cselect_b32 s0, 0x3ea52b5c, 1.0
    s_mov_b32 s1, s0
    s_sub_u32 s26, 8, s16
    s_cmp_eq_u32 s19, 0
    s_cselect_b32 s26, s26, 0
    s_lshr_b32 s3, s22, 2
    s_mul_i32 s3, s3, 491520
    s_and_b32 s4, s22, 3
    s_lshl_b32 s4, s4, 9
    s_add_u32 s3, s3, s4
    s_lshl_b32 s5, s20, 11
    s_add_u32 s5, s5, 7864320
    s_add_u32 s28, s3, s5
    s_sub_u32 s3, s22, 1
    s_max_i32 s4, s3, 0
    s_lshr_b32 s3, s4, 2
    s_mul_i32 s3, s3, 491520
    s_and_b32 s4, s4, 3
    s_lshl_b32 s4, s4, 9
    s_add_u32 s3, s3, s4
    s_add_u32 s29, s3, s5
    s_lshl_b32 s3, s22, 5
    s_add_u32 s3, s3, s18
    s_mul_i32 s4, s3, 1280
    s_add_u32 s30, s4, 15728640
    s_lshl_b32 s3, s19, 2
    s_lshr_b32 s4, s18, 3
    s_add_u32 s3, s3, s4
    s_lshl_b32 s3, s3, 2
    s_lshr_b32 s4, s16, 1
    s_add_u32 s3, s3, s4
    s_lshl_b32 s3, s3, 8
    s_add_u32 s31, s3, 21266432
    s_add_u32 m0, s87, 17664
    s_add_u32 s3, s89, 61440
    buffer_load_dwordx4 v9, s[72:75], s3 offen  lds
    s_add_u32 m0, s86, 124672
    s_add_u32 s3, s88, 81920
    buffer_load_dwordx4 v8, s[68:71], s3 offen  lds
    v_and_b32 v24, 31, v0
    v_lshrrev_b32 v25, 5, v0
    s_lshl_b32 s4, s91, 5
    v_add_u32 v7, s4, v24
    v_lshlrev_b32 v26, 13, v25
    v_lshl_add_u32 v26, v7, 4, v26
    v_add_u32 v84, 99840, v26
    v_lshlrev_b32 v26, 3, v7
    v_add_u32 v85, 116224, v26
    v_lshlrev_b32 v26, 12, v25
    v_lshl_add_u32 v26, v7, 4, v26
    v_add_u32 v86, 0, v26
    s_lshl_b32 s4, s21, 3
    s_add_u32 s4, s4, 8192
    v_lshl_add_u32 v87, v7, 4, s4
    v_add_u32 v64, 2048, v84
    v_add_u32 v65, 1024, v85
    v_add_u32 v66, 2048, v86
    v_add_u32 v67, 2048, v87
    v_mov_b32 v72, 0
    v_mov_b32 v73, 0
    v_bfe_u32 v20, v0, 4, 1
    v_and_b32 v21, 3, v0
    v_lshl_add_u32 v20, v20, 2, v21
    v_add_u32 v21, s21, v20
    v_bfe_u32 v22, v0, 2, 2
    v_lshl_add_u32 v22, v25, 2, v22
    v_lshlrev_b32 v22, 4, v22
    v_and_b32 v23, 1, v21
    v_lshl_add_u32 v23, v23, 3, v22
    v_lshrrev_b32 v21, 1, v21
    v_cmp_lt_u32 vcc, 4, v20
    s_lshl_b32 s4, s91, 9
    s_add_u32 s4, s4, 120384
    v_mul_u32_u24 v7, 8256, v21
    v_add3_u32 v7, v7, v23, s4
    s_add_u32 s4, s4, 25280
    v_add_u32 v26, s4, v22
    v_cndmask_b32 v89, v7, v26, vcc
    v_add_u32 v69, 2048, v89
    v_add_u32 v26, 149760, v22
    s_mul_i32 s4, s91, 3328
    s_add_u32 s4, s4, 33344
    v_mul_u32_u24 v7, 1088, v21
    v_add3_u32 v7, v7, v23, s4
    v_cndmask_b32 v90, v7, v26, vcc
    v_add_u32 v7, 13312, v7
    v_cndmask_b32 v70, v7, v26, vcc
    s_add_u32 m0, s87, 25984
    s_add_u32 s3, s89, 92160
    buffer_load_dwordx4 v9, s[72:75], s3 offen  lds
    s_add_u32 m0, s86, 128768
    s_add_u32 s3, s88, 122880
    buffer_load_dwordx4 v8, s[68:71], s3 offen  lds
    v_lshrrev_b32 v23, 2, v0
    v_min_u32 v23, 2, v23
    v_cmp_eq_u32 vcc, 0, v23
    v_and_b32 v20, 1, v0
    v_mul_u32_u24 v22, 5, v23
    v_cndmask_b32_e64 v20, v20, 1, vcc
    s_sub_u32 s3, s22, 5
    v_add_u32 v21, s3, v20
    v_and_b32 v20, 2, v0
    v_add_u32 v20, s20, v20
    v_lshrrev_b32 v20, 4, v20
    v_add_u32 v20, v20, v22
    v_lshlrev_b32 v20, 7, v20
    v_add_u32 v20, 21135360, v20
    v_add_u32 v22, 4, v21
    v_lshl_add_u32 v68, v22, 11, v20
    v_max_i32 v21, 0, v21
    v_lshl_add_u32 v88, v21, 11, v20
    s_lshl_b32 s3, s19, 7
    s_lshr_b32 s4, s18, 3
    s_add_u32 s3, s3, s4
    s_lshl_b32 s3, s3, 7
    s_add_u32 s3, s3, 21135360
    v_writelane_b32 v88, s3, 12
    v_writelane_b32 v68, s3, 12
    v_lshlrev_b32 v26, 4, v24
    v_add_u32 v7, s21, v25
    v_lshl_add_u32 v74, v7, 11, v26
    s_cmp_eq_u32 s21, 0
    s_cselect_b32 s4, 4096, 8
    v_add_u32 v75, s4, v26
    s_cmp_eq_u32 s91, 0
    s_cselect_b32 s4, 489472, 0
    s_add_u32 s4, s4, 512
    v_mad_u32_u24 v71, s4, v25, v26
    s_cmp_eq_u32 s22, 4
    s_cselect_b32 s4, 0, s4
    v_mad_u32_u24 v91, s4, v25, v26
    v_mov_b32 v7, 0xffff
    v_cndmask_b32 v76, 0, v7, s[36:37]
    v_cndmask_b32 v77, 0, v7, s[40:41]
    v_cndmask_b32 v78, 0, v7, s[44:45]
    v_cndmask_b32 v79, 0, v7, s[48:49]
    v_cndmask_b32 v80, 0, v7, s[52:53]
    v_cndmask_b32 v81, 0, v7, s[56:57]
    v_cndmask_b32 v82, 0, v7, s[60:61]
    v_cndmask_b32 v83, 0, v7, s[64:65]
    v_cndmask_b32 v76, v76, -1, s[38:39]
    v_cndmask_b32 v77, v77, -1, s[42:43]
    v_cndmask_b32 v78, v78, -1, s[46:47]
    v_cndmask_b32 v79, v79, -1, s[50:51]
    v_cndmask_b32 v80, v80, -1, s[54:55]
    v_cndmask_b32 v81, v81, -1, s[58:59]
    v_cndmask_b32 v82, v82, -1, s[62:63]
    v_cndmask_b32 v83, v83, -1, s[66:67]
    s_add_u32 s3, s98, 149760
    v_add_u32 v7, s3, v16
    ds_write_b128 v7, v[88:91] offset:8192
    s_cmp_lg_u32 s16, 4
    s_cbranch_scc1 .Lnocommon_8
    ds_write_b128 v7, v[84:87] offset:4096
    ds_write_b128 v7, v[72:75] offset:5120
    ds_write_b128 v7, v[76:79] offset:6144
    ds_write_b128 v7, v[80:83] offset:7168
.Lnocommon_8:
    v_mov_b32 v20, 0x3f803f80
    v_mov_b32 v21, 0x3f803f80
    v_mov_b32 v22, 0x3f803f80
    v_mov_b32 v23, 0x3f803f80
    ds_write_b128 v7, v[20:23]
    s_add_u32 s3, s25, 2
    s_cmp_ge_u32 s3, 10
    s_cselect_b32 s4, 10, 0
    s_sub_u32 s3, s3, s4
    s_lshl_b32 s4, s3, 7
    s_add_u32 s88, s4, s84
    s_mul_i32 s4, s3, 245760
    s_add_u32 s89, s4, s85
    s_waitcnt vmcnt(8)
    s_barrier
    s_add_u32 m0, s87, 33280
    s_add_u32 s3, s89, 0
    buffer_load_dwordx4 v9, s[72:75], s3 offen  lds
    s_add_u32 m0, s87, 41600
    s_add_u32 s3, s89, 30720
    buffer_load_dwordx4 v9, s[72:75], s3 offen  lds
    ds_read_b128 v[96:99], v2 offset:0
    ds_read_b128 v[100:103], v2 offset:2048
    ds_read_b128 v[104:107], v3 offset:0
    ds_read_b128 v[108:111], v3 offset:2048
    s_add_u32 m0, s87, 34304
    s_add_u32 s3, s89, 61440
    buffer_load_dwordx4 v9, s[72:75], s3 offen  lds
    s_add_u32 m0, s87, 42624
    s_add_u32 s3, s89, 92160
    buffer_load_dwordx4 v9, s[72:75], s3 offen  lds
    s_add_u32 m0, s86, 133120
    s_add_u32 s3, s88, 0
    buffer_load_dwordx4 v8, s[68:71], s3 offen  lds
    s_add_u32 m0, s86, 137216
    s_add_u32 s3, s88, 40960
    buffer_load_dwordx4 v8, s[68:71], s3 offen  lds
    s_add_u32 m0, s86, 141312
    s_add_u32 s3, s88, 81920
    buffer_load_dwordx4 v8, s[68:71], s3 offen  lds
    s_add_u32 m0, s86, 145408
    s_add_u32 s3, s88, 122880
    buffer_load_dwordx4 v8, s[68:71], s3 offen  lds
    s_add_u32 s3, s25, 3
    s_cmp_ge_u32 s3, 10
    s_cselect_b32 s4, 10, 0
    s_sub_u32 s3, s3, s4
    s_lshl_b32 s4, s3, 7
    s_add_u32 s88, s4, s84
    s_mul_i32 s4, s3, 245760
    s_add_u32 s89, s4, s85
    s_waitcnt vmcnt(8)
    s_waitcnt lgkmcnt(0)
    s_barrier
    s_add_u32 m0, s87, 49920
    s_add_u32 s3, s89, 0
    buffer_load_dwordx4 v9, s[72:75], s3 offen  lds
    s_add_u32 m0, s87, 58240
    s_add_u32 s3, s89, 30720
    buffer_load_dwordx4 v9, s[72:75], s3 offen  lds
    ds_read_b128 v[112:115], v2 offset:16640
    ds_read_b128 v[116:119], v2 offset:18688
    ds_read_b128 v[120:123], v3 offset:16640
    ds_read_b128 v[124:127], v3 offset:18688
    s_add_u32 m0, s87, 50944
    s_add_u32 s3, s89, 61440
    buffer_load_dwordx4 v9, s[72:75], s3 offen  lds
    s_add_u32 m0, s87, 59264
    s_add_u32 s3, s89, 92160
    buffer_load_dwordx4 v9, s[72:75], s3 offen  lds
    s_add_u32 m0, s86, 99840
    s_add_u32 s3, s88, 0
    buffer_load_dwordx4 v8, s[68:71], s3 offen  lds
    s_add_u32 m0, s86, 103936
    s_add_u32 s3, s88, 40960
    buffer_load_dwordx4 v8, s[68:71], s3 offen  lds
    s_add_u32 m0, s86, 108032
    s_add_u32 s3, s88, 81920
    buffer_load_dwordx4 v8, s[68:71], s3 offen  lds
    s_add_u32 m0, s86, 112128
    s_add_u32 s3, s88, 122880
    buffer_load_dwordx4 v8, s[68:71], s3 offen  lds
    s_add_u32 s3, s25, 4
    s_cmp_ge_u32 s3, 10
    s_cselect_b32 s4, 10, 0
    s_sub_u32 s3, s3, s4
    s_lshl_b32 s4, s3, 7
    s_add_u32 s88, s4, s84
    s_mul_i32 s4, s3, 245760
    s_add_u32 s89, s4, s85
    s_waitcnt vmcnt(8)
    s_waitcnt lgkmcnt(0)
    s_barrier
    s_add_u32 m0, s87, 66560
    s_add_u32 s3, s89, 0
    buffer_load_dwordx4 v9, s[72:75], s3 offen  lds
    s_add_u32 m0, s87, 74880
    s_add_u32 s3, s89, 30720
    buffer_load_dwordx4 v9, s[72:75], s3 offen  lds
    ds_read_b128 v[128:131], v2 offset:33280
    ds_read_b128 v[132:135], v2 offset:35328
    ds_read_b128 v[136:139], v3 offset:33280
    ds_read_b128 v[140:143], v3 offset:35328
    s_add_u32 m0, s87, 67584
    s_add_u32 s3, s89, 61440
    buffer_load_dwordx4 v9, s[72:75], s3 offen  lds
    s_add_u32 m0, s87, 75904
    s_add_u32 s3, s89, 92160
    buffer_load_dwordx4 v9, s[72:75], s3 offen  lds
    s_add_u32 m0, s86, 116480
    s_add_u32 s3, s88, 0
    buffer_load_dwordx4 v8, s[68:71], s3 offen  lds
    s_add_u32 m0, s86, 120576
    s_add_u32 s3, s88, 40960
    buffer_load_dwordx4 v8, s[68:71], s3 offen  lds
    s_add_u32 m0, s86, 124672
    s_add_u32 s3, s88, 81920
    buffer_load_dwordx4 v8, s[68:71], s3 offen  lds
    s_add_u32 m0, s86, 128768
    s_add_u32 s3, s88, 122880
    buffer_load_dwordx4 v8, s[68:71], s3 offen  lds
    s_add_u32 s3, s25, 5
    s_cmp_ge_u32 s3, 10
    s_cselect_b32 s4, 10, 0
    s_sub_u32 s3, s3, s4
    s_lshl_b32 s4, s3, 7
    s_add_u32 s88, s4, s84
    s_mul_i32 s4, s3, 245760
    s_add_u32 s89, s4, s85
    s_add_u32 m0, s87, 83200
    s_add_u32 s3, s89, 0
    buffer_load_dwordx4 v9, s[72:75], s3 offen  lds
    s_add_u32 m0, s87, 91520
    s_add_u32 s3, s89, 30720
    buffer_load_dwordx4 v9, s[72:75], s3 offen  lds
    s_waitcnt vmcnt(10)
    s_waitcnt lgkmcnt(0)
    s_barrier
    s_add_u32 m0, s87, 84224
    s_add_u32 s3, s89, 61440
    buffer_load_dwordx4 v9, s[72:75], s3 offen  lds
    s_add_u32 m0, s87, 92544
    s_add_u32 s3, s89, 92160
    buffer_load_dwordx4 v9, s[72:75], s3 offen  lds
    ds_read_b128 v[144:147], v2 offset:0
    ds_read_b128 v[148:151], v2 offset:2048
    ds_read_b128 v[152:155], v3 offset:0
    ds_read_b128 v[156:159], v3 offset:2048
    s_add_u32 m0, s86, 133120
    s_add_u32 s3, s88, 0
    buffer_load_dwordx4 v8, s[68:71], s3 offen  lds
    s_add_u32 m0, s86, 137216
    s_add_u32 s3, s88, 40960
    buffer_load_dwordx4 v8, s[68:71], s3 offen  lds
    s_add_u32 m0, s86, 141312
    s_add_u32 s3, s88, 81920
    buffer_load_dwordx4 v8, s[68:71], s3 offen  lds
    s_add_u32 m0, s86, 145408
    s_add_u32 s3, s88, 122880
    buffer_load_dwordx4 v8, s[68:71], s3 offen  lds
    s_add_u32 s3, s25, 6
    s_cmp_ge_u32 s3, 10
    s_cselect_b32 s4, 10, 0
    s_sub_u32 s3, s3, s4
    s_lshl_b32 s4, s3, 7
    s_add_u32 s88, s4, s84
    s_mul_i32 s4, s3, 245760
    s_add_u32 s89, s4, s85
    s_add_u32 m0, s87, 0
    s_add_u32 s3, s89, 0
    buffer_load_dwordx4 v9, s[72:75], s3 offen  lds
    s_add_u32 m0, s87, 8320
    s_add_u32 s3, s89, 30720
    buffer_load_dwordx4 v9, s[72:75], s3 offen  lds
    buffer_load_dwordx2 v[94:95], off, s[32:35], 0 sc1
    s_waitcnt vmcnt(11)
    s_waitcnt lgkmcnt(0)
    s_barrier
    s_add_u32 m0, s87, 1024
    s_add_u32 s3, s89, 61440
    buffer_load_dwordx4 v9, s[72:75], s3 offen  lds
    s_add_u32 m0, s87, 9344
    s_add_u32 s3, s89, 92160
    buffer_load_dwordx4 v9, s[72:75], s3 offen  lds
    ds_read_b128 v[160:163], v2 offset:16640
    ds_read_b128 v[164:167], v2 offset:18688
    ds_read_b128 v[168:171], v3 offset:16640
    ds_read_b128 v[172:175], v3 offset:18688
    s_add_u32 m0, s86, 99840
    s_add_u32 s3, s88, 0
    buffer_load_dwordx4 v8, s[68:71], s3 offen  lds
    s_add_u32 m0, s86, 103936
    s_add_u32 s3, s88, 40960
    buffer_load_dwordx4 v8, s[68:71], s3 offen  lds
    s_add_u32 m0, s86, 108032
    s_add_u32 s3, s88, 81920
    buffer_load_dwordx4 v8, s[68:71], s3 offen  lds
    s_add_u32 m0, s86, 112128
    s_add_u32 s3, s88, 122880
    buffer_load_dwordx4 v8, s[68:71], s3 offen  lds
    s_add_u32 s3, s25, 7
    s_cmp_ge_u32 s3, 10
    s_cselect_b32 s4, 10, 0
    s_sub_u32 s3, s3, s4
    s_lshl_b32 s4, s3, 7
    s_add_u32 s88, s4, s84
    s_mul_i32 s4, s3, 245760
    s_add_u32 s89, s4, s85
    s_add_u32 m0, s87, 16640
    s_add_u32 s3, s89, 0
    buffer_load_dwordx4 v9, s[72:75], s3 offen  lds
    s_add_u32 m0, s87, 24960
    s_add_u32 s3, s89, 30720
    buffer_load_dwordx4 v9, s[72:75], s3 offen  lds
    s_waitcnt vmcnt(11)
    s_waitcnt lgkmcnt(0)
    s_barrier
    s_add_u32 m0, s87, 17664
    s_add_u32 s3, s89, 61440
    buffer_load_dwordx4 v9, s[72:75], s3 offen  lds
    s_add_u32 m0, s87, 25984
    s_add_u32 s3, s89, 92160
    buffer_load_dwordx4 v9, s[72:75], s3 offen  lds
    ds_read_b128 v[176:179], v2 offset:33280
    ds_read_b128 v[180:183], v2 offset:35328
    ds_read_b128 v[184:187], v3 offset:33280
    ds_read_b128 v[188:191], v3 offset:35328
    s_add_u32 m0, s86, 116480
    s_add_u32 s3, s88, 0
    buffer_load_dwordx4 v8, s[68:71], s3 offen  lds
    s_add_u32 m0, s86, 120576
    s_add_u32 s3, s88, 40960
    buffer_load_dwordx4 v8, s[68:71], s3 offen  lds
    s_add_u32 m0, s86, 124672
    s_add_u32 s3, s88, 81920
    buffer_load_dwordx4 v8, s[68:71], s3 offen  lds
    s_add_u32 m0, s86, 128768
    s_add_u32 s3, s88, 122880
    buffer_load_dwordx4 v8, s[68:71], s3 offen  lds
    s_add_u32 s3, s25, 8
    s_cmp_ge_u32 s3, 10
    s_cselect_b32 s4, 10, 0
    s_sub_u32 s3, s3, s4
    s_lshl_b32 s4, s3, 7
    s_add_u32 s88, s4, s84
    s_mul_i32 s4, s3, 245760
    s_add_u32 s89, s4, s85
    s_add_u32 m0, s87, 33280
    s_add_u32 s3, s89, 0
    buffer_load_dwordx4 v9, s[72:75], s3 offen  lds
    s_add_u32 m0, s87, 41600
    s_add_u32 s3, s89, 30720
    buffer_load_dwordx4 v9, s[72:75], s3 offen  lds
    s_waitcnt vmcnt(10)
    s_waitcnt lgkmcnt(0)
    s_barrier
    s_add_u32 m0, s87, 34304
    s_add_u32 s3, s89, 61440
    buffer_load_dwordx4 v9, s[72:75], s3 offen  lds
    s_add_u32 m0, s87, 42624
    s_add_u32 s3, s89, 92160
    buffer_load_dwordx4 v9, s[72:75], s3 offen  lds
    ds_read_b128 v[192:195], v2 offset:0
    ds_read_b128 v[196:199], v2 offset:2048
    ds_read_b128 v[200:203], v3 offset:0
    ds_read_b128 v[204:207], v3 offset:2048
    s_add_u32 m0, s86, 133120
    s_add_u32 s3, s88, 0
    buffer_load_dwordx4 v8, s[68:71], s3 offen  lds
    s_add_u32 m0, s86, 137216
    s_add_u32 s3, s88, 40960
    buffer_load_dwordx4 v8, s[68:71], s3 offen  lds
    s_add_u32 m0, s86, 141312
    s_add_u32 s3, s88, 81920
    buffer_load_dwordx4 v8, s[68:71], s3 offen  lds
    s_add_u32 m0, s86, 145408
    s_add_u32 s3, s88, 122880
    buffer_load_dwordx4 v8, s[68:71], s3 offen  lds
    s_add_u32 s3, s25, 9
    s_cmp_ge_u32 s3, 10
    s_cselect_b32 s4, 10, 0
    s_sub_u32 s3, s3, s4
    s_lshl_b32 s4, s3, 7
    s_add_u32 s88, s4, s84
    s_mul_i32 s4, s3, 245760
    s_add_u32 s89, s4, s85
    s_add_u32 m0, s87, 49920
    s_add_u32 s3, s89, 0
    buffer_load_dwordx4 v9, s[72:75], s3 offen  lds
    s_add_u32 m0, s87, 58240
    s_add_u32 s3, s89, 30720
    buffer_load_dwordx4 v9, s[72:75], s3 offen  lds
    s_waitcnt vmcnt(10)
    s_waitcnt lgkmcnt(0)
    s_barrier
    s_add_u32 m0, s87, 50944
    s_add_u32 s3, s89, 61440
    buffer_load_dwordx4 v9, s[72:75], s3 offen  lds
    s_add_u32 m0, s87, 59264
    s_add_u32 s3, s89, 92160
    buffer_load_dwordx4 v9, s[72:75], s3 offen  lds
    ds_read_b128 v[208:211], v2 offset:16640
    ds_read_b128 v[212:215], v2 offset:18688
    ds_read_b128 v[216:219], v3 offset:16640
    ds_read_b128 v[220:223], v3 offset:18688
    s_add_u32 m0, s86, 99840
    s_add_u32 s3, s88, 0
    buffer_load_dwordx4 v8, s[68:71], s3 offen  lds
    s_add_u32 m0, s86, 103936
    s_add_u32 s3, s88, 40960
    buffer_load_dwordx4 v8, s[68:71], s3 offen  lds
    s_add_u32 m0, s86, 108032
    s_add_u32 s3, s88, 81920
    buffer_load_dwordx4 v8, s[68:71], s3 offen  lds
    s_add_u32 m0, s86, 112128
    s_add_u32 s3, s88, 122880
    buffer_load_dwordx4 v8, s[68:71], s3 offen  lds
    s_add_u32 s3, s25, 0
    s_cmp_ge_u32 s3, 10
    s_cselect_b32 s4, 10, 0
    s_sub_u32 s3, s3, s4
    s_mul_i32 s4, s3, 245760
    s_add_u32 s89, s4, s85
    s_cmp_eq_u32 s3, 9
    s_cselect_b32 s89, s85, s89
    s_cselect_b64 vcc, -1, 0
    v_cndmask_b32 v10, v30, v31, vcc
    s_add_u32 m0, s87, 66560
    s_add_u32 s3, s89, 0
    buffer_load_dwordx4 v10, s[76:79], s3 offen  lds
    s_add_u32 m0, s87, 74880
    s_add_u32 s3, s89, 30720
    buffer_load_dwordx4 v10, s[76:79], s3 offen  lds
    v_cmp_eq_u32 vcc, 0, v94
    s_nop 1
    s_cbranch_vccnz .Lnsp_10
.Lnok_9:
    s_waitcnt vmcnt(10)
    s_waitcnt lgkmcnt(0)
    s_barrier
    s_add_u32 m0, s87, 67584
    s_add_u32 s3, s89, 61440
    buffer_load_dwordx4 v10, s[76:79], s3 offen  lds
    s_add_u32 m0, s87, 75904
    s_add_u32 s3, s89, 92160
    buffer_load_dwordx4 v10, s[76:79], s3 offen  lds
    ds_read_b128 v[224:227], v2 offset:33280
    ds_read_b128 v[228:231], v2 offset:35328
    ds_read_b128 v[232:235], v3 offset:33280
    ds_read_b128 v[236:239], v3 offset:35328
    s_add_u32 s3, s25, 2
    s_cmp_ge_u32 s3, 10
    s_cselect_b32 s4, 10, 0
    s_sub_u32 s3, s3, s4
    s_mul_i32 s4, s3, 245760
    s_add_u32 s89, s4, s85
    s_cmp_eq_u32 s3, 9
    s_cselect_b32 s89, s85, s89
    s_cselect_b64 vcc, -1, 0
    v_cndmask_b32 v10, v30, v31, vcc
    s_add_u32 m0, s87, 83200
    s_add_u32 s3, s89, 0
    buffer_load_dwordx4 v10, s[76:79], s3 offen  lds
    s_add_u32 m0, s87, 91520
    s_add_u32 s3, s89, 30720
    buffer_load_dwordx4 v10, s[76:79], s3 offen  lds
    s_add_u32 m0, s87, 84224
    s_add_u32 s3, s89, 61440
    buffer_load_dwordx4 v10, s[76:79], s3 offen  lds
    s_add_u32 m0, s87, 92544
    s_add_u32 s3, s89, 92160
    buffer_load_dwordx4 v10, s[76:79], s3 offen  lds
    s_add_u32 s3, s25, 4
    s_cmp_ge_u32 s3, 10
    s_cselect_b32 s4, 10, 0
    s_sub_u32 s3, s3, s4
    s_mul_i32 s4, s3, 245760
    s_add_u32 s89, s4, s85
    s_cmp_eq_u32 s3, 9
    s_cselect_b32 s89, s85, s89
    s_cselect_b64 vcc, -1, 0
    v_cndmask_b32 v10, v30, v31, vcc
    s_waitcnt vmcnt(8)
    s_waitcnt lgkmcnt(0)
    s_barrier
    s_add_u32 m0, s87, 116480
    s_add_u32 s3, s89, 0
    buffer_load_dwordx4 v10, s[76:79], s3 offen  lds
    s_add_u32 m0, s87, 124800
    s_add_u32 s3, s89, 30720
    buffer_load_dwordx4 v10, s[76:79], s3 offen  lds
    ds_read_b128 v[240:243], v2 offset:0
    ds_read_b128 v[244:247], v2 offset:2048
    ds_read_b128 v[248:251], v3 offset:0
    ds_read_b128 v[252:255], v3 offset:2048
    s_add_u32 m0, s87, 117504
    s_add_u32 s3, s89, 61440
    buffer_load_dwordx4 v10, s[76:79], s3 offen  lds
    s_add_u32 m0, s87, 125824
    s_add_u32 s3, s89, 92160
    buffer_load_dwordx4 v10, s[76:79], s3 offen  lds
    s_add_u32 s3, s25, 6
    s_cmp_ge_u32 s3, 10
    s_cselect_b32 s4, 10, 0
    s_sub_u32 s3, s3, s4
    s_mul_i32 s4, s3, 245760
    s_add_u32 s89, s4, s85
    s_cmp_eq_u32 s3, 9
    s_cselect_b32 s89, s85, s89
    s_cselect_b64 vcc, -1, 0
    v_cndmask_b32 v10, v30, v31, vcc
    s_add_u32 m0, s87, 133120
    s_add_u32 s3, s89, 0
    buffer_load_dwordx4 v10, s[76:79], s3 offen  lds
    s_add_u32 m0, s87, 141440
    s_add_u32 s3, s89, 30720
    buffer_load_dwordx4 v10, s[76:79], s3 offen  lds
    s_add_u32 m0, s87, 134144
    s_add_u32 s3, s89, 61440
    buffer_load_dwordx4 v10, s[76:79], s3 offen  lds
    s_add_u32 m0, s87, 142464
    s_add_u32 s3, s89, 92160
    buffer_load_dwordx4 v10, s[76:79], s3 offen  lds
    s_add_u32 s3, s25, 8
    s_cmp_ge_u32 s3, 10
    s_cselect_b32 s4, 10, 0
    s_sub_u32 s3, s3, s4
    s_mul_i32 s4, s3, 245760
    s_add_u32 s89, s4, s85
    s_cmp_eq_u32 s3, 9
    s_cselect_b32 s89, s85, s89
    s_cselect_b64 vcc, -1, 0
    v_cndmask_b32 v10, v30, v31, vcc
    s_add_u32 m0, s87, 0
    s_add_u32 s3, s89, 0
    buffer_load_dwordx4 v10, s[76:79], s3 offen  lds
    s_add_u32 m0, s87, 8320
    s_add_u32 s3, s89, 30720
    buffer_load_dwordx4 v10, s[76:79], s3 offen  lds
    s_add_u32 m0, s87, 1024
    s_add_u32 s3, s89, 61440
    buffer_load_dwordx4 v10, s[76:79], s3 offen  lds
    s_add_u32 m0, s87, 9344
    s_add_u32 s3, s89, 92160
    buffer_load_dwordx4 v10, s[76:79], s3 offen  lds
    s_waitcnt lgkmcnt(0)
    v_add_u32 v2, 133120, v4
    s_setprio 0
    s_waitcnt vmcnt(12)
    s_barrier
    ds_read_b64_tr_b16 v[24:25], v5 offset:0
    ds_read_b64_tr_b16 v[26:27], v5 offset:128
    ds_read_b64_tr_b16 v[28:29], v5 offset:32
    ds_read_b64_tr_b16 v[30:31], v5 offset:160
    ds_read_b64_tr_b16 v[8:9], v5 offset:64
    ds_read_b64_tr_b16 v[10:11], v5 offset:192
    ds_read_b64_tr_b16 v[12:13], v5 offset:96
    ds_read_b64_tr_b16 v[14:15], v5 offset:224
    ds_read_b64_tr_b16 v[16:17], v5 offset:256
    ds_read_b64_tr_b16 v[18:19], v5 offset:384
    s_waitcnt lgkmcnt(8)
    v_mfma_f32_16x16x32_bf16 v[32:35], v[24:27], v[96:99], 0
    ds_read_b64_tr_b16 v[20:21], v5 offset:288
    v_mfma_f32_16x16x32_bf16 v[36:39], v[24:27], v[100:103], 0
    ds_read_b64_tr_b16 v[22:23], v5 offset:416
    s_waitcnt lgkmcnt(8)
    v_mfma_f32_16x16x32_bf16 v[40:43], v[28:31], v[96:99], 0
    ds_read_b64_tr_b16 v[24:25], v5 offset:320
    v_mfma_f32_16x16x32_bf16 v[44:47], v[28:31], v[100:103], 0
    ds_read_b64_tr_b16 v[26:27], v5 offset:448
    s_waitcnt lgkmcnt(8)
    v_mfma_f32_16x16x32_bf16 v[48:51], v[8:11], v[96:99], 0
    ds_read_b64_tr_b16 v[28:29], v5 offset:352
    v_mfma_f32_16x16x32_bf16 v[52:55], v[8:11], v[100:103], 0
    ds_read_b64_tr_b16 v[30:31], v5 offset:480
    s_waitcnt lgkmcnt(8)
    v_mfma_f32_16x16x32_bf16 v[56:59], v[12:15], v[96:99], 0
    ds_read_b64_tr_b16 v[8:9], v5 offset:512
    v_mfma_f32_16x16x32_bf16 v[60:63], v[12:15], v[100:103], 0
    ds_read_b64_tr_b16 v[10:11], v5 offset:640
    s_waitcnt lgkmcnt(8)
    v_mfma_f32_16x16x32_bf16 v[32:35], v[16:19], v[104:107], v[32:35]
    ds_read_b64_tr_b16 v[12:13], v5 offset:544
    v_mfma_f32_16x16x32_bf16 v[36:39], v[16:19], v[108:111], v[36:39]
    ds_read_b64_tr_b16 v[14:15], v5 offset:672
    s_waitcnt lgkmcnt(8)
    v_mfma_f32_16x16x32_bf16 v[40:43], v[20:23], v[104:107], v[40:43]
    ds_read_b64_tr_b16 v[16:17], v5 offset:576
    v_mfma_f32_16x16x32_bf16 v[44:47], v[20:23], v[108:111], v[44:47]
    ds_read_b64_tr_b16 v[18:19], v5 offset:704
    s_waitcnt lgkmcnt(8)
    v_mfma_f32_16x16x32_bf16 v[48:51], v[24:27], v[104:107], v[48:51]
    ds_read_b64_tr_b16 v[20:21], v5 offset:608
    v_mfma_f32_16x16x32_bf16 v[52:55], v[24:27], v[108:111], v[52:55]
    ds_read_b64_tr_b16 v[22:23], v5 offset:736
    s_waitcnt lgkmcnt(8)
    v_mfma_f32_16x16x32_bf16 v[56:59], v[28:31], v[104:107], v[56:59]
    ds_read_b64_tr_b16 v[24:25], v5 offset:768
    v_mfma_f32_16x16x32_bf16 v[60:63], v[28:31], v[108:111], v[60:63]
    ds_read_b64_tr_b16 v[26:27], v5 offset:896
    s_waitcnt lgkmcnt(8)
    v_mfma_f32_16x16x32_bf16 v[32:35], v[8:11], v[112:115], v[32:35]
    ds_read_b64_tr_b16 v[28:29], v5 offset:800
    v_mfma_f32_16x16x32_bf16 v[36:39], v[8:11], v[116:119], v[36:39]
    ds_read_b64_tr_b16 v[30:31], v5 offset:928
    s_waitcnt lgkmcnt(8)
    v_mfma_f32_16x16x32_bf16 v[40:43], v[12:15], v[112:115], v[40:43]
    ds_read_b64_tr_b16 v[8:9], v5 offset:832
    v_mfma_f32_16x16x32_bf16 v[44:47], v[12:15], v[116:119], v[44:47]
    ds_read_b64_tr_b16 v[10:11], v5 offset:960
    s_waitcnt lgkmcnt(8)
    v_mfma_f32_16x16x32_bf16 v[48:51], v[16:19], v[112:115], v[48:51]
    ds_read_b64_tr_b16 v[12:13], v5 offset:864
    v_mfma_f32_16x16x32_bf16 v[52:55], v[16:19], v[116:119], v[52:55]
    ds_read_b64_tr_b16 v[14:15], v5 offset:992
    s_waitcnt lgkmcnt(8)
    v_mfma_f32_16x16x32_bf16 v[56:59], v[20:23], v[112:115], v[56:59]
    ds_read_b64_tr_b16 v[16:17], v5 offset:16640
    v_mfma_f32_16x16x32_bf16 v[60:63], v[20:23], v[116:119], v[60:63]
    ds_read_b64_tr_b16 v[18:19], v5 offset:16768
    s_waitcnt lgkmcnt(8)
    v_mfma_f32_16x16x32_bf16 v[32:35], v[24:27], v[120:123], v[32:35]
    ds_read_b64_tr_b16 v[20:21], v5 offset:16672
    v_mfma_f32_16x16x32_bf16 v[36:39], v[24:27], v[124:127], v[36:39]
    ds_read_b64_tr_b16 v[22:23], v5 offset:16800
    s_waitcnt lgkmcnt(8)
    v_mfma_f32_16x16x32_bf16 v[40:43], v[28:31], v[120:123], v[40:43]
    ds_read_b64_tr_b16 v[24:25], v5 offset:16704
    v_mfma_f32_16x16x32_bf16 v[44:47], v[28:31], v[124:127], v[44:47]
    ds_read_b64_tr_b16 v[26:27], v5 offset:16832
    s_waitcnt lgkmcnt(8)
    v_mfma_f32_16x16x32_bf16 v[48:51], v[8:11], v[120:123], v[48:51]
    ds_read_b64_tr_b16 v[28:29], v5 offset:16736
    v_mfma_f32_16x16x32_bf16 v[52:55], v[8:11], v[124:127], v[52:55]
    ds_read_b64_tr_b16 v[30:31], v5 offset:16864
    s_waitcnt lgkmcnt(8)
    v_mfma_f32_16x16x32_bf16 v[56:59], v[12:15], v[120:123], v[56:59]
    ds_read_b64_tr_b16 v[8:9], v5 offset:16896
    v_mfma_f32_16x16x32_bf16 v[60:63], v[12:15], v[124:127], v[60:63]
    ds_read_b64_tr_b16 v[10:11], v5 offset:17024
    s_waitcnt lgkmcnt(8)
    v_mfma_f32_16x16x32_bf16 v[32:35], v[16:19], v[128:131], v[32:35]
    ds_read_b64_tr_b16 v[12:13], v5 offset:16928
    v_mfma_f32_16x16x32_bf16 v[36:39], v[16:19], v[132:135], v[36:39]
    ds_read_b64_tr_b16 v[14:15], v5 offset:17056
    s_waitcnt lgkmcnt(8)
    v_mfma_f32_16x16x32_bf16 v[40:43], v[20:23], v[128:131], v[40:43]
    ds_read_b64_tr_b16 v[16:17], v5 offset:16960
    v_mfma_f32_16x16x32_bf16 v[44:47], v[20:23], v[132:135], v[44:47]
    ds_read_b64_tr_b16 v[18:19], v5 offset:17088
    s_waitcnt lgkmcnt(8)
    v_mfma_f32_16x16x32_bf16 v[48:51], v[24:27], v[128:131], v[48:51]
    ds_read_b64_tr_b16 v[20:21], v5 offset:16992
    v_mfma_f32_16x16x32_bf16 v[52:55], v[24:27], v[132:135], v[52:55]
    ds_read_b64_tr_b16 v[22:23], v5 offset:17120
    s_waitcnt lgkmcnt(8)
    v_mfma_f32_16x16x32_bf16 v[56:59], v[28:31], v[128:131], v[56:59]
    ds_read_b64_tr_b16 v[24:25], v5 offset:17152
    v_mfma_f32_16x16x32_bf16 v[60:63], v[28:31], v[132:135], v[60:63]
    ds_read_b64_tr_b16 v[26:27], v5 offset:17280
    s_waitcnt lgkmcnt(8)
    v_mfma_f32_16x16x32_bf16 v[32:35], v[8:11], v[136:139], v[32:35]
    ds_read_b64_tr_b16 v[28:29], v5 offset:17184
    v_mfma_f32_16x16x32_bf16 v[36:39], v[8:11], v[140:143], v[36:39]
    ds_read_b64_tr_b16 v[30:31], v5 offset:17312
    s_waitcnt lgkmcnt(8)
    v_mfma_f32_16x16x32_bf16 v[40:43], v[12:15], v[136:139], v[40:43]
    ds_read_b64_tr_b16 v[8:9], v5 offset:17216
    v_mfma_f32_16x16x32_bf16 v[44:47], v[12:15], v[140:143], v[44:47]
    ds_read_b64_tr_b16 v[10:11], v5 offset:17344
    s_waitcnt lgkmcnt(8)
    v_mfma_f32_16x16x32_bf16 v[48:51], v[16:19], v[136:139], v[48:51]
    ds_read_b64_tr_b16 v[12:13], v5 offset:17248
    v_mfma_f32_16x16x32_bf16 v[52:55], v[16:19], v[140:143], v[52:55]
    ds_read_b64_tr_b16 v[14:15], v5 offset:17376
    s_waitcnt lgkmcnt(8)
    v_mfma_f32_16x16x32_bf16 v[56:59], v[20:23], v[136:139], v[56:59]
    ds_read_b64_tr_b16 v[16:17], v5 offset:17408
    v_mfma_f32_16x16x32_bf16 v[60:63], v[20:23], v[140:143], v[60:63]
    ds_read_b64_tr_b16 v[18:19], v5 offset:17536
    s_waitcnt lgkmcnt(8)
    v_mfma_f32_16x16x32_bf16 v[32:35], v[24:27], v[144:147], v[32:35]
    ds_read_b64_tr_b16 v[20:21], v5 offset:17440
    v_mfma_f32_16x16x32_bf16 v[36:39], v[24:27], v[148:151], v[36:39]
    ds_read_b64_tr_b16 v[22:23], v5 offset:17568
    s_waitcnt lgkmcnt(8)
    v_mfma_f32_16x16x32_bf16 v[40:43], v[28:31], v[144:147], v[40:43]
    ds_read_b64_tr_b16 v[24:25], v5 offset:17472
    v_mfma_f32_16x16x32_bf16 v[44:47], v[28:31], v[148:151], v[44:47]
    ds_read_b64_tr_b16 v[26:27], v5 offset:17600
    s_waitcnt lgkmcnt(8)
    v_mfma_f32_16x16x32_bf16 v[48:51], v[8:11], v[144:147], v[48:51]
    ds_read_b64_tr_b16 v[28:29], v5 offset:17504
    v_mfma_f32_16x16x32_bf16 v[52:55], v[8:11], v[148:151], v[52:55]
    ds_read_b64_tr_b16 v[30:31], v5 offset:17632
    s_waitcnt lgkmcnt(8)
    v_mfma_f32_16x16x32_bf16 v[56:59], v[12:15], v[144:147], v[56:59]
    s_waitcnt vmcnt(4)
    s_barrier
    ds_read_b64_tr_b16 v[8:9], v5 offset:49920
    v_mfma_f32_16x16x32_bf16 v[60:63], v[12:15], v[148:151], v[60:63]
    ds_read_b64_tr_b16 v[10:11], v5 offset:50048
    s_waitcnt lgkmcnt(8)
    v_mfma_f32_16x16x32_bf16 v[32:35], v[16:19], v[152:155], v[32:35]
    ds_read_b64_tr_b16 v[12:13], v5 offset:49952
    v_mfma_f32_16x16x32_bf16 v[36:39], v[16:19], v[156:159], v[36:39]
    ds_read_b64_tr_b16 v[14:15], v5 offset:50080
    s_waitcnt lgkmcnt(8)
    v_mfma_f32_16x16x32_bf16 v[40:43], v[20:23], v[152:155], v[40:43]
    ds_read_b64_tr_b16 v[16:17], v5 offset:49984
    v_mfma_f32_16x16x32_bf16 v[44:47], v[20:23], v[156:159], v[44:47]
    ds_read_b64_tr_b16 v[18:19], v5 offset:50112
    s_waitcnt lgkmcnt(8)
    v_mfma_f32_16x16x32_bf16 v[48:51], v[24:27], v[152:155], v[48:51]
    ds_read_b64_tr_b16 v[20:21], v5 offset:50016
    v_mfma_f32_16x16x32_bf16 v[52:55], v[24:27], v[156:159], v[52:55]
    ds_read_b64_tr_b16 v[22:23], v5 offset:50144
    s_waitcnt lgkmcnt(8)
    v_mfma_f32_16x16x32_bf16 v[56:59], v[28:31], v[152:155], v[56:59]
    ds_read_b64_tr_b16 v[24:25], v5 offset:50176
    v_mfma_f32_16x16x32_bf16 v[60:63], v[28:31], v[156:159], v[60:63]
    ds_read_b64_tr_b16 v[26:27], v5 offset:50304
    s_waitcnt lgkmcnt(8)
    v_mfma_f32_16x16x32_bf16 v[32:35], v[8:11], v[160:163], v[32:35]
    ds_read_b64_tr_b16 v[28:29], v5 offset:50208
    v_mfma_f32_16x16x32_bf16 v[36:39], v[8:11], v[164:167], v[36:39]
    ds_read_b64_tr_b16 v[30:31], v5 offset:50336
    s_waitcnt lgkmcnt(8)
    v_mfma_f32_16x16x32_bf16 v[40:43], v[12:15], v[160:163], v[40:43]
    ds_read_b64_tr_b16 v[8:9], v5 offset:50240
    v_mfma_f32_16x16x32_bf16 v[44:47], v[12:15], v[164:167], v[44:47]
    ds_read_b64_tr_b16 v[10:11], v5 offset:50368
    s_waitcnt lgkmcnt(8)
    v_mfma_f32_16x16x32_bf16 v[48:51], v[16:19], v[160:163], v[48:51]
    ds_read_b64_tr_b16 v[12:13], v5 offset:50272
    v_mfma_f32_16x16x32_bf16 v[52:55], v[16:19], v[164:167], v[52:55]
    ds_read_b64_tr_b16 v[14:15], v5 offset:50400
    s_waitcnt lgkmcnt(8)
    v_mfma_f32_16x16x32_bf16 v[56:59], v[20:23], v[160:163], v[56:59]
    ds_read_b64_tr_b16 v[16:17], v5 offset:50432
    v_mfma_f32_16x16x32_bf16 v[60:63], v[20:23], v[164:167], v[60:63]
    ds_read_b64_tr_b16 v[18:19], v5 offset:50560
    s_waitcnt lgkmcnt(8)
    v_mfma_f32_16x16x32_bf16 v[32:35], v[24:27], v[168:171], v[32:35]
    ds_read_b64_tr_b16 v[20:21], v5 offset:50464
    v_mfma_f32_16x16x32_bf16 v[36:39], v[24:27], v[172:175], v[36:39]
    ds_read_b64_tr_b16 v[22:23], v5 offset:50592
    s_waitcnt lgkmcnt(8)
    v_mfma_f32_16x16x32_bf16 v[40:43], v[28:31], v[168:171], v[40:43]
    ds_read_b64_tr_b16 v[24:25], v5 offset:50496
    v_mfma_f32_16x16x32_bf16 v[44:47], v[28:31], v[172:175], v[44:47]
    ds_read_b64_tr_b16 v[26:27], v5 offset:50624
    s_waitcnt lgkmcnt(8)
    v_mfma_f32_16x16x32_bf16 v[48:51], v[8:11], v[168:171], v[48:51]
    ds_read_b64_tr_b16 v[28:29], v5 offset:50528
    v_mfma_f32_16x16x32_bf16 v[52:55], v[8:11], v[172:175], v[52:55]
    ds_read_b64_tr_b16 v[30:31], v5 offset:50656
    s_waitcnt lgkmcnt(8)
    v_mfma_f32_16x16x32_bf16 v[56:59], v[12:15], v[168:171], v[56:59]
    ds_read_b64_tr_b16 v[8:9], v5 offset:50688
    v_mfma_f32_16x16x32_bf16 v[60:63], v[12:15], v[172:175], v[60:63]
    ds_read_b64_tr_b16 v[10:11], v5 offset:50816
    s_waitcnt lgkmcnt(8)
    v_mfma_f32_16x16x32_bf16 v[32:35], v[16:19], v[176:179], v[32:35]
    ds_read_b64_tr_b16 v[12:13], v5 offset:50720
    v_mfma_f32_16x16x32_bf16 v[36:39], v[16:19], v[180:183], v[36:39]
    ds_read_b64_tr_b16 v[14:15], v5 offset:50848
    s_waitcnt lgkmcnt(8)
    v_mfma_f32_16x16x32_bf16 v[40:43], v[20:23], v[176:179], v[40:43]
    ds_read_b64_tr_b16 v[16:17], v5 offset:50752
    v_mfma_f32_16x16x32_bf16 v[44:47], v[20:23], v[180:183], v[44:47]
    ds_read_b64_tr_b16 v[18:19], v5 offset:50880
    s_waitcnt lgkmcnt(8)
    v_mfma_f32_16x16x32_bf16 v[48:51], v[24:27], v[176:179], v[48:51]
    ds_read_b64_tr_b16 v[20:21], v5 offset:50784
    v_mfma_f32_16x16x32_bf16 v[52:55], v[24:27], v[180:183], v[52:55]
    ds_read_b64_tr_b16 v[22:23], v5 offset:50912
    s_waitcnt lgkmcnt(8)
    v_mfma_f32_16x16x32_bf16 v[56:59], v[28:31], v[176:179], v[56:59]
    ds_read_b64_tr_b16 v[24:25], v2 offset:0
    v_mfma_f32_16x16x32_bf16 v[60:63], v[28:31], v[180:183], v[60:63]
    ds_read_b64_tr_b16 v[26:27], v2 offset:128
    s_waitcnt lgkmcnt(8)
    v_mfma_f32_16x16x32_bf16 v[32:35], v[8:11], v[184:187], v[32:35]
    ds_read_b64_tr_b16 v[28:29], v2 offset:32
    v_mfma_f32_16x16x32_bf16 v[36:39], v[8:11], v[188:191], v[36:39]
    ds_read_b64_tr_b16 v[30:31], v2 offset:160
    s_waitcnt lgkmcnt(8)
    v_mfma_f32_16x16x32_bf16 v[40:43], v[12:15], v[184:187], v[40:43]
    ds_read_b64_tr_b16 v[8:9], v2 offset:64
    v_mfma_f32_16x16x32_bf16 v[44:47], v[12:15], v[188:191], v[44:47]
    ds_read_b64_tr_b16 v[10:11], v2 offset:192
    s_waitcnt lgkmcnt(8)
    v_mfma_f32_16x16x32_bf16 v[48:51], v[16:19], v[184:187], v[48:51]
    ds_read_b64_tr_b16 v[12:13], v2 offset:96
    v_mfma_f32_16x16x32_bf16 v[52:55], v[16:19], v[188:191], v[52:55]
    ds_read_b64_tr_b16 v[14:15], v2 offset:224
    s_waitcnt lgkmcnt(8)
    v_mfma_f32_16x16x32_bf16 v[56:59], v[20:23], v[184:187], v[56:59]
    ds_read_b64_tr_b16 v[16:17], v2 offset:256
    v_mfma_f32_16x16x32_bf16 v[60:63], v[20:23], v[188:191], v[60:63]
    ds_read_b64_tr_b16 v[18:19], v2 offset:384
    s_waitcnt lgkmcnt(8)
    v_mfma_f32_16x16x32_bf16 v[32:35], v[24:27], v[192:195], v[32:35]
    ds_read_b64_tr_b16 v[20:21], v2 offset:288
    v_mfma_f32_16x16x32_bf16 v[36:39], v[24:27], v[196:199], v[36:39]
    ds_read_b64_tr_b16 v[22:23], v2 offset:416
    s_waitcnt lgkmcnt(8)
    v_mfma_f32_16x16x32_bf16 v[40:43], v[28:31], v[192:195], v[40:43]
    ds_read_b64_tr_b16 v[24:25], v2 offset:320
    v_mfma_f32_16x16x32_bf16 v[44:47], v[28:31], v[196:199], v[44:47]
    ds_read_b64_tr_b16 v[26:27], v2 offset:448
    s_waitcnt lgkmcnt(8)
    v_mfma_f32_16x16x32_bf16 v[48:51], v[8:11], v[192:195], v[48:51]
    ds_read_b64_tr_b16 v[28:29], v2 offset:352
    v_mfma_f32_16x16x32_bf16 v[52:55], v[8:11], v[196:199], v[52:55]
    ds_read_b64_tr_b16 v[30:31], v2 offset:480
    s_waitcnt lgkmcnt(8)
    v_mfma_f32_16x16x32_bf16 v[56:59], v[12:15], v[192:195], v[56:59]
    ds_read_b64_tr_b16 v[8:9], v2 offset:512
    v_mfma_f32_16x16x32_bf16 v[60:63], v[12:15], v[196:199], v[60:63]
    ds_read_b64_tr_b16 v[10:11], v2 offset:640
    s_waitcnt lgkmcnt(8)
    v_mfma_f32_16x16x32_bf16 v[32:35], v[16:19], v[200:203], v[32:35]
    ds_read_b64_tr_b16 v[12:13], v2 offset:544
    v_mfma_f32_16x16x32_bf16 v[36:39], v[16:19], v[204:207], v[36:39]
    ds_read_b64_tr_b16 v[14:15], v2 offset:672
    s_waitcnt lgkmcnt(8)
    v_mfma_f32_16x16x32_bf16 v[40:43], v[20:23], v[200:203], v[40:43]
    ds_read_b64_tr_b16 v[16:17], v2 offset:576
    v_mfma_f32_16x16x32_bf16 v[44:47], v[20:23], v[204:207], v[44:47]
    ds_read_b64_tr_b16 v[18:19], v2 offset:704
    s_waitcnt lgkmcnt(8)
    v_mfma_f32_16x16x32_bf16 v[48:51], v[24:27], v[200:203], v[48:51]
    ds_read_b64_tr_b16 v[20:21], v2 offset:608
    v_mfma_f32_16x16x32_bf16 v[52:55], v[24:27], v[204:207], v[52:55]
    ds_read_b64_tr_b16 v[22:23], v2 offset:736
    s_waitcnt lgkmcnt(8)
    v_mfma_f32_16x16x32_bf16 v[56:59], v[28:31], v[200:203], v[56:59]
    ds_read_b64_tr_b16 v[24:25], v2 offset:768
    v_mfma_f32_16x16x32_bf16 v[60:63], v[28:31], v[204:207], v[60:63]
    ds_read_b64_tr_b16 v[26:27], v2 offset:896
    s_waitcnt lgkmcnt(8)
    v_mfma_f32_16x16x32_bf16 v[32:35], v[8:11], v[208:211], v[32:35]
    ds_read_b64_tr_b16 v[28:29], v2 offset:800
    v_mfma_f32_16x16x32_bf16 v[36:39], v[8:11], v[212:215], v[36:39]
    ds_read_b64_tr_b16 v[30:31], v2 offset:928
    s_waitcnt lgkmcnt(8)
    v_mfma_f32_16x16x32_bf16 v[40:43], v[12:15], v[208:211], v[40:43]
    ds_read_b64_tr_b16 v[8:9], v2 offset:832
    v_mfma_f32_16x16x32_bf16 v[44:47], v[12:15], v[212:215], v[44:47]
    ds_read_b64_tr_b16 v[10:11], v2 offset:960
    s_waitcnt lgkmcnt(8)
    v_mfma_f32_16x16x32_bf16 v[48:51], v[16:19], v[208:211], v[48:51]
    ds_read_b64_tr_b16 v[12:13], v2 offset:864
    v_mfma_f32_16x16x32_bf16 v[52:55], v[16:19], v[212:215], v[52:55]
    ds_read_b64_tr_b16 v[14:15], v2 offset:992
    s_waitcnt lgkmcnt(8)
    v_mfma_f32_16x16x32_bf16 v[56:59], v[20:23], v[208:211], v[56:59]
    s_waitcnt vmcnt(0)
    s_barrier
    ds_read_b64_tr_b16 v[16:17], v4 offset:0
    v_mfma_f32_16x16x32_bf16 v[60:63], v[20:23], v[212:215], v[60:63]
    ds_read_b64_tr_b16 v[18:19], v4 offset:128
    s_waitcnt lgkmcnt(8)
    v_mfma_f32_16x16x32_bf16 v[32:35], v[24:27], v[216:219], v[32:35]
    ds_read_b64_tr_b16 v[20:21], v4 offset:32
    v_mfma_f32_16x16x32_bf16 v[36:39], v[24:27], v[220:223], v[36:39]
    ds_read_b64_tr_b16 v[22:23], v4 offset:160
    s_waitcnt lgkmcnt(8)
    v_mfma_f32_16x16x32_bf16 v[40:43], v[28:31], v[216:219], v[40:43]
    ds_read_b64_tr_b16 v[24:25], v4 offset:64
    v_mfma_f32_16x16x32_bf16 v[44:47], v[28:31], v[220:223], v[44:47]
    ds_read_b64_tr_b16 v[26:27], v4 offset:192
    s_waitcnt lgkmcnt(8)
    v_mfma_f32_16x16x32_bf16 v[48:51], v[8:11], v[216:219], v[48:51]
    ds_read_b64_tr_b16 v[28:29], v4 offset:96
    v_mfma_f32_16x16x32_bf16 v[52:55], v[8:11], v[220:223], v[52:55]
    ds_read_b64_tr_b16 v[30:31], v4 offset:224
    s_waitcnt lgkmcnt(8)
    v_mfma_f32_16x16x32_bf16 v[56:59], v[12:15], v[216:219], v[56:59]
    ds_read_b64_tr_b16 v[8:9], v4 offset:256
    v_mfma_f32_16x16x32_bf16 v[60:63], v[12:15], v[220:223], v[60:63]
    ds_read_b64_tr_b16 v[10:11], v4 offset:384
    s_waitcnt lgkmcnt(8)
    v_mfma_f32_16x16x32_bf16 v[32:35], v[16:19], v[224:227], v[32:35]
    ds_read_b64_tr_b16 v[12:13], v4 offset:288
    v_mfma_f32_16x16x32_bf16 v[36:39], v[16:19], v[228:231], v[36:39]
    ds_read_b64_tr_b16 v[14:15], v4 offset:416
    s_waitcnt lgkmcnt(8)
    v_mfma_f32_16x16x32_bf16 v[40:43], v[20:23], v[224:227], v[40:43]
    ds_read_b64_tr_b16 v[16:17], v4 offset:320
    v_mfma_f32_16x16x32_bf16 v[44:47], v[20:23], v[228:231], v[44:47]
    ds_read_b64_tr_b16 v[18:19], v4 offset:448
    s_waitcnt lgkmcnt(8)
    v_mfma_f32_16x16x32_bf16 v[48:51], v[24:27], v[224:227], v[48:51]
    ds_read_b64_tr_b16 v[20:21], v4 offset:352
    v_mfma_f32_16x16x32_bf16 v[52:55], v[24:27], v[228:231], v[52:55]
    ds_read_b64_tr_b16 v[22:23], v4 offset:480
    s_waitcnt lgkmcnt(8)
    v_mfma_f32_16x16x32_bf16 v[56:59], v[28:31], v[224:227], v[56:59]
    ds_read_b64_tr_b16 v[24:25], v4 offset:512
    v_mfma_f32_16x16x32_bf16 v[60:63], v[28:31], v[228:231], v[60:63]
    ds_read_b64_tr_b16 v[26:27], v4 offset:640
    s_waitcnt lgkmcnt(8)
    v_mfma_f32_16x16x32_bf16 v[32:35], v[8:11], v[232:235], v[32:35]
    ds_read_b64_tr_b16 v[28:29], v4 offset:544
    v_mfma_f32_16x16x32_bf16 v[36:39], v[8:11], v[236:239], v[36:39]
    ds_read_b64_tr_b16 v[30:31], v4 offset:672
    s_waitcnt lgkmcnt(8)
    v_mfma_f32_16x16x32_bf16 v[40:43], v[12:15], v[232:235], v[40:43]
    ds_read_b64_tr_b16 v[8:9], v4 offset:576
    v_mfma_f32_16x16x32_bf16 v[44:47], v[12:15], v[236:239], v[44:47]
    ds_read_b64_tr_b16 v[10:11], v4 offset:704
    s_waitcnt lgkmcnt(8)
    v_mfma_f32_16x16x32_bf16 v[48:51], v[16:19], v[232:235], v[48:51]
    ds_read_b64_tr_b16 v[12:13], v4 offset:608
    v_mfma_f32_16x16x32_bf16 v[52:55], v[16:19], v[236:239], v[52:55]
    ds_read_b64_tr_b16 v[14:15], v4 offset:736
    s_waitcnt lgkmcnt(8)
    v_mfma_f32_16x16x32_bf16 v[56:59], v[20:23], v[232:235], v[56:59]
    ds_read_b64_tr_b16 v[16:17], v4 offset:768
    v_mfma_f32_16x16x32_bf16 v[60:63], v[20:23], v[236:239], v[60:63]
    ds_read_b64_tr_b16 v[18:19], v4 offset:896
    s_waitcnt lgkmcnt(8)
    v_mfma_f32_16x16x32_bf16 v[32:35], v[24:27], v[240:243], v[32:35]
    ds_read_b64_tr_b16 v[20:21], v4 offset:800
    v_mfma_f32_16x16x32_bf16 v[36:39], v[24:27], v[244:247], v[36:39]
    ds_read_b64_tr_b16 v[22:23], v4 offset:928
    s_waitcnt lgkmcnt(8)
    v_mfma_f32_16x16x32_bf16 v[40:43], v[28:31], v[240:243], v[40:43]
    ds_read_b64_tr_b16 v[24:25], v4 offset:832
    v_mfma_f32_16x16x32_bf16 v[44:47], v[28:31], v[244:247], v[44:47]
    ds_read_b64_tr_b16 v[26:27], v4 offset:960
    s_waitcnt lgkmcnt(8)
    v_mfma_f32_16x16x32_bf16 v[48:51], v[8:11], v[240:243], v[48:51]
    ds_read_b64_tr_b16 v[28:29], v4 offset:864
    v_mfma_f32_16x16x32_bf16 v[52:55], v[8:11], v[244:247], v[52:55]
    ds_read_b64_tr_b16 v[30:31], v4 offset:992
    s_waitcnt lgkmcnt(8)
    v_mfma_f32_16x16x32_bf16 v[56:59], v[12:15], v[240:243], v[56:59]
    s_barrier
    v_mfma_f32_16x16x32_bf16 v[60:63], v[12:15], v[244:247], v[60:63]
    s_waitcnt lgkmcnt(6)
    v_mfma_f32_16x16x32_bf16 v[32:35], v[16:19], v[248:251], v[32:35]
    v_mfma_f32_16x16x32_bf16 v[36:39], v[16:19], v[252:255], v[36:39]
    s_waitcnt lgkmcnt(4)
    v_mfma_f32_16x16x32_bf16 v[40:43], v[20:23], v[248:251], v[40:43]
    v_mfma_f32_16x16x32_bf16 v[44:47], v[20:23], v[252:255], v[44:47]
    s_waitcnt lgkmcnt(2)
    v_mfma_f32_16x16x32_bf16 v[48:51], v[24:27], v[248:251], v[48:51]
    v_mfma_f32_16x16x32_bf16 v[52:55], v[24:27], v[252:255], v[52:55]
    s_waitcnt lgkmcnt(0)
    v_mfma_f32_16x16x32_bf16 v[56:59], v[28:31], v[248:251], v[56:59]
    v_mfma_f32_16x16x32_bf16 v[60:63], v[28:31], v[252:255], v[60:63]
    s_setprio 2
    v_and_b32 v7, 1, v0
    v_lshlrev_b32 v7, 7, v7
    s_add_u32 s3, s81, 8192
    buffer_load_dwordx2 v[100:101], v7, s[8:11], s3 offen sc1
    v_mul_f32 v32, s0, v32
    v_mul_f32 v33, s0, v33
    v_mul_f32 v34, s0, v34
    v_mul_f32 v35, s0, v35
    v_mul_f32 v36, s0, v36
    v_mul_f32 v37, s0, v37
    v_mul_f32 v38, s0, v38
    v_mul_f32 v39, s0, v39
    v_cvt_pk_bf16_f32 v32, v32, v33
    v_cvt_pk_bf16_f32 v33, v34, v35
    v_cvt_pk_bf16_f32 v34, v36, v37
    v_cvt_pk_bf16_f32 v35, v38, v39
    v_mul_f32 v40, s0, v40
    v_mul_f32 v41, s0, v41
    v_mul_f32 v42, s0, v42
    v_mul_f32 v43, s0, v43
    v_mul_f32 v44, s0, v44
    v_mul_f32 v45, s0, v45
    v_mul_f32 v46, s0, v46
    v_mul_f32 v47, s0, v47
    v_permlane16_swap_b32 v32, v34
    v_permlane16_swap_b32 v33, v35
    v_cvt_pk_bf16_f32 v40, v40, v41
    v_cvt_pk_bf16_f32 v41, v42, v43
    s_add_u32 s3, s27, 7864320
    buffer_store_dwordx4 v[32:35], v1, s[8:11], s3 offen sc1
    s_barrier
    v_cvt_pk_bf16_f32 v42, v44, v45
    v_cvt_pk_bf16_f32 v43, v46, v47
    v_mul_f32 v48, s0, v48
    v_mul_f32 v49, s0, v49
    v_mul_f32 v50, s0, v50
    v_mul_f32 v51, s0, v51
    v_mul_f32 v52, s0, v52
    v_mul_f32 v53, s0, v53
    v_mul_f32 v54, s0, v54
    v_mul_f32 v55, s0, v55
    v_permlane16_swap_b32 v40, v42
    v_permlane16_swap_b32 v41, v43
    v_cvt_pk_bf16_f32 v48, v48, v49
    v_cvt_pk_bf16_f32 v49, v50, v51
    s_add_u32 s3, s27, 7868416
    buffer_store_dwordx4 v[40:43], v1, s[8:11], s3 offen sc1
    v_cvt_pk_bf16_f32 v50, v52, v53
    v_cvt_pk_bf16_f32 v51, v54, v55
    v_mul_f32 v56, s0, v56
    v_mul_f32 v57, s0, v57
    v_mul_f32 v58, s0, v58
    v_mul_f32 v59, s0, v59
    v_mul_f32 v60, s0, v60
    v_mul_f32 v61, s0, v61
    v_mul_f32 v62, s0, v62
    v_mul_f32 v63, s0, v63
    v_permlane16_swap_b32 v48, v50
    v_permlane16_swap_b32 v49, v51
    v_cvt_pk_bf16_f32 v56, v56, v57
    v_cvt_pk_bf16_f32 v57, v58, v59
    s_add_u32 s3, s27, 7872512
    buffer_store_dwordx4 v[48:51], v1, s[8:11], s3 offen sc1
    v_cvt_pk_bf16_f32 v58, v60, v61
    v_cvt_pk_bf16_f32 v59, v62, v63
    s_nop 0
    v_permlane16_swap_b32 v56, v58
    v_permlane16_swap_b32 v57, v59
    s_add_u32 s3, s27, 7876608
    buffer_store_dwordx4 v[56:59], v1, s[8:11], s3 offen sc1
    v_lshlrev_b32 v1, 4, v0
    s_waitcnt vmcnt(4)
    v_cmp_ne_u64 vcc, v[100:101], v[94:95]
    s_nop 1
    s_or_b32 s82, vcc_lo, vcc_hi
    v_mov_b32 v8, v64
    v_mov_b32 v9, v65
    v_mov_b32 v10, v66
    v_mov_b32 v11, v67
    v_mov_b32 v12, v68
    v_mov_b32 v13, v69
    v_mov_b32 v14, v70
    v_mov_b32 v15, v71
    v_mov_b32 v28, v72
    v_mov_b32 v29, v73
    v_mov_b32 v30, v74
    v_mov_b32 v31, v75
    v_mov_b32 v32, v76
    v_mov_b32 v33, v77
    v_mov_b32 v34, v78
    v_mov_b32 v35, v79
    v_mov_b32 v36, v80
    v_mov_b32 v37, v81
    v_mov_b32 v38, v82
    v_mov_b32 v39, v83
    s_mul_i32 s4, s21, 4088
    s_add_u32 s4, s4, 20967424
    s_lshl_b32 s5, s22, 9
    s_add_u32 s23, s5, s4
    s_mov_b32 s25, 1
    s_lshl_b32 s5, s16, 3
    s_add_u32 s5, s5, s90
    s_mul_i32 s5, s5, 25600
    s_add_u32 s24, s5, 21577728
    v_mov_b32 v2, v94
    v_mov_b32 v3, v95
    v_mov_b32 v4, v2
    v_mov_b32 v5, v3
    s_mov_b64 exec, 0xf33ffff
    buffer_load_dwordx2 v[4:5], v92, s[8:11], 0 offen sc1
    s_mov_b64 exec, -1
    buffer_load_dwordx4 v[156:159], v1, s[8:11], s24 offen offset:0 sc1
    buffer_load_dwordx4 v[160:163], v1, s[8:11], s24 offen offset:1024 sc1
    buffer_load_dwordx4 v[164:167], v1, s[8:11], s24 offen offset:2048 sc1
    buffer_load_dwordx4 v[168:171], v1, s[8:11], s24 offen offset:3072 sc1
.Lktail_3:
    s_lshl_b32 s3, s19, 1
    s_add_u32 s3, s3, s91
    s_cmp_lt_u32 s3, 2
    s_cselect_b32 s3, 0x40000000, 0
    v_add_u32 v102, s3, v1
    v_add_u32 v93, s3, v93
    s_cmp_lg_u32 s19, 0
    s_cselect_b32 s3, 0x3f803f80, 0
    v_mov_b32 v120, s3
    v_mov_b32 v121, s3
    v_mov_b32 v122, s3
    v_mov_b32 v123, s3
    s_add_u32 s3, s98, 145664
    v_add_u32 v7, s3, v1
    ds_write_b128 v7, v[120:123]
    s_waitcnt vmcnt(4)
    v_cmp_ne_u64 vcc, v[4:5], v[2:3]
    s_nop 1
    s_cbranch_vccz .Lpok_11
    s_mov_b32 s3, 131072
.Lpsp_12:
    s_nop 0
    s_mov_b64 exec, vcc
    buffer_load_dwordx2 v[4:5], v92, s[8:11], 0 offen sc1
    s_mov_b64 exec, -1
    s_sub_u32 s3, s3, 1
    s_waitcnt vmcnt(0)
    s_cbranch_scc1 .Lpok_11
    v_cmp_ne_u64 vcc, v[4:5], v[2:3]
    s_nop 1
    s_cbranch_vccnz .Lpsp_12
.Lpok_11:
    s_setprio 3
    buffer_load_dwordx4 v[104:107], v1, s[8:11], s95 offen offset:0 sc1
    buffer_load_dwordx4 v[108:111], v1, s[8:11], s95 offen offset:2048 sc1
    buffer_load_dwordx4 v[112:115], v1, s[8:11], s96 offen sc1
    s_add_u32 m0, s97, 99840
    s_add_u32 s3, s93, 163840
    buffer_load_dwordx4 v102, s[8:11], s3 offen offset:0 sc1 lds
    buffer_load_dwordx4 v102, s[8:11], s3 offen offset:1024 sc1 lds
    s_add_u32 m0, s97, 108032
    s_add_u32 s3, s93, 165888
    buffer_load_dwordx4 v102, s[8:11], s3 offen offset:0 sc1 lds
    buffer_load_dwordx4 v102, s[8:11], s3 offen offset:1024 sc1 lds
    s_add_u32 m0, s98, 116224
    s_add_u32 s3, s94, 163840
    buffer_load_dword v93, s[8:11], s3 offen offset:0 sc1 lds
    s_add_u32 m0, s98, 116480
    s_add_u32 s3, s94, 164352
    buffer_load_dword v93, s[8:11], s3 offen offset:0 sc1 lds
    s_add_u32 m0, s98, 116736
    s_add_u32 s3, s94, 164864
    buffer_load_dword v93, s[8:11], s3 offen offset:0 sc1 lds
    s_add_u32 m0, s98, 116992
    s_add_u32 s3, s94, 165376
    buffer_load_dword v93, s[8:11], s3 offen offset:0 sc1 lds
    s_setprio 2
    s_add_u32 m0, s97, 120384
    s_add_u32 s3, s92, 327680
    buffer_load_dwordx4 v102, s[8:11], s3 offen offset:0 sc1 lds
    buffer_load_dwordx4 v102, s[8:11], s3 offen offset:1024 sc1 lds
    s_add_u32 m0, s97, 128640
    s_add_u32 s3, s92, 329728
    buffer_load_dwordx4 v102, s[8:11], s3 offen offset:0 sc1 lds
    buffer_load_dwordx4 v102, s[8:11], s3 offen offset:1024 sc1 lds
    s_add_u32 m0, s97, 136896
    s_add_u32 s3, s92, 331776
    buffer_load_dwordx4 v102, s[8:11], s3 offen offset:0 sc1 lds
    buffer_load_dwordx4 v102, s[8:11], s3 offen offset:1024 sc1 lds
    s_add_u32 s3, s98, 0
    v_add_u32 v7, s3, v1
    s_mov_b32 s3, 0x3ea52b5c
    s_waitcnt vmcnt(16)
    v_lshlrev_b32 v116, 16, v104
    v_lshlrev_b32 v117, 16, v105
    v_lshlrev_b32 v118, 16, v106
    v_lshlrev_b32 v119, 16, v107
    v_and_b32 v104, 0xffff0000, v104
    v_and_b32 v105, 0xffff0000, v105
    v_and_b32 v106, 0xffff0000, v106
    v_and_b32 v107, 0xffff0000, v107
    v_mul_f32 v116, s3, v116
    v_mul_f32 v117, s3, v117
    v_mul_f32 v118, s3, v118
    v_mul_f32 v119, s3, v119
    v_mul_f32 v104, s3, v104
    v_mul_f32 v105, s3, v105
    v_mul_f32 v106, s3, v106
    v_mul_f32 v107, s3, v107
    v_cvt_pk_bf16_f32 v104, v116, v104
    v_cvt_pk_bf16_f32 v105, v117, v105
    v_cvt_pk_bf16_f32 v106, v118, v106
    v_cvt_pk_bf16_f32 v107, v119, v107
    ds_write_b128 v7, v[104:107] offset:0
    s_waitcnt vmcnt(15)
    v_lshlrev_b32 v116, 16, v108
    v_lshlrev_b32 v117, 16, v109
    v_lshlrev_b32 v118, 16, v110
    v_lshlrev_b32 v119, 16, v111
    v_and_b32 v108, 0xffff0000, v108
    v_and_b32 v109, 0xffff0000, v109
    v_and_b32 v110, 0xffff0000, v110
    v_and_b32 v111, 0xffff0000, v111
    v_mul_f32 v116, s3, v116
    v_mul_f32 v117, s3, v117
    v_mul_f32 v118, s3, v118
    v_mul_f32 v119, s3, v119
    v_mul_f32 v108, s3, v108
    v_mul_f32 v109, s3, v109
    v_mul_f32 v110, s3, v110
    v_mul_f32 v111, s3, v111
    v_cvt_pk_bf16_f32 v108, v116, v108
    v_cvt_pk_bf16_f32 v109, v117, v109
    v_cvt_pk_bf16_f32 v110, v118, v110
    v_cvt_pk_bf16_f32 v111, v119, v111
    ds_write_b128 v7, v[108:111] offset:4096
    s_waitcnt vmcnt(14)
    v_lshlrev_b32 v116, 16, v112
    v_lshlrev_b32 v117, 16, v113
    v_lshlrev_b32 v118, 16, v114
    v_lshlrev_b32 v119, 16, v115
    v_and_b32 v112, 0xffff0000, v112
    v_and_b32 v113, 0xffff0000, v113
    v_and_b32 v114, 0xffff0000, v114
    v_and_b32 v115, 0xffff0000, v115
    v_mul_f32 v116, s3, v116
    v_mul_f32 v117, s3, v117
    v_mul_f32 v118, s3, v118
    v_mul_f32 v119, s3, v119
    v_mul_f32 v112, s3, v112
    v_mul_f32 v113, s3, v113
    v_mul_f32 v114, s3, v114
    v_mul_f32 v115, s3, v115
    v_cvt_pk_bf16_f32 v112, v116, v112
    v_cvt_pk_bf16_f32 v113, v117, v113
    v_cvt_pk_bf16_f32 v114, v118, v114
    v_cvt_pk_bf16_f32 v115, v119, v115
    ds_write_b128 v7, v[112:115] offset:8192
    s_cmp_lg_u32 s82, 0
    s_cbranch_scc1 .Lredo_13
.Lredone_14:
    s_mov_b32 s68, 0xffff
    s_mov_b32 s69, 0xffff0
    s_mov_b32 s70, 0x3fffc
    s_mov_b32 s71, 0x3fffc0
    s_mov_b32 s72, 0xffff00
    s_mov_b32 s73, 0xffff000
    s_mov_b32 s74, 0x3fffc00
    s_mov_b32 s75, 0x3fffc000
    s_mov_b32 s76, 0xffff0000
    s_mov_b32 s77, 0xfff0000f
    s_mov_b32 s78, 0xfffc0003
    s_mov_b32 s79, 0xffc0003f
    s_mov_b32 s80, 0xff0000ff
    s_mov_b32 s81, 0xf0000fff
    s_mov_b32 s82, 0xfc0003ff
    s_mov_b32 s83, 0xc0003fff
    s_waitcnt vmcnt(6) lgkmcnt(0)
    s_barrier
    s_setprio 3
    ds_read_b128 v[24:27], v10
    ds_read_b128 v[40:43], v8 offset:512
    s_mov_b32 exec_hi, 0
    ds_read_b64 v[28:29], v11
    s_mov_b32 exec_hi, -1
    ds_read_b64 v[44:45], v9 offset:256
    ds_read_b128 v[48:51], v8 offset:0
    ds_read_b64 v[52:53], v9 offset:0
    ds_read_b128 v[88:91], v8 offset:4096
    ds_read_b64 v[92:93], v9 offset:2048
    v_mov_b32_e64 v18, 0
    v_mov_b32 v19, 0
    s_waitcnt lgkmcnt(6)
    v_mfma_f32_32x32x16_bf16 v[104:119], v[40:43], v[24:27], 0
    s_waitcnt lgkmcnt(4)
    v_mfma_f32_32x32x8_bf16 v[104:119], v[44:45], v[28:29], v[104:119]
    ds_read_b128 v[40:43], v8 offset:1024
    ds_read_b64 v[44:45], v9 offset:512
    s_waitcnt lgkmcnt(2)
    v_mfma_f32_32x32x16_bf16 v[120:135], v[48:51], v[24:27], 0
    s_add_u32 s24, s24, 4096
    buffer_load_dwordx4 v[172:175], v1, s[8:11], s24 offen offset:0 sc1
    v_mfma_f32_32x32x8_bf16 v[120:135], v[52:53], v[28:29], v[120:135]
    buffer_load_dwordx4 v[176:179], v1, s[8:11], s24 offen offset:1024 sc1
    v_mfma_f32_32x32x16_bf16 v[136:151], v[88:91], v[24:27], 0
    s_nop 2
    v_exp_f32 v104, v104
    v_exp_f32 v105, v105
    v_exp_f32 v106, v106
    v_exp_f32_e64 v107, v107
    v_mfma_f32_32x32x8_bf16 v[136:151], v[92:93], v[28:29], v[136:151]
    v_exp_f32 v108, v108
    v_exp_f32 v109, v109
    v_exp_f32 v110, v110
    v_exp_f32 v111, v111
    v_cvt_pk_bf16_f32 v80, v104, v105
    v_cvt_pk_bf16_f32 v81, v106, v107
    v_exp_f32 v112, v112
    v_exp_f32 v113, v113
    v_exp_f32 v114, v114
    v_exp_f32 v115, v115
    v_cvt_pk_bf16_f32 v82, v108, v109
    v_cvt_pk_bf16_f32 v83, v110, v111
    v_exp_f32 v116, v116
    v_exp_f32 v117, v117
    v_exp_f32 v118, v118
    v_exp_f32 v119, v119
    v_cvt_pk_bf16_f32 v84, v112, v113
    v_cvt_pk_bf16_f32 v85, v114, v115
    v_cvt_pk_bf16_f32 v86, v116, v117
    v_cvt_pk_bf16_f32 v87, v118, v119
    buffer_load_dwordx4 v[180:183], v1, s[8:11], s24 offen offset:2048 sc1
    s_waitcnt lgkmcnt(0)
    s_waitcnt vmcnt(3)
    s_barrier
    v_mfma_f32_32x32x16_bf16 v[104:119], v[40:43], v[24:27], 0
    ds_read_b64_tr_b16 v[64:65], v13 offset:512
    ds_read_b64_tr_b16 v[66:67], v13 offset:640
    ds_read_b64_tr_b16 v[68:69], v13 offset:768
    ds_read_b64_tr_b16 v[70:71], v13 offset:896
    ds_read_b64_tr_b16 v[56:57], v13 offset:4096
    ds_read_b64_tr_b16 v[58:59], v13 offset:4224
    ds_read_b64_tr_b16 v[60:61], v13 offset:4352
    ds_read_b64_tr_b16 v[62:63], v13 offset:4480
    ds_read_b128 v[48:51], v8 offset:1536
    ds_read_b64 v[52:53], v9 offset:768
    v_cndmask_b32 v136, v120, v136, s[36:37]
    v_cndmask_b32 v137, v121, v137, s[38:39]
    v_cndmask_b32 v138, v122, v138, s[40:41]
    v_cndmask_b32 v139, v123, v139, s[42:43]
    v_cndmask_b32 v140, v124, v140, s[44:45]
    v_cndmask_b32 v141, v125, v141, s[46:47]
    v_cndmask_b32 v142, v126, v142, s[48:49]
    v_cndmask_b32 v143, v127, v143, s[50:51]
    v_cndmask_b32 v144, v128, v144, s[52:53]
    v_cndmask_b32 v145, v129, v145, s[54:55]
    v_mfma_f32_32x32x8_bf16 v[104:119], v[44:45], v[28:29], v[104:119]
    v_cndmask_b32 v146, v130, v146, s[56:57]
    v_cndmask_b32 v147, v131, v147, s[58:59]
    buffer_load_dwordx4 v[184:187], v1, s[8:11], s24 offen offset:3072 sc1
    v_cndmask_b32 v148, v132, v148, s[60:61]
    v_cndmask_b32 v149, v133, v149, s[62:63]
    v_cndmask_b32 v150, v134, v150, s[64:65]
    v_cndmask_b32 v151, v135, v151, s[66:67]
    v_exp_f32 v136, v136
    v_exp_f32 v137, v137
    v_exp_f32 v138, v138
    v_exp_f32_e64 v139, v139
    v_exp_f32 v140, v140
    s_waitcnt lgkmcnt(6)
    v_mfma_f32_32x32x16_bf16 v[88:103], v[64:67], v[80:83], 0
    v_exp_f32 v141, v141
    v_exp_f32 v142, v142
    v_exp_f32 v143, v143
    v_exp_f32 v144, v144
    v_exp_f32 v145, v145
    v_exp_f32 v146, v146
    v_mfma_f32_32x32x16_bf16 v[88:103], v[68:71], v[84:87], v[88:103]
    ds_read_b64_tr_b16 v[64:65], v13 offset:0
    ds_read_b64_tr_b16 v[66:67], v13 offset:128
    ds_read_b64_tr_b16 v[68:69], v13 offset:256
    ds_read_b64_tr_b16 v[70:71], v13 offset:384
    v_exp_f32 v147, v147
    v_exp_f32 v148, v148
    v_exp_f32_e64 v149, v149
    s_add_u32 s24, s24, 4096
    buffer_load_dwordx4 v[188:191], v1, s[8:11], s24 offen offset:0 sc1
    v_exp_f32 v150, v150
    v_exp_f32 v151, v151
    v_cvt_pk_bf16_f32 v80, v136, v137
    v_cvt_pk_bf16_f32 v81, v138, v139
    v_cvt_pk_bf16_f32 v82, v140, v141
    v_cvt_pk_bf16_f32 v83, v142, v143
    v_cvt_pk_bf16_f32 v84, v144, v145
    v_cvt_pk_bf16_f32 v85, v146, v147
    v_cvt_pk_bf16_f32 v86, v148, v149
    v_cvt_pk_bf16_f32 v87, v150, v151
    v_and_b32 v72, v80, v32
    v_and_b32 v73, v81, v33
    v_and_b32 v74, v82, v34
    v_and_b32 v75, v83, v35
    v_and_b32 v76, v84, v36
    v_and_b32 v77, v85, v37
    v_and_b32 v78, v86, v38
    v_and_b32 v79, v87, v39
    v_xor_b32 v80, v80, v72
    v_xor_b32 v81, v81, v73
    v_xor_b32 v82, v82, v74
    v_xor_b32 v83, v83, v75
    v_xor_b32 v84, v84, v76
    v_xor_b32 v85, v85, v77
    buffer_load_dwordx4 v[192:195], v1, s[8:11], s24 offen offset:1024 sc1
    v_xor_b32 v86, v86, v78
    v_xor_b32 v87, v87, v79
    s_setprio 2
    s_waitcnt lgkmcnt(0)
    v_mfma_f32_32x32x16_bf16 v[88:103], v[56:59], v[72:75], v[88:103]
    ds_read_b128 v[40:43], v8 offset:2048
    ds_read_b64 v[44:45], v9 offset:1024
    v_exp_f32 v104, v104
    v_exp_f32 v105, v105
    v_exp_f32_e64 v106, v106
    v_mfma_f32_32x32x16_bf16 v[88:103], v[60:63], v[76:79], v[88:103]
    ds_read_b64_tr_b16 v[56:57], v13 offset:1024
    ds_read_b64_tr_b16 v[58:59], v13 offset:1152
    ds_read_b64_tr_b16 v[60:61], v13 offset:1280
    ds_read_b64_tr_b16 v[62:63], v13 offset:1408
    v_exp_f32_e64 v107, v107
    buffer_load_dwordx4 v[196:199], v1, s[8:11], s24 offen offset:2048 sc1
    v_exp_f32 v108, v108
    v_exp_f32 v109, v109
    v_mfma_f32_32x32x16_bf16 v[120:135], v[48:51], v[24:27], 0
    v_exp_f32 v110, v110
    v_exp_f32 v111, v111
    v_exp_f32_e64 v112, v112
    v_mfma_f32_32x32x8_bf16 v[120:135], v[52:53], v[28:29], v[120:135]
    v_exp_f32 v113, v113
    v_exp_f32 v114, v114
    v_exp_f32_e64 v115, v115
    v_mfma_f32_32x32x16_bf16 v[88:103], v[64:67], v[80:83], v[88:103]
    v_exp_f32_e64 v116, v116
    buffer_load_dwordx4 v[200:203], v1, s[8:11], s24 offen offset:3072 sc1
    v_exp_f32 v117, v117
    v_exp_f32 v118, v118
    v_exp_f32_e64 v119, v119
    v_mfma_f32_32x32x16_bf16 v[88:103], v[68:71], v[84:87], v[88:103]
    v_cvt_pk_bf16_f32 v72, v104, v105
    v_cvt_pk_bf16_f32 v73, v106, v107
    v_cvt_pk_bf16_f32 v74, v108, v109
    v_cvt_pk_bf16_f32 v75, v110, v111
    v_cvt_pk_bf16_f32 v76, v112, v113
    v_cvt_pk_bf16_f32 v77, v114, v115
    v_cvt_pk_bf16_f32 v78, v116, v117
    v_cvt_pk_bf16_f32 v79, v118, v119
    s_add_u32 s24, s24, 4096
    buffer_load_dwordx4 v[204:207], v1, s[8:11], s24 offen offset:0 sc1
    s_waitcnt lgkmcnt(0)
    v_mfma_f32_32x32x16_bf16 v[104:119], v[40:43], v[24:27], 0
    ds_read_b128 v[48:51], v8 offset:2560
    ds_read_b64 v[52:53], v9 offset:1280
    ds_read_b64_tr_b16 v[64:65], v13 offset:1536
    ds_read_b64_tr_b16 v[66:67], v13 offset:1664
    ds_read_b64_tr_b16 v[68:69], v13 offset:1792
    ds_read_b64_tr_b16 v[70:71], v13 offset:1920
    v_exp_f32 v120, v120
    v_exp_f32 v121, v121
    v_exp_f32 v122, v122
    v_exp_f32_e64 v123, v123
    v_mfma_f32_32x32x16_bf16 v[88:103], v[56:59], v[72:75], v[88:103]
    v_exp_f32 v124, v124
    v_exp_f32 v125, v125
    v_exp_f32 v126, v126
    v_exp_f32 v127, v127
    v_cvt_pk_bf16_f32 v80, v120, v121
    buffer_load_dwordx4 v[208:211], v1, s[8:11], s24 offen offset:1024 sc1
    v_cvt_pk_bf16_f32 v81, v122, v123
    v_mfma_f32_32x32x8_bf16 v[104:119], v[44:45], v[28:29], v[104:119]
    v_exp_f32 v128, v128
    v_exp_f32 v129, v129
    v_exp_f32 v130, v130
    v_exp_f32 v131, v131
    v_cvt_pk_bf16_f32 v82, v124, v125
    v_cvt_pk_bf16_f32 v83, v126, v127
    v_mfma_f32_32x32x16_bf16 v[88:103], v[60:63], v[76:79], v[88:103]
    v_exp_f32 v132, v132
    v_exp_f32 v133, v133
    v_exp_f32 v134, v134
    v_exp_f32 v135, v135
    v_cvt_pk_bf16_f32 v84, v128, v129
    v_cvt_pk_bf16_f32 v85, v130, v131
    v_cvt_pk_bf16_f32 v86, v132, v133
    v_cvt_pk_bf16_f32 v87, v134, v135
    buffer_load_dwordx4 v[212:215], v1, s[8:11], s24 offen offset:2048 sc1
    buffer_load_dwordx4 v[20:23], v31, s[8:11], s23 offen sc1
    v_mov_b32 v4, v2
    v_mov_b32 v5, v3
    s_mov_b64 exec, 0x1ff5
    buffer_load_dwordx2 v[4:5], v12, s[8:11], 0 offen sc1
    s_mov_b64 exec, -1
    s_waitcnt lgkmcnt(0)
    v_mfma_f32_32x32x16_bf16 v[120:135], v[48:51], v[24:27], 0
    ds_read_b128 v[40:43], v8 offset:3072
    ds_read_b64 v[44:45], v9 offset:1536
    ds_read_b64_tr_b16 v[56:57], v13 offset:2048
    ds_read_b64_tr_b16 v[58:59], v13 offset:2176
    ds_read_b64_tr_b16 v[60:61], v13 offset:2304
    ds_read_b64_tr_b16 v[62:63], v13 offset:2432
    v_exp_f32 v104, v104
    v_exp_f32 v105, v105
    v_exp_f32 v106, v106
    v_exp_f32 v107, v107
    v_mfma_f32_32x32x16_bf16 v[88:103], v[64:67], v[80:83], v[88:103]
    v_exp_f32 v108, v108
    v_exp_f32 v109, v109
    v_exp_f32 v110, v110
    v_exp_f32 v111, v111
    v_cvt_pk_bf16_f32 v72, v104, v105
    buffer_load_dwordx4 v[216:219], v1, s[8:11], s24 offen offset:3072 sc1
    v_cvt_pk_bf16_f32 v73, v106, v107
    v_mfma_f32_32x32x8_bf16 v[120:135], v[52:53], v[28:29], v[120:135]
    v_exp_f32 v112, v112
    v_exp_f32 v113, v113
    v_exp_f32 v114, v114
    v_exp_f32 v115, v115
    v_cvt_pk_bf16_f32 v74, v108, v109
    v_cvt_pk_bf16_f32 v75, v110, v111
    v_mfma_f32_32x32x16_bf16 v[88:103], v[68:71], v[84:87], v[88:103]
    v_exp_f32 v116, v116
    v_exp_f32 v117, v117
    v_exp_f32 v118, v118
    v_exp_f32 v119, v119
    v_cvt_pk_bf16_f32 v76, v112, v113
    v_cvt_pk_bf16_f32 v77, v114, v115
    v_cvt_pk_bf16_f32 v78, v116, v117
    v_cvt_pk_bf16_f32 v79, v118, v119
    s_add_u32 s24, s24, 4096
    buffer_load_dwordx4 v[220:223], v1, s[8:11], s24 offen offset:0 sc1
    s_waitcnt vmcnt(2)
    v_cmp_ne_u64 vcc, v[4:5], v[2:3]
    s_nop 1
    s_cbranch_vccnz .Lchance_17
    s_mov_b32 s25, 0
    s_add_u32 s5, s28, 163840
    s_add_u32 s6, s29, 163840
    buffer_load_dwordx4 v[152:155], v30, s[8:11], s28 offen sc1
    s_mov_b32 exec_hi, 0
    buffer_load_dwordx2 v[18:19], v31, s[8:11], s28 offen sc1
    s_mov_b32 exec_hi, -1
    buffer_load_dwordx4 v[144:147], v30, s[8:11], s5 offen sc1
    buffer_load_dwordx2 v[148:149], v31, s[8:11], s5 offen sc1
    s_mov_b32 exec_lo, 0xffff0000
    s_mov_b32 exec_hi, 0xffff0000
    buffer_load_dwordx4 v[136:139], v30, s[8:11], s6 offen sc1
    buffer_load_dwordx2 v[140:141], v31, s[8:11], s6 offen sc1
    s_mov_b32 exec_hi, -1
    s_mul_i32 s4, s16, 3328
    s_add_u32 m0, s4, 33344
    s_add_u32 s3, s29, 327680
    buffer_load_dwordx4 v15, s[8:11], s3 offen sc1 lds
    s_add_u32 m0, s4, 34432
    s_add_u32 s3, s29, 329728
    buffer_load_dwordx4 v15, s[8:11], s3 offen sc1 lds
    s_add_u32 m0, s4, 35520
    s_add_u32 s3, s29, 331776
    buffer_load_dwordx4 v15, s[8:11], s3 offen sc1 lds
    s_mov_b32 exec_lo, -1
.Lchback_18:
    s_setprio 1
    s_waitcnt lgkmcnt(0)
    v_mfma_f32_32x32x16_bf16 v[104:119], v[40:43], v[24:27], 0
    ds_read_b128 v[48:51], v8 offset:3584
    ds_read_b64 v[52:53], v9 offset:1792
    ds_read_b64_tr_b16 v[64:65], v13 offset:2560
    ds_read_b64_tr_b16 v[66:67], v13 offset:2688
    ds_read_b64_tr_b16 v[68:69], v13 offset:2816
    ds_read_b64_tr_b16 v[70:71], v13 offset:2944
    v_exp_f32 v120, v120
    v_exp_f32 v121, v121
    v_exp_f32 v122, v122
    v_exp_f32_e64 v123, v123
    v_mfma_f32_32x32x16_bf16 v[88:103], v[56:59], v[72:75], v[88:103]
    v_exp_f32 v124, v124
    v_exp_f32 v125, v125
    v_exp_f32 v126, v126
    v_exp_f32 v127, v127
    v_cvt_pk_bf16_f32 v80, v120, v121
    v_cvt_pk_bf16_f32 v81, v122, v123
    v_mfma_f32_32x32x8_bf16 v[104:119], v[44:45], v[28:29], v[104:119]
    v_exp_f32 v128, v128
    v_exp_f32 v129, v129
    v_exp_f32 v130, v130
    v_exp_f32 v131, v131
    v_cvt_pk_bf16_f32 v82, v124, v125
    v_cvt_pk_bf16_f32 v83, v126, v127
    v_mfma_f32_32x32x16_bf16 v[88:103], v[60:63], v[76:79], v[88:103]
    v_exp_f32 v132, v132
    v_exp_f32 v133, v133
    v_exp_f32 v134, v134
    v_exp_f32 v135, v135
    v_cvt_pk_bf16_f32 v84, v128, v129
    v_cvt_pk_bf16_f32 v85, v130, v131
    v_cvt_pk_bf16_f32 v86, v132, v133
    v_cvt_pk_bf16_f32 v87, v134, v135
    s_cmp_lg_u32 s25, 0
    s_cbranch_scc1 .Lchance_19
.Lchback_20:
    s_waitcnt lgkmcnt(0)
    v_mfma_f32_32x32x16_bf16 v[120:135], v[48:51], v[24:27], 0
    ds_read_b64_tr_b16 v[56:57], v13 offset:3072
    ds_read_b64_tr_b16 v[58:59], v13 offset:3200
    ds_read_b64_tr_b16 v[60:61], v13 offset:3328
    ds_read_b64_tr_b16 v[62:63], v13 offset:3456
    v_exp_f32 v104, v104
    v_exp_f32 v105, v105
    v_exp_f32 v106, v106
    v_exp_f32_e64 v107, v107
    v_mfma_f32_32x32x16_bf16 v[88:103], v[64:67], v[80:83], v[88:103]
    v_exp_f32 v108, v108
    v_exp_f32 v109, v109
    v_exp_f32 v110, v110
    v_exp_f32 v111, v111
    v_cvt_pk_bf16_f32 v72, v104, v105
    v_cvt_pk_bf16_f32 v73, v106, v107
    v_mfma_f32_32x32x8_bf16 v[120:135], v[52:53], v[28:29], v[120:135]
    v_exp_f32 v112, v112
    v_exp_f32 v113, v113
    v_exp_f32 v114, v114
    v_exp_f32 v115, v115
    v_cvt_pk_bf16_f32 v74, v108, v109
    v_cvt_pk_bf16_f32 v75, v110, v111
    v_mfma_f32_32x32x16_bf16 v[88:103], v[68:71], v[84:87], v[88:103]
    v_exp_f32 v116, v116
    v_exp_f32 v117, v117
    v_exp_f32 v118, v118
    v_exp_f32 v119, v119
    v_cvt_pk_bf16_f32 v76, v112, v113
    v_cvt_pk_bf16_f32 v77, v114, v115
    v_cvt_pk_bf16_f32 v78, v116, v117
    v_cvt_pk_bf16_f32 v79, v118, v119
    s_cmp_lg_u32 s25, 0
    s_cbranch_scc1 .Lchance_21
.Lchback_22:
    s_waitcnt lgkmcnt(0)
    v_mfma_f32_32x32x16_bf16 v[88:103], v[56:59], v[72:75], v[88:103]
    ds_read_b64_tr_b16 v[64:65], v13 offset:3584
    ds_read_b64_tr_b16 v[66:67], v13 offset:3712
    ds_read_b64_tr_b16 v[68:69], v13 offset:3840
    ds_read_b64_tr_b16 v[70:71], v13 offset:3968
    v_exp_f32 v120, v120
    v_exp_f32 v121, v121
    v_exp_f32 v122, v122
    v_exp_f32_e64 v123, v123
    v_mfma_f32_32x32x16_bf16 v[88:103], v[60:63], v[76:79], v[88:103]
    v_exp_f32 v124, v124
    v_exp_f32 v125, v125
    v_exp_f32 v126, v126
    v_exp_f32 v127, v127
    v_cvt_pk_bf16_f32 v80, v120, v121
    v_cvt_pk_bf16_f32 v81, v122, v123
    v_exp_f32 v128, v128
    v_exp_f32 v129, v129
    v_exp_f32 v130, v130
    v_exp_f32 v131, v131
    v_cvt_pk_bf16_f32 v82, v124, v125
    v_cvt_pk_bf16_f32 v83, v126, v127
    v_exp_f32 v132, v132
    v_exp_f32 v133, v133
    v_exp_f32 v134, v134
    v_exp_f32 v135, v135
    v_cvt_pk_bf16_f32 v84, v128, v129
    v_cvt_pk_bf16_f32 v85, v130, v131
    v_cvt_pk_bf16_f32 v86, v132, v133
    v_cvt_pk_bf16_f32 v87, v134, v135
    s_waitcnt lgkmcnt(0)
    v_mfma_f32_32x32x16_bf16 v[88:103], v[64:67], v[80:83], v[88:103]
    v_mfma_f32_32x32x16_bf16 v[88:103], v[68:71], v[84:87], v[88:103]
    s_cmp_lg_u32 s25, 0
    s_cbranch_scc1 .Lchance_23
.Lchback_24:
    v_cmp_ne_u64 vcc, v[22:23], v[2:3]
    s_nop 1
    s_cbranch_vccz .Lpok_25
    s_mov_b32 s3, 131072
.Lpsp_26:
    buffer_load_dwordx4 v[20:23], v31, s[8:11], s23 offen sc1
    s_sub_u32 s3, s3, 1
    s_waitcnt vmcnt(0)
    s_cbranch_scc1 .Lpok_25
    v_cmp_ne_u64 vcc, v[22:23], v[2:3]
    s_nop 1
    s_cbranch_vccnz .Lpsp_26
.Lpok_25:
    s_nop 5
    v_rcp_f32 v7, v100
    s_nop 0
    v_mul_f32 v16, v7, v20
    v_mul_f32 v104, v16, v88
    v_mul_f32 v105, v16, v89
    v_mul_f32 v106, v16, v90
    v_mul_f32 v107, v16, v91
    v_mul_f32 v108, v16, v92
    v_mul_f32 v109, v16, v93
    v_mul_f32 v110, v16, v94
    v_mul_f32 v111, v16, v95
    v_cvt_pk_bf16_f32 v72, v104, v105
    v_cvt_pk_bf16_f32 v73, v106, v107
    v_cvt_pk_bf16_f32 v74, v108, v109
    v_cvt_pk_bf16_f32 v75, v110, v111
    buffer_store_dwordx4 v[72:75], v1, s[8:11], s30 offen sc1
    v_mul_f32 v112, v16, v96
    v_mul_f32 v113, v16, v97
    v_mul_f32 v114, v16, v98
    v_mul_f32 v115, v16, v99
    v_lshlrev_b32_e64 v7, 3, v0
    v_cvt_pk_bf16_f32 v76, v112, v113
    v_cvt_pk_bf16_f32 v77, v114, v115
    s_mov_b32 exec_hi, 0
    buffer_store_dwordx2 v[76:77], v7, s[8:11], s30 offen offset:1024 sc1
    s_mov_b32 exec_hi, -1
    v_fma_f32 v7, v100, v100, v88
    v_fma_f32 v16, v89, v90, v91
    v_cmp_lt_f32 vcc, 0x21800000, v100
    v_fma_f32 v7, v92, v93, v7
    v_fma_f32 v16, v94, v95, v16
    v_fma_f32 v7, v96, v97, v7
    v_fma_f32 v16, v98, v99, v16
    s_mov_b32 s3, 0x7f800000
    v_add_f32_e64 v7, v7, v16
    v_cmp_gt_f32 s[4:5], s3, abs(v7)
    s_nop 1
    s_and_b64 s[4:5], s[4:5], vcc
    s_cmp_eq_u64 s[4:5], -1
    s_cbranch_scc0 .Lsafe_15
.Lback_16:
    s_cmp_lg_u32 s25, 0
    s_cbranch_scc1 .Llate_27
.Llateb_28:
    s_setprio 0
    s_waitcnt vmcnt(2)
    v_mfma_f32_32x32x16_bf16 v[104:119], v[136:139], v[152:155], 0
    ds_read_b64_tr_b16 v[68:69], v14 offset:256
    ds_read_b64_tr_b16 v[70:71], v14 offset:384
    v_mfma_f32_32x32x8_bf16 v[104:119], v[140:141], v[18:19], v[104:119]
    buffer_load_dwordx4 v[224:227], v1, s[8:11], s24 offen offset:1024 sc1
    ds_read_b64_tr_b16 v[56:57], v14 offset:512
    ds_read_b64_tr_b16 v[58:59], v14 offset:640
    ds_read_b64_tr_b16 v[60:61], v14 offset:768
    ds_read_b64_tr_b16 v[62:63], v14 offset:896
    v_mfma_f32_32x32x16_bf16 v[120:135], v[144:147], v[152:155], 0
    buffer_load_dwordx4 v[228:231], v1, s[8:11], s24 offen offset:2048 sc1
    s_lshr_b32 s4, s16, 2
    s_and_b32 s5, s16, 3
    s_lshl_b32 s3, s99, 3
    s_add_u32 s3, s3, s5
    s_mul_i32 s6, s3, 10240
    s_mul_i32 s7, s4, 2621440
    s_add_u32 s6, s6, s7
    s_add_u32 s27, s6, 15728640
    v_mfma_f32_32x32x8_bf16 v[120:135], v[148:149], v[18:19], v[120:135]
    buffer_load_dwordx4 v[232:235], v1, s[8:11], s24 offen offset:3072 sc1
    s_and_b32 s3, s99, 28
    s_add_u32 s3, s3, s5
    s_lshl_b32 s3, s3, 2
    s_and_b32 s6, s99, 3
    s_add_u32 s3, s3, s6
    s_lshl_b32 s3, s3, 1
    s_add_u32 s3, s3, s4
    s_lshl_b32 s3, s3, 7
    s_add_u32 s35, s3, 21266432
    s_mov_b32 vcc_lo, 0xaaaaaaaa
    s_mov_b32 vcc_hi, 0xaaaaaaaa
    v_mov_b32 v7, 0xffff
    v_not_b32 v16, v7
    v_cndmask_b32_e64 v11, v7, v16, vcc
    v_mov_b32 v7, 0xff800000
    s_add_u32 s24, s24, 4096
    buffer_load_dwordx4 v[236:239], v1, s[8:11], s24 offen offset:0 sc1
    v_cndmask_b32 v108, v112, v113, vcc
    v_cndmask_b32 v109, v114, v115, vcc
    v_cndmask_b32 v110, v116, v117, vcc
    v_cndmask_b32 v111, v118, v119, vcc
    buffer_load_dwordx4 v[240:243], v1, s[8:11], s24 offen offset:1024 sc1
    v_cndmask_b32 v120, v120, v121, vcc
    v_cndmask_b32 v121, v122, v123, vcc
    v_cndmask_b32 v122, v124, v125, vcc
    v_cndmask_b32 v123, v126, v127, vcc
    buffer_load_dwordx4 v[244:247], v1, s[8:11], s24 offen offset:2048 sc1
    v_cndmask_b32 v124, v128, v129, vcc
    v_cndmask_b32 v125, v130, v131, vcc
    v_cndmask_b32 v126, v132, v133, vcc
    v_cndmask_b32 v127, v134, v135, vcc
    v_cndmask_b32 v108, v108, v124, s[52:53]
    v_cndmask_b32 v109, v109, v125, s[56:57]
    v_cndmask_b32 v110, v110, v126, s[60:61]
    v_cndmask_b32 v111, v111, v127, s[64:65]
    v_cndmask_b32 v104, v7, v120, s[68:69]
    v_cndmask_b32 v105, v7, v121, s[70:71]
    v_cndmask_b32 v106, v7, v122, s[72:73]
    v_cndmask_b32 v107, v7, v123, s[74:75]
    v_cndmask_b32 v108, v7, v108, s[76:77]
    v_cndmask_b32 v109, v7, v109, s[78:79]
    v_cndmask_b32 v110, v7, v110, s[80:81]
    v_cndmask_b32 v111, v7, v111, s[82:83]
    v_max3_f32 v16, v104, v105, v106
    v_max3_f32 v17, v107, v108, v109
    v_max3_f32 v16, v16, v110, v111
    v_max_f32 v16, v16, v17
    v_mov_b32 v17, v16
    s_nop 1
    v_permlane32_swap_b32 v16, v17
    v_max_f32 v16, v16, v17
    v_sub_f32 v104, v104, v16
    v_sub_f32 v105, v105, v16
    v_sub_f32 v106, v106, v16
    v_sub_f32 v107, v107, v16
    v_sub_f32 v108, v108, v16
    v_sub_f32 v109, v109, v16
    v_sub_f32 v110, v110, v16
    v_sub_f32 v111, v111, v16
    v_exp_f32 v104, v104
    v_exp_f32 v105, v105
    v_exp_f32 v106, v106
    v_exp_f32 v107, v107
    v_exp_f32 v108, v108
    v_exp_f32 v109, v109
    v_exp_f32 v110, v110
    v_exp_f32_e64 v111, v111
    v_cvt_pk_bf16_f32 v104, v104, v104
    v_cvt_pk_bf16_f32 v105, v105, v105
    v_cvt_pk_bf16_f32 v106, v106, v106
    v_cvt_pk_bf16_f32 v107, v107, v107
    v_cvt_pk_bf16_f32 v108, v108, v108
    v_cvt_pk_bf16_f32 v109, v109, v109
    v_cvt_pk_bf16_f32 v110, v110, v110
    v_cvt_pk_bf16_f32 v111, v111, v111
    v_bitop3_b32 v72, v104, v11, v32 bitop3:0x80
    v_bitop3_b32 v73, v105, v11, v33 bitop3:0x80
    v_bitop3_b32 v74, v106, v11, v34 bitop3:0x80
    v_bitop3_b32 v75, v107, v11, v35 bitop3:0x80
    v_bitop3_b32 v76, v108, v11, v36 bitop3:0x80
    v_bitop3_b32 v77, v109, v11, v37 bitop3:0x80
    v_bitop3_b32 v78, v110, v11, v38 bitop3:0x80
    v_bitop3_b32 v79, v111, v11, v39 bitop3:0x80
    s_waitcnt lgkmcnt(0)
    v_mfma_f32_32x32x16_bf16 v[88:103], v[56:59], v[72:75], 0
    v_bitop3_b32 v84, v108, v11, v36 bitop3:0x40
    v_bitop3_b32 v85, v109, v11, v37 bitop3:0x40
    v_bitop3_b32 v86, v110, v11, v38 bitop3:0x40
    v_bitop3_b32 v87, v111, v11, v39 bitop3:0x40
    v_mfma_f32_32x32x16_bf16 v[88:103], v[60:63], v[76:79], v[88:103]
    s_nop 0
    v_mfma_f32_32x32x16_bf16 v[88:103], v[68:71], v[84:87], v[88:103]
    s_xor_b32 s3, s25, 1
    s_waitcnt vmcnt(6)
    v_mov_b32_e64 v16, s3
    v_mov_b32 v17, 0
    s_mov_b64 exec, 1
    buffer_atomic_add_x2 v[16:17], off, s[8:11], s31 offset:0 sc1
    s_mov_b64 exec, -1
    s_nop 4
    v_rcp_f32 v7, v100
    v_sub_f32 v20, 1.0, v20
    s_add_u32 s30, s30, 2621440
    v_mul_f32 v16, v7, v20
    v_mul_f32 v104, v16, v88
    v_mul_f32 v105, v16, v89
    v_mul_f32 v106, v16, v90
    v_mul_f32 v107, v16, v91
    v_mul_f32 v108, v16, v92
    v_mul_f32 v109, v16, v93
    v_mul_f32 v110, v16, v94
    v_mul_f32_e64 v111, v16, v95
    v_cvt_pk_bf16_f32 v72, v104, v105
    v_cvt_pk_bf16_f32 v73, v106, v107
    v_cvt_pk_bf16_f32 v74, v108, v109
    v_cvt_pk_bf16_f32 v75, v110, v111
    buffer_store_dwordx4 v[72:75], v1, s[8:11], s30 offen sc1
    v_mul_f32 v112, v16, v96
    v_mul_f32 v113, v16, v97
    v_mul_f32 v114, v16, v98
    v_mul_f32 v115, v16, v99
    v_lshlrev_b32_e64 v7, 3, v0
    v_cvt_pk_bf16_f32 v76, v112, v113
    v_cvt_pk_bf16_f32 v77, v114, v115
    s_mov_b32 exec_hi, 0
    buffer_store_dwordx2 v[76:77], v7, s[8:11], s30 offen offset:1024 sc1
    s_mov_b32 exec_hi, -1
    buffer_load_dwordx4 v[248:251], v1, s[8:11], s24 offen offset:3072 sc1
    s_add_u32 s24, s24, 4096
    buffer_load_dwordx4 v[252:255], v1, s[8:11], s24 offen offset:0 sc1
    v_mov_b32_e64 v4, 0
    v_mov_b32 v5, 0
    s_mov_b64 exec, 1
    buffer_atomic_or_x2 v[4:5], off, s[8:11], s35 sc0 sc1
    s_mov_b64 exec, -1
    v_add_co_u32 v2, vcc, 16, v2
    s_nop 1
    v_addc_co_u32 v3, vcc, 0, v3, vcc
    s_barrier
    s_setprio 3
    v_and_b32 v18, 15, v0
    v_lshrrev_b32 v16, 5, v0
    v_mul_u32_u24 v16, 1280, v16
    v_bfe_u32 v17, v0, 4, 1
    v_lshl_add_u32 v16, v17, 9, v16
    v_lshl_add_u32 v8, v18, 4, v16
    v_lshrrev_b32_e64 v19, 4, v0
    v_mul_u32_u24 v16, 1280, v19
    v_lshl_add_u32 v9, v18, 3, v16
    s_lshl_b32 s3, s16, 12
    s_add_u32 s3, s3, 131072
    v_lshl_add_u32 v10, v0, 2, s3
    s_and_b32 s3, s16, 3
    s_lshl_b32 s3, s3, 14
    s_add_u32 m0, s3, 16380
    s_mul_i32 s69, s90, 0
    s_add_u32 s72, s27, 0
    s_add_u32 s73, s27, 5120
    s_add_u32 s74, s27, 40960
    s_add_u32 s75, s27, 46080
    s_and_b32 s5, s16, 3
    s_lshl_b32 s3, s5, 12
    v_add_u32 v20, s3, v1
    v_add_u32 v21, 65536, v20
    s_lshl_b32 s3, s5, 10
    s_add_u32 s3, s3, 131072
    v_add_u32 v22, s3, v1
    v_bfe_u32 v16, v0, 2, 2
    v_lshl_add_u32 v16, v16, 2, v19
    v_mul_u32_u24 v16, 1280, v16
    v_and_b32_e64 v17, 3, v0
    v_lshl_add_u32 v23, v17, 4, v16
    v_lshl_add_u32 v24, v17, 3, v16
    s_add_u32 s3, s69, s16
    s_and_b32 s3, s3, 3
    s_lshl_b32 s4, s99, 2
    s_add_u32 s3, s3, s4
    s_mul_i32 s3, s3, 20480
    s_mul_i32 s4, s90, 160
    s_add_u32 s68, s3, s4
    s_waitcnt vmcnt(3)
    v_mov_b32_e64 v16, 1
    v_mov_b32 v17, 0
    s_mov_b64 exec, 1
    buffer_atomic_add_x2 v[16:17], off, s[8:11], s31 offset:128 sc1
    s_mov_b64 exec, -1
    s_setprio 1
    s_waitcnt vmcnt(1)
    v_cmp_eq_u64 vcc, v[4:5], v[2:3]
    s_nop 1
    s_cbranch_vccnz .Lcok_30
    s_mov_b32 s3, 131072
.Lcsp_31:
    v_mov_b32_e64 v4, 0
    v_mov_b32 v5, 0
    s_mov_b64 exec, 1
    buffer_atomic_or_x2 v[4:5], off, s[8:11], s35 sc0 sc1
    s_mov_b64 exec, -1
    s_sub_u32 s3, s3, 1
    s_waitcnt vmcnt(0)
    s_cbranch_scc1 .Lcok_30
    v_cmp_eq_u64 vcc, v[4:5], v[2:3]
    s_nop 1
    s_cbranch_vccz .Lcsp_31
.Lcok_30:
.Lgotearly_29:
    buffer_load_dwordx4 v[32:35], v8, s[8:11], s72 offen offset:0 sc1
    buffer_load_dwordx4 v[36:39], v8, s[8:11], s72 offen offset:2560 sc1
    buffer_load_dwordx4 v[40:43], v8, s[8:11], s73 offen offset:0 sc1
    buffer_load_dwordx4 v[44:47], v8, s[8:11], s73 offen offset:2560 sc1
    buffer_load_dwordx2 v[48:49], v9, s[8:11], s72 offen offset:1024 sc1
    buffer_load_dwordx2 v[50:51], v9, s[8:11], s73 offen offset:1024 sc1
    buffer_load_dwordx4 v[52:55], v8, s[8:11], s72 offen offset:256 sc1
    buffer_load_dwordx4 v[56:59], v8, s[8:11], s72 offen offset:2816 sc1
    buffer_load_dwordx4 v[60:63], v8, s[8:11], s73 offen offset:256 sc1
    buffer_load_dwordx4 v[64:67], v8, s[8:11], s73 offen offset:2816 sc1
    s_setprio 1
    s_waitcnt vmcnt(9)
    v_mfma_f32_16x16x32_bf16 v[112:115], v[32:35], v[156:159], 0
    buffer_load_dwordx2 v[68:69], v9, s[8:11], s72 offen offset:1152 sc1
    v_mfma_f32_16x16x32_bf16 v[116:119], v[32:35], v[160:163], 0
    v_mfma_f32_16x16x32_bf16 v[120:123], v[32:35], v[164:167], 0
    v_mfma_f32_16x16x32_bf16 v[124:127], v[32:35], v[168:171], 0
    v_mfma_f32_16x16x32_bf16 v[128:131], v[32:35], v[172:175], 0
    buffer_load_dwordx2 v[70:71], v9, s[8:11], s73 offen offset:1152 sc1
    s_waitcnt vmcnt(10)
    v_mfma_f32_16x16x32_bf16 v[112:115], v[36:39], v[176:179], v[112:115]
    buffer_load_dwordx4 v[72:75], v8, s[8:11], s74 offen offset:0 sc1
    v_mfma_f32_16x16x32_bf16 v[116:119], v[36:39], v[180:183], v[116:119]
    v_mfma_f32_16x16x32_bf16 v[120:123], v[36:39], v[184:187], v[120:123]
    v_mfma_f32_16x16x32_bf16 v[124:127], v[36:39], v[188:191], v[124:127]
    v_mfma_f32_16x16x32_bf16 v[128:131], v[36:39], v[192:195], v[128:131]
    buffer_load_dwordx4 v[76:79], v8, s[8:11], s74 offen offset:2560 sc1
    s_waitcnt vmcnt(11)
    v_mfma_f32_16x16x32_bf16 v[112:115], v[40:43], v[196:199], v[112:115]
    buffer_load_dwordx4 v[80:83], v8, s[8:11], s75 offen offset:0 sc1
    v_mfma_f32_16x16x32_bf16 v[116:119], v[40:43], v[200:203], v[116:119]
    v_mfma_f32_16x16x32_bf16 v[120:123], v[40:43], v[204:207], v[120:123]
    v_mfma_f32_16x16x32_bf16 v[124:127], v[40:43], v[208:211], v[124:127]
    v_mfma_f32_16x16x32_bf16 v[128:131], v[40:43], v[212:215], v[128:131]
    buffer_load_dwordx4 v[84:87], v8, s[8:11], s75 offen offset:2560 sc1
    s_waitcnt vmcnt(12)
    v_mfma_f32_16x16x32_bf16 v[112:115], v[44:47], v[216:219], v[112:115]
    buffer_load_dwordx2 v[88:89], v9, s[8:11], s74 offen offset:1024 sc1
    v_mfma_f32_16x16x32_bf16 v[116:119], v[44:47], v[220:223], v[116:119]
    v_mfma_f32_16x16x32_bf16 v[120:123], v[44:47], v[224:227], v[120:123]
    v_mfma_f32_16x16x32_bf16 v[124:127], v[44:47], v[228:231], v[124:127]
    v_mfma_f32_16x16x32_bf16 v[128:131], v[44:47], v[232:235], v[128:131]
    buffer_load_dwordx2 v[90:91], v9, s[8:11], s75 offen offset:1024 sc1
    s_waitcnt vmcnt(12)
    v_mfma_f32_16x16x32_bf16 v[112:115], v[48:51], v[236:239], v[112:115]
    buffer_load_dwordx4 v[92:95], v8, s[8:11], s74 offen offset:256 sc1
    v_mfma_f32_16x16x32_bf16 v[116:119], v[48:51], v[240:243], v[116:119]
    v_mfma_f32_16x16x32_bf16 v[120:123], v[48:51], v[244:247], v[120:123]
    v_mfma_f32_16x16x32_bf16 v[124:127], v[48:51], v[248:251], v[124:127]
    v_mfma_f32_16x16x32_bf16 v[128:131], v[48:51], v[252:255], v[128:131]
    buffer_load_dwordx4 v[96:99], v8, s[8:11], s74 offen offset:2816 sc1
    s_waitcnt vmcnt(13) lgkmcnt(8)
    v_mfma_f32_16x16x32_bf16 v[132:135], v[52:55], v[156:159], 0
    buffer_load_dwordx4 v[100:103], v8, s[8:11], s75 offen offset:256 sc1
    v_mfma_f32_16x16x32_bf16 v[136:139], v[52:55], v[160:163], 0
    ds_write_addtid_b32 v112 offset:49156
    v_mfma_f32_16x16x32_bf16 v[140:143], v[52:55], v[164:167], 0
    ds_write_addtid_b32 v113 offset:49412
    v_mfma_f32_16x16x32_bf16 v[144:147], v[52:55], v[168:171], 0
    ds_write_addtid_b32 v114 offset:49668
    v_mfma_f32_16x16x32_bf16 v[148:151], v[52:55], v[172:175], 0
    ds_write_addtid_b32 v115 offset:49924
    buffer_load_dwordx4 v[104:107], v8, s[8:11], s75 offen offset:2816 sc1
    s_waitcnt vmcnt(14) lgkmcnt(8)
    v_mfma_f32_16x16x32_bf16 v[132:135], v[56:59], v[176:179], v[132:135]
    buffer_load_dwordx2 v[108:109], v9, s[8:11], s74 offen offset:1152 sc1
    v_mfma_f32_16x16x32_bf16 v[136:139], v[56:59], v[180:183], v[136:139]
    ds_write_addtid_b32 v116 offset:50180
    v_mfma_f32_16x16x32_bf16 v[140:143], v[56:59], v[184:187], v[140:143]
    ds_write_addtid_b32 v117 offset:50436
    v_mfma_f32_16x16x32_bf16 v[144:147], v[56:59], v[188:191], v[144:147]
    ds_write_addtid_b32 v118 offset:50692
    v_mfma_f32_16x16x32_bf16 v[148:151], v[56:59], v[192:195], v[148:151]
    ds_write_addtid_b32 v119 offset:50948
    buffer_load_dwordx2 v[110:111], v9, s[8:11], s75 offen offset:1152 sc1
    s_waitcnt vmcnt(15) lgkmcnt(8)
    v_mfma_f32_16x16x32_bf16 v[132:135], v[60:63], v[196:199], v[132:135]
    v_mfma_f32_16x16x32_bf16 v[136:139], v[60:63], v[200:203], v[136:139]
    ds_write_addtid_b32 v120 offset:51204
    v_mfma_f32_16x16x32_bf16 v[140:143], v[60:63], v[204:207], v[140:143]
    ds_write_addtid_b32 v121 offset:51460
    v_mfma_f32_16x16x32_bf16 v[144:147], v[60:63], v[208:211], v[144:147]
    ds_write_addtid_b32 v122 offset:51716
    v_mfma_f32_16x16x32_bf16 v[148:151], v[60:63], v[212:215], v[148:151]
    ds_write_addtid_b32 v123 offset:51972
    s_waitcnt vmcnt(14) lgkmcnt(8)
    v_mfma_f32_16x16x32_bf16 v[132:135], v[64:67], v[216:219], v[132:135]
    v_mfma_f32_16x16x32_bf16 v[136:139], v[64:67], v[220:223], v[136:139]
    ds_write_addtid_b32 v124 offset:52228
    v_mfma_f32_16x16x32_bf16 v[140:143], v[64:67], v[224:227], v[140:143]
    ds_write_addtid_b32 v125 offset:52484
    v_mfma_f32_16x16x32_bf16 v[144:147], v[64:67], v[228:231], v[144:147]
    ds_write_addtid_b32 v126 offset:52740
    v_mfma_f32_16x16x32_bf16 v[148:151], v[64:67], v[232:235], v[148:151]
    ds_write_addtid_b32 v127 offset:52996
    s_waitcnt vmcnt(12) lgkmcnt(8)
    v_mfma_f32_16x16x32_bf16 v[132:135], v[68:71], v[236:239], v[132:135]
    v_mfma_f32_16x16x32_bf16 v[136:139], v[68:71], v[240:243], v[136:139]
    ds_write_b32 v10, v128 offset:0
    v_mfma_f32_16x16x32_bf16 v[140:143], v[68:71], v[244:247], v[140:143]
    ds_write_b32 v10, v129 offset:256
    v_mfma_f32_16x16x32_bf16 v[144:147], v[68:71], v[248:251], v[144:147]
    ds_write_b32 v10, v130 offset:512
    v_mfma_f32_16x16x32_bf16 v[148:151], v[68:71], v[252:255], v[148:151]
    ds_write_b32 v10, v131 offset:768
    s_waitcnt vmcnt(11) lgkmcnt(8)
    v_mfma_f32_16x16x32_bf16 v[112:115], v[72:75], v[156:159], 0
    v_mfma_f32_16x16x32_bf16 v[116:119], v[72:75], v[160:163], 0
    ds_write_addtid_b32 v132 offset:53252
    v_mfma_f32_16x16x32_bf16 v[120:123], v[72:75], v[164:167], 0
    ds_write_addtid_b32 v133 offset:53508
    v_mfma_f32_16x16x32_bf16 v[124:127], v[72:75], v[168:171], 0
    ds_write_addtid_b32 v134 offset:53764
    v_mfma_f32_16x16x32_bf16 v[128:131], v[72:75], v[172:175], 0
    ds_write_addtid_b32 v135 offset:54020
    s_waitcnt vmcnt(10) lgkmcnt(8)
    v_mfma_f32_16x16x32_bf16 v[112:115], v[76:79], v[176:179], v[112:115]
    v_mfma_f32_16x16x32_bf16 v[116:119], v[76:79], v[180:183], v[116:119]
    ds_write_addtid_b32 v136 offset:54276
    v_mfma_f32_16x16x32_bf16 v[120:123], v[76:79], v[184:187], v[120:123]
    ds_write_addtid_b32 v137 offset:54532
    v_mfma_f32_16x16x32_bf16 v[124:127], v[76:79], v[188:191], v[124:127]
    ds_write_addtid_b32 v138 offset:54788
    v_mfma_f32_16x16x32_bf16 v[128:131], v[76:79], v[192:195], v[128:131]
    ds_write_addtid_b32 v139 offset:55044
    s_waitcnt vmcnt(9) lgkmcnt(8)
    v_mfma_f32_16x16x32_bf16 v[112:115], v[80:83], v[196:199], v[112:115]
    v_mfma_f32_16x16x32_bf16 v[116:119], v[80:83], v[200:203], v[116:119]
    ds_write_addtid_b32 v140 offset:55300
    v_mfma_f32_16x16x32_bf16 v[120:123], v[80:83], v[204:207], v[120:123]
    ds_write_addtid_b32 v141 offset:55556
    v_mfma_f32_16x16x32_bf16 v[124:127], v[80:83], v[208:211], v[124:127]
    ds_write_addtid_b32 v142 offset:55812
    v_mfma_f32_16x16x32_bf16 v[128:131], v[80:83], v[212:215], v[128:131]
    ds_write_addtid_b32 v143 offset:56068
    s_waitcnt vmcnt(8) lgkmcnt(8)
    v_mfma_f32_16x16x32_bf16 v[112:115], v[84:87], v[216:219], v[112:115]
    v_mfma_f32_16x16x32_bf16 v[116:119], v[84:87], v[220:223], v[116:119]
    ds_write_addtid_b32 v144 offset:56324
    v_mfma_f32_16x16x32_bf16 v[120:123], v[84:87], v[224:227], v[120:123]
    ds_write_addtid_b32 v145 offset:56580
    v_mfma_f32_16x16x32_bf16 v[124:127], v[84:87], v[228:231], v[124:127]
    ds_write_addtid_b32 v146 offset:56836
    v_mfma_f32_16x16x32_bf16 v[128:131], v[84:87], v[232:235], v[128:131]
    ds_write_addtid_b32 v147 offset:57092
    s_waitcnt vmcnt(6) lgkmcnt(8)
    v_mfma_f32_16x16x32_bf16 v[112:115], v[88:91], v[236:239], v[112:115]
    v_mfma_f32_16x16x32_bf16 v[116:119], v[88:91], v[240:243], v[116:119]
    ds_write_b32 v10, v148 offset:1024
    v_mfma_f32_16x16x32_bf16 v[120:123], v[88:91], v[244:247], v[120:123]
    ds_write_b32 v10, v149 offset:1280
    v_mfma_f32_16x16x32_bf16 v[124:127], v[88:91], v[248:251], v[124:127]
    ds_write_b32 v10, v150 offset:1536
    v_mfma_f32_16x16x32_bf16 v[128:131], v[88:91], v[252:255], v[128:131]
    ds_write_b32 v10, v151 offset:1792
    s_waitcnt vmcnt(5) lgkmcnt(8)
    v_mfma_f32_16x16x32_bf16 v[132:135], v[92:95], v[156:159], 0
    v_mfma_f32_16x16x32_bf16 v[136:139], v[92:95], v[160:163], 0
    ds_write_addtid_b32 v112 offset:57348
    v_mfma_f32_16x16x32_bf16 v[140:143], v[92:95], v[164:167], 0
    ds_write_addtid_b32 v113 offset:57604
    v_mfma_f32_16x16x32_bf16 v[144:147], v[92:95], v[168:171], 0
    ds_write_addtid_b32 v114 offset:57860
    v_mfma_f32_16x16x32_bf16 v[148:151], v[92:95], v[172:175], 0
    ds_write_addtid_b32 v115 offset:58116
    s_waitcnt vmcnt(4) lgkmcnt(8)
    v_mfma_f32_16x16x32_bf16 v[132:135], v[96:99], v[176:179], v[132:135]
    v_mfma_f32_16x16x32_bf16 v[136:139], v[96:99], v[180:183], v[136:139]
    ds_write_addtid_b32 v116 offset:58372
    v_mfma_f32_16x16x32_bf16 v[140:143], v[96:99], v[184:187], v[140:143]
    ds_write_addtid_b32 v117 offset:58628
    v_mfma_f32_16x16x32_bf16 v[144:147], v[96:99], v[188:191], v[144:147]
    ds_write_addtid_b32 v118 offset:58884
    v_mfma_f32_16x16x32_bf16 v[148:151], v[96:99], v[192:195], v[148:151]
    ds_write_addtid_b32 v119 offset:59140
    s_waitcnt vmcnt(3) lgkmcnt(8)
    v_mfma_f32_16x16x32_bf16 v[132:135], v[100:103], v[196:199], v[132:135]
    v_mfma_f32_16x16x32_bf16 v[136:139], v[100:103], v[200:203], v[136:139]
    ds_write_addtid_b32 v120 offset:59396
    v_mfma_f32_16x16x32_bf16 v[140:143], v[100:103], v[204:207], v[140:143]
    ds_write_addtid_b32 v121 offset:59652
    v_mfma_f32_16x16x32_bf16 v[144:147], v[100:103], v[208:211], v[144:147]
    ds_write_addtid_b32 v122 offset:59908
    v_mfma_f32_16x16x32_bf16 v[148:151], v[100:103], v[212:215], v[148:151]
    ds_write_addtid_b32 v123 offset:60164
    s_waitcnt vmcnt(2) lgkmcnt(8)
    v_mfma_f32_16x16x32_bf16 v[132:135], v[104:107], v[216:219], v[132:135]
    v_mfma_f32_16x16x32_bf16 v[136:139], v[104:107], v[220:223], v[136:139]
    ds_write_addtid_b32 v124 offset:60420
    v_mfma_f32_16x16x32_bf16 v[140:143], v[104:107], v[224:227], v[140:143]
    ds_write_addtid_b32 v125 offset:60676
    v_mfma_f32_16x16x32_bf16 v[144:147], v[104:107], v[228:231], v[144:147]
    ds_write_addtid_b32 v126 offset:60932
    v_mfma_f32_16x16x32_bf16 v[148:151], v[104:107], v[232:235], v[148:151]
    ds_write_addtid_b32 v127 offset:61188
    s_waitcnt vmcnt(0) lgkmcnt(8)
    v_mfma_f32_16x16x32_bf16 v[132:135], v[108:111], v[236:239], v[132:135]
    v_mfma_f32_16x16x32_bf16 v[136:139], v[108:111], v[240:243], v[136:139]
    ds_write_b32 v10, v128 offset:2048
    v_mfma_f32_16x16x32_bf16 v[140:143], v[108:111], v[244:247], v[140:143]
    ds_write_b32 v10, v129 offset:2304
    v_mfma_f32_16x16x32_bf16 v[144:147], v[108:111], v[248:251], v[144:147]
    ds_write_b32 v10, v130 offset:2560
    v_mfma_f32_16x16x32_bf16 v[148:151], v[108:111], v[252:255], v[148:151]
    ds_write_b32 v10, v131 offset:2816
    ds_write_addtid_b32 v132 offset:61444
    ds_write_addtid_b32 v133 offset:61700
    ds_write_addtid_b32 v134 offset:61956
    ds_write_addtid_b32 v135 offset:62212
    s_waitcnt lgkmcnt(4)
    ds_write_addtid_b32 v136 offset:62468
    ds_write_addtid_b32 v137 offset:62724
    ds_write_addtid_b32 v138 offset:62980
    ds_write_addtid_b32 v139 offset:63236
    ds_write_addtid_b32 v140 offset:63492
    ds_write_addtid_b32 v141 offset:63748
    ds_write_addtid_b32 v142 offset:64004
    ds_write_addtid_b32 v143 offset:64260
    s_waitcnt lgkmcnt(4)
    ds_write_addtid_b32 v144 offset:64516
    ds_write_addtid_b32 v145 offset:64772
    ds_write_addtid_b32 v146 offset:65028
    ds_write_addtid_b32 v147 offset:65284
    ds_write_b32 v10, v148 offset:3072
    ds_write_b32 v10, v149 offset:3328
    ds_write_b32 v10, v150 offset:3584
    ds_write_b32 v10, v151 offset:3840
    s_waitcnt lgkmcnt(0)
    s_barrier
    ds_read_b128 v[32:35], v20 offset:2048
    ds_read_b128 v[36:39], v20 offset:18432
    ds_read_b128 v[40:43], v20 offset:34816
    ds_read_b128 v[44:47], v20 offset:51200
    ds_read_b128 v[48:51], v21 offset:2048
    ds_read_b128 v[52:55], v21 offset:18432
    ds_read_b128 v[56:59], v21 offset:34816
    ds_read_b128 v[60:63], v21 offset:51200
    ds_read_b128 v[64:67], v20 offset:3072
    ds_read_b128 v[68:71], v20 offset:19456
    ds_read_b128 v[72:75], v20 offset:35840
    ds_read_b128 v[76:79], v20 offset:52224
    s_waitcnt lgkmcnt(8)
    ds_read_b128 v[80:83], v21 offset:3072
    ds_read_b128 v[84:87], v21 offset:19456
    ds_read_b128 v[88:91], v21 offset:35840
    ds_read_b128 v[92:95], v21 offset:52224
    v_pk_add_f32 v[32:33], v[32:33], v[36:37]
    v_pk_add_f32 v[34:35], v[34:35], v[38:39]
    v_pk_add_f32 v[40:41], v[40:41], v[44:45]
    v_pk_add_f32 v[42:43], v[42:43], v[46:47]
    v_pk_add_f32 v[32:33], v[32:33], v[40:41]
    v_pk_add_f32 v[34:35], v[34:35], v[42:43]
    s_waitcnt lgkmcnt(8)
    v_pk_add_f32 v[48:49], v[48:49], v[52:53]
    v_pk_add_f32 v[50:51], v[50:51], v[54:55]
    v_pk_add_f32 v[56:57], v[56:57], v[60:61]
    v_pk_add_f32 v[58:59], v[58:59], v[62:63]
    v_pk_add_f32 v[48:49], v[48:49], v[56:57]
    v_pk_add_f32 v[50:51], v[50:51], v[58:59]
    v_pk_add_f32 v[32:33], v[32:33], v[48:49]
    v_pk_add_f32 v[34:35], v[34:35], v[50:51]
    v_cvt_pk_bf16_f32 v140, v32, v33
    v_cvt_pk_bf16_f32 v141, v34, v35
    s_waitcnt lgkmcnt(4)
    v_pk_add_f32 v[64:65], v[64:65], v[68:69]
    v_pk_add_f32 v[66:67], v[66:67], v[70:71]
    v_pk_add_f32 v[72:73], v[72:73], v[76:77]
    v_pk_add_f32 v[74:75], v[74:75], v[78:79]
    v_pk_add_f32 v[64:65], v[64:65], v[72:73]
    v_pk_add_f32 v[66:67], v[66:67], v[74:75]
    s_waitcnt lgkmcnt(0)
    v_pk_add_f32 v[80:81], v[80:81], v[84:85]
    v_pk_add_f32 v[82:83], v[82:83], v[86:87]
    v_pk_add_f32 v[88:89], v[88:89], v[92:93]
    v_pk_add_f32 v[90:91], v[90:91], v[94:95]
    v_pk_add_f32 v[80:81], v[80:81], v[88:89]
    v_pk_add_f32 v[82:83], v[82:83], v[90:91]
    v_pk_add_f32 v[64:65], v[64:65], v[80:81]
    v_pk_add_f32 v[66:67], v[66:67], v[82:83]
    v_cvt_pk_bf16_f32 v142, v64, v65
    v_cvt_pk_bf16_f32 v143, v66, v67
    buffer_store_dwordx4 v[140:143], v23, s[12:15], s68 offen offset:64
    s_endpgm
.Lspare_2:
    s_mov_b32 s88, s23
    s_waitcnt lgkmcnt(0)
    s_cmp_lt_u32 s88, 8
    s_cselect_b32 s6, s40, s46
    s_cselect_b32 s7, s41, s47
    s_mov_b32 s68, s6
    s_and_b32 s69, s7, 0xffff
    s_mov_b32 s70, 0xc8000
    s_mov_b32 s71, 0x20000
    s_mov_b32 s76, s44
    s_and_b32 s77, s45, 0xffff
    s_mov_b32 s78, 0x258000
    s_mov_b32 s79, 0x20000
    s_mov_b32 s72, s36
    s_and_b32 s73, s37, 0xffff
    s_mov_b32 s74, 0x280000
    s_mov_b32 s75, 0x20000
    s_mov_b32 s84, s48
    s_and_b32 s85, s49, 0xffff
    s_mov_b32 s86, 0x500
    s_mov_b32 s87, 0x20000
    s_mov_b32 s8, s54
    s_and_b32 s9, s55, 0xffff
    s_mov_b32 s10, 0x2000000
    s_mov_b32 s11, 0x20000
    s_mov_b32 s12, s50
    s_and_b32 s13, s51, 0xffff
    s_mov_b32 s14, 0x280000
    s_mov_b32 s15, 0x20000
    s_mov_b32 s32, s52
    s_and_b32 s33, s53, 0xffff
    s_mov_b32 s34, 0x100
    s_mov_b32 s35, 0x20000
    s_and_b32 s3, s2, 7
    s_lshr_b32 s4, s2, 3
    s_and_b32 s7, s4, 3
    s_lshl_b32 s3, s3, 2
    s_add_u32 s18, s3, s7
    s_lshr_b32 s19, s4, 2
    s_bfe_u32 s3, s2, 0x20001
    s_lshl_b32 s3, s3, 3
    s_and_b32 s6, s4, 7
    s_add_u32 s99, s3, s6
    s_and_b32 s3, s2, 1
    s_lshl_b32 s3, s3, 2
    s_lshr_b32 s6, s4, 3
    s_add_u32 s90, s3, s6
    s_and_b32 s21, s18, 1
    s_lshr_b32 s3, s18, 1
    s_mul_i32 s3, s3, 5
    s_lshl_b32 s6, s21, 1
    s_add_u32 s20, s3, s6
    s_lshl_b32 s3, s19, 3
    s_add_u32 s22, s3, s16
    s_lshl_b32 s3, s2, 3
    s_add_u32 s3, s3, s16
    s_lshl_b32 s3, s3, 7
    s_add_u32 s17, s3, 21315584
    s_mov_b32 s36, 0xffffffff
    s_mov_b32 s37, 0xfffffff0
    s_mov_b32 s38, 0xfffffffe
    s_mov_b32 s39, 0xffffffe0
    s_mov_b32 s40, 0xfffffffc
    s_mov_b32 s41, 0xffffffc0
    s_mov_b32 s42, 0xfffffff8
    s_mov_b32 s43, 0xffffff80
    s_mov_b32 s44, 0xffffff00
    s_mov_b32 s45, 0xfffff000
    s_mov_b32 s46, 0xfffffe00
    s_mov_b32 s47, 0xffffe000
    s_mov_b32 s48, 0xfffffc00
    s_mov_b32 s49, 0xffffc000
    s_mov_b32 s50, 0xfffff800
    s_mov_b32 s51, 0xffff8000
    s_mov_b32 s52, 0xffff0000
    s_mov_b32 s53, 0xfff00000
    s_mov_b32 s54, 0xfffe0000
    s_mov_b32 s55, 0xffe00000
    s_mov_b32 s56, 0xfffc0000
    s_mov_b32 s57, 0xffc00000
    s_mov_b32 s58, 0xfff80000
    s_mov_b32 s59, 0xff800000
    s_mov_b32 s60, 0xff000000
    s_mov_b32 s61, 0xf0000000
    s_mov_b32 s62, 0xfe000000
    s_mov_b32 s63, 0xe0000000
    s_mov_b32 s64, 0xfc000000
    s_mov_b32 s65, 0xc0000000
    s_mov_b32 s66, 0xf8000000
    s_mov_b32 s67, 0x80000000
    v_add_u32 v7, 0, v0
    v_mul_u32_u24 v8, 1639, v7
    v_lshrrev_b32 v8, 16, v8
    v_mul_u32_u24 v8, 640, v8
    v_lshl_add_u32 v16, v7, 4, v8
    v_add_u32 v7, 64, v0
    v_mul_u32_u24 v8, 1639, v7
    v_lshrrev_b32 v8, 16, v8
    v_mul_u32_u24 v8, 640, v8
    v_lshl_add_u32 v17, v7, 4, v8
    v_add_u32 v7, 128, v0
    v_mul_u32_u24 v8, 1639, v7
    v_lshrrev_b32 v8, 16, v8
    v_mul_u32_u24 v8, 640, v8
    v_lshl_add_u32 v18, v7, 4, v8
    v_add_u32 v7, 192, v0
    v_mul_u32_u24 v8, 1639, v7
    v_lshrrev_b32 v8, 16, v8
    v_mul_u32_u24 v8, 640, v8
    v_lshl_add_u32 v19, v7, 4, v8
    v_add_u32 v7, 256, v0
    v_mul_u32_u24 v8, 1639, v7
    v_lshrrev_b32 v8, 16, v8
    v_mul_u32_u24 v8, 640, v8
    v_lshl_add_u32 v20, v7, 4, v8
    s_bfe_u32 s3, s88, 0x20001
    s_mul_i32 s3, s3, 160
    s_mul_i32 s4, s16, 20
    s_add_u32 s3, s3, s4
    s_mul_i32 s3, s3, 1280
    s_and_b32 s4, s88, 1
    s_mul_i32 s4, s4, 640
    s_add_u32 s5, s3, s4
    s_mul_i32 s6, s16, 12800
    s_add_u32 m0, s6, 0
    s_add_u32 s3, s5, 0
    buffer_load_dwordx4 v16, s[68:71], s3 offen nt lds
    s_add_u32 m0, s6, 1024
    s_add_u32 s3, s5, 0
    buffer_load_dwordx4 v17, s[68:71], s3 offen nt lds
    s_add_u32 m0, s6, 2048
    s_add_u32 s3, s5, 0
    buffer_load_dwordx4 v18, s[68:71], s3 offen nt lds
    s_add_u32 m0, s6, 3072
    s_add_u32 s3, s5, 0
    buffer_load_dwordx4 v19, s[68:71], s3 offen nt lds
    s_add_u32 m0, s6, 4096
    s_add_u32 s3, s5, 0
    buffer_load_dwordx4 v20, s[68:71], s3 offen nt lds
    s_add_u32 m0, s6, 5120
    s_add_u32 s3, s5, 10240
    buffer_load_dwordx4 v16, s[68:71], s3 offen nt lds
    s_add_u32 m0, s6, 6144
    s_add_u32 s3, s5, 10240
    buffer_load_dwordx4 v17, s[68:71], s3 offen nt lds
    s_add_u32 m0, s6, 7168
    s_add_u32 s3, s5, 10240
    buffer_load_dwordx4 v18, s[68:71], s3 offen nt lds
    s_add_u32 m0, s6, 8192
    s_add_u32 s3, s5, 10240
    buffer_load_dwordx4 v19, s[68:71], s3 offen nt lds
    s_add_u32 m0, s6, 9216
    s_add_u32 s3, s5, 10240
    buffer_load_dwordx4 v20, s[68:71], s3 offen nt lds
    s_add_u32 m0, s6, 10240
    s_add_u32 s3, s5, 20480
    buffer_load_dwordx4 v16, s[68:71], s3 offen nt lds
    s_add_u32 m0, s6, 11264
    s_add_u32 s3, s5, 20480
    buffer_load_dwordx4 v17, s[68:71], s3 offen nt lds
    s_add_u32 m0, s6, 12288
    s_add_u32 s3, s5, 20480
    s_mov_b32 exec_hi, 0
    buffer_load_dwordx4 v18, s[68:71], s3 offen nt lds
    s_mov_b32 exec_hi, -1
    buffer_load_dwordx2 v[2:3], off, s[32:35], 0 sc1
    v_lshlrev_b32 v1, 4, v0
    s_sub_u32 s26, 8, s16
    s_cmp_eq_u32 s19, 0
    s_cselect_b32 s26, s26, 0
    s_lshr_b32 s3, s22, 2
    s_mul_i32 s3, s3, 491520
    s_and_b32 s4, s22, 3
    s_lshl_b32 s4, s4, 9
    s_add_u32 s3, s3, s4
    s_lshl_b32 s5, s20, 11
    s_add_u32 s5, s5, 7864320
    s_add_u32 s28, s3, s5
    s_sub_u32 s3, s22, 1
    s_max_i32 s4, s3, 0
    s_lshr_b32 s3, s4, 2
    s_mul_i32 s3, s3, 491520
    s_and_b32 s4, s4, 3
    s_lshl_b32 s4, s4, 9
    s_add_u32 s3, s3, s4
    s_add_u32 s29, s3, s5
    s_lshl_b32 s3, s22, 5
    s_add_u32 s3, s3, s18
    s_mul_i32 s4, s3, 1280
    s_add_u32 s30, s4, 15728640
    s_lshl_b32 s3, s19, 2
    s_lshr_b32 s4, s18, 3
    s_add_u32 s3, s3, s4
    s_lshl_b32 s3, s3, 2
    s_lshr_b32 s4, s16, 1
    s_add_u32 s3, s3, s4
    s_lshl_b32 s3, s3, 8
    s_add_u32 s31, s3, 21266432
    s_and_b32 s91, s16, 3
    s_lshl_b32 s3, s19, 1
    s_add_u32 s3, s3, s91
    s_sub_u32 s3, s3, 2
    s_max_i32 s80, s3, 0
    s_mul_i32 s92, s80, 491520
    s_lshl_b32 s4, s20, 11
    s_add_u32 s92, s92, s4
    s_lshl_b32 s5, s21, 11
    s_add_u32 s93, s92, s5
    s_cmp_eq_u32 s21, 0
    s_cselect_b32 s6, 4096, 8
    s_cselect_b32 s7, 4096, 0
    s_add_u32 s94, s92, s6
    s_lshl_b32 s3, s19, 1
    s_lshr_b32 s6, s91, 1
    s_add_u32 s3, s3, s6
    s_mul_i32 s3, s3, 491520
    s_and_b32 s6, s91, 1
    s_lshl_b32 s6, s6, 10
    s_add_u32 s3, s3, s6
    s_add_u32 s3, s3, s4
    s_add_u32 s95, s3, s5
    s_add_u32 s96, s3, s7
    s_lshl_b32 s97, s91, 11
    s_lshl_b32 s98, s91, 10
    s_lshl_b32 s3, s91, 3
    s_add_u32 s3, s3, s90
    s_lshl_b32 s3, s3, 8
    s_add_u32 s81, s3, 21299200
    v_and_b32 v20, 3, v0
    s_lshl_b32 s3, s80, 2
    v_add_u32 v21, s3, v20
    v_and_b32 v23, 1, v0
    s_lshl_b32 s3, s19, 3
    s_lshl_b32 s4, s91, 1
    s_add_u32 s3, s3, s4
    v_add_u32 v20, s3, v23
    v_cmp_gt_u32 vcc, 16, v0
    v_lshrrev_b32 v22, 1, v0
    v_and_b32 v22, 2, v22
    v_cndmask_b32 v21, v20, v21, vcc
    v_bfe_u32 v20, v0, 3, 1
    v_mul_u32_u24 v20, 5, v20
    v_add_u32 v20, 5, v20
    v_cndmask_b32 v20, 0, v20, vcc
    v_add_u32 v22, s20, v22
    v_lshrrev_b32 v22, 4, v22
    v_add_u32 v20, v20, v22
    v_lshl_add_u32 v20, v21, 4, v20
    v_lshlrev_b32 v20, 7, v20
    v_add_u32 v20, 21004288, v20
    v_cmp_gt_u32 vcc, 24, v0
    v_and_b32 v22, 2, v0
    v_lshlrev_b32 v22, 12, v22
    v_lshl_add_u32 v22, v23, 7, v22
    v_add_u32 v22, s81, v22
    v_cndmask_b32 v92, v22, v20, vcc
    v_lshrrev_b32 v7, 1, v0
    v_lshlrev_b32 v7, 4, v7
    v_lshl_add_u32 v93, v23, 2, v7
    v_and_b32 v24, 31, v0
    v_lshrrev_b32 v25, 5, v0
    s_lshl_b32 s4, s91, 5
    v_add_u32 v7, s4, v24
    v_lshlrev_b32 v26, 13, v25
    v_lshl_add_u32 v26, v7, 4, v26
    v_add_u32 v84, 99840, v26
    v_lshlrev_b32 v26, 3, v7
    v_add_u32 v85, 116224, v26
    v_lshlrev_b32 v26, 12, v25
    v_lshl_add_u32 v26, v7, 4, v26
    v_add_u32 v86, 0, v26
    s_lshl_b32 s4, s21, 3
    s_add_u32 s4, s4, 8192
    v_lshl_add_u32 v87, v7, 4, s4
    v_add_u32 v64, 2048, v84
    v_add_u32 v65, 1024, v85
    v_add_u32 v66, 2048, v86
    v_add_u32 v67, 2048, v87
    v_mov_b32 v72, 0
    v_mov_b32 v73, 0
    v_bfe_u32 v20, v0, 4, 1
    v_and_b32 v21, 3, v0
    v_lshl_add_u32 v20, v20, 2, v21
    v_add_u32 v21, s21, v20
    v_bfe_u32 v22, v0, 2, 2
    v_lshl_add_u32 v22, v25, 2, v22
    v_lshlrev_b32 v22, 4, v22
    v_and_b32 v23, 1, v21
    v_lshl_add_u32 v23, v23, 3, v22
    v_lshrrev_b32 v21, 1, v21
    v_cmp_lt_u32 vcc, 4, v20
    s_lshl_b32 s4, s91, 9
    s_add_u32 s4, s4, 120384
    v_mul_u32_u24 v7, 8256, v21
    v_add3_u32 v7, v7, v23, s4
    s_add_u32 s4, s4, 25280
    v_add_u32 v26, s4, v22
    v_cndmask_b32 v89, v7, v26, vcc
    v_add_u32 v69, 2048, v89
    v_add_u32 v26, 149760, v22
    s_mul_i32 s4, s91, 3328
    s_add_u32 s4, s4, 33344
    v_mul_u32_u24 v7, 1088, v21
    v_add3_u32 v7, v7, v23, s4
    v_cndmask_b32 v90, v7, v26, vcc
    v_add_u32 v7, 13312, v7
    v_cndmask_b32 v70, v7, v26, vcc
    v_lshrrev_b32 v23, 2, v0
    v_min_u32 v23, 2, v23
    v_cmp_eq_u32 vcc, 0, v23
    v_and_b32 v20, 1, v0
    v_mul_u32_u24 v22, 5, v23
    v_cndmask_b32_e64 v20, v20, 1, vcc
    s_sub_u32 s3, s22, 5
    v_add_u32 v21, s3, v20
    v_and_b32 v20, 2, v0
    v_add_u32 v20, s20, v20
    v_lshrrev_b32 v20, 4, v20
    v_add_u32 v20, v20, v22
    v_lshlrev_b32 v20, 7, v20
    v_add_u32 v20, 21135360, v20
    v_add_u32 v22, 4, v21
    v_lshl_add_u32 v68, v22, 11, v20
    v_max_i32 v21, 0, v21
    v_lshl_add_u32 v88, v21, 11, v20
    s_lshl_b32 s3, s19, 7
    s_lshr_b32 s4, s18, 3
    s_add_u32 s3, s3, s4
    s_lshl_b32 s3, s3, 7
    s_add_u32 s3, s3, 21135360
    v_writelane_b32 v88, s3, 12
    v_writelane_b32 v68, s3, 12
    v_lshlrev_b32 v26, 4, v24
    v_add_u32 v7, s21, v25
    v_lshl_add_u32 v74, v7, 11, v26
    s_cmp_eq_u32 s21, 0
    s_cselect_b32 s4, 4096, 8
    v_add_u32 v75, s4, v26
    s_cmp_eq_u32 s91, 0
    s_cselect_b32 s4, 489472, 0
    s_add_u32 s4, s4, 512
    v_mad_u32_u24 v71, s4, v25, v26
    s_cmp_eq_u32 s22, 4
    s_cselect_b32 s4, 0, s4
    v_mad_u32_u24 v91, s4, v25, v26
    v_mov_b32 v7, 0xffff
    v_cndmask_b32 v76, 0, v7, s[36:37]
    v_cndmask_b32 v77, 0, v7, s[40:41]
    v_cndmask_b32 v78, 0, v7, s[44:45]
    v_cndmask_b32 v79, 0, v7, s[48:49]
    v_cndmask_b32 v80, 0, v7, s[52:53]
    v_cndmask_b32 v81, 0, v7, s[56:57]
    v_cndmask_b32 v82, 0, v7, s[60:61]
    v_cndmask_b32 v83, 0, v7, s[64:65]
    v_cndmask_b32 v76, v76, -1, s[38:39]
    v_cndmask_b32 v77, v77, -1, s[42:43]
    v_cndmask_b32 v78, v78, -1, s[46:47]
    v_cndmask_b32 v79, v79, -1, s[50:51]
    v_cndmask_b32 v80, v80, -1, s[54:55]
    v_cndmask_b32 v81, v81, -1, s[58:59]
    v_cndmask_b32 v82, v82, -1, s[62:63]
    v_cndmask_b32 v83, v83, -1, s[66:67]
    s_cmp_lt_u32 s16, 4
    s_cbranch_scc1 .Lsp03_32
    s_add_u32 s3, s98, 149760
    v_add_u32 v7, s3, v1
    ds_write_b128 v7, v[88:91] offset:8192
    s_cmp_lg_u32 s16, 4
    s_cbranch_scc1 .Lnocommon_33
    ds_write_b128 v7, v[84:87] offset:4096
    ds_write_b128 v7, v[72:75] offset:5120
    ds_write_b128 v7, v[76:79] offset:6144
    ds_write_b128 v7, v[80:83] offset:7168
.Lnocommon_33:
    v_mov_b32 v20, 0x3f803f80
    v_mov_b32 v21, 0x3f803f80
    v_mov_b32 v22, 0x3f803f80
    v_mov_b32 v23, 0x3f803f80
    ds_write_b128 v7, v[20:23]
    s_waitcnt lgkmcnt(0)
.Lsp03_32:
    s_lshr_b32 s4, s16, 1
    s_mul_i32 s4, s4, 160
    v_bfe_u32 v7, v0, 2, 3
    v_lshrrev_b32 v8, 5, v0
    v_mul_u32_u24 v8, 20, v8
    v_add_u32 v8, v8, v7
    v_mul_u32_u24 v8, 640, v8
    v_and_b32 v9, 3, v0
    v_lshl_add_u32 v9, v9, 3, s4
    v_add_u32 v22, v8, v9
    v_add_u32 v23, 51200, v22
    v_lshrrev_b32 v8, 4, v0
    v_mul_u32_u24 v8, 20, v8
    v_and_b32 v7, 3, v7
    v_add3_u32 v8, v8, v7, 16
    v_mul_u32_u24 v8, 640, v8
    v_add_u32 v24, v8, v9
    v_and_b32 v9, 3, v0
    v_lshl_add_u32 v25, v9, 3, v22
    v_lshl_add_u32 v26, v9, 3, v23
    v_lshl_add_u32 v27, v9, 3, v24
    v_lshlrev_b32 v1, 4, v0
    s_lshl_b32 s3, s88, 2
    s_lshr_b32 s4, s16, 1
    s_add_u32 s3, s3, s4
    s_mul_i32 s5, s3, 25600
    s_add_u32 s5, s5, 21577728
    s_lshl_b32 s3, s88, 3
    s_add_u32 s3, s3, s16
    s_lshl_b32 s3, s3, 7
    s_add_u32 s89, s3, 21299200
    s_waitcnt vmcnt(0)
    v_cmp_eq_u32 vcc, 0, v2
    s_nop 1
    s_cbranch_vccnz .Lnsp_35
.Lnok_34:
    s_barrier
    s_bitcmp1_b32 s16, 0
    s_cbranch_scc1 .Lodd_36
    ds_read_b64_tr_b16 v[96:97], v25 offset:0
    ds_read_b64_tr_b16 v[98:99], v25 offset:5120
    ds_read_b64_tr_b16 v[100:101], v25 offset:8
    ds_read_b64_tr_b16 v[102:103], v25 offset:5128
    ds_read_b64_tr_b16 v[104:105], v25 offset:64
    ds_read_b64_tr_b16 v[106:107], v25 offset:5184
    s_waitcnt lgkmcnt(4)
    s_add_u32 s3, s5, 0
    buffer_store_dwordx4 v[96:99], v1, s[8:11], s3 offen sc1
    ds_read_b64_tr_b16 v[108:109], v25 offset:72
    ds_read_b64_tr_b16 v[110:111], v25 offset:5192
    s_waitcnt lgkmcnt(4)
    s_add_u32 s3, s5, 1024
    buffer_store_dwordx4 v[100:103], v1, s[8:11], s3 offen sc1
    ds_read_b64_tr_b16 v[112:113], v22 offset:128
    ds_read_b64_tr_b16 v[114:115], v22 offset:5248
    s_waitcnt lgkmcnt(4)
    s_add_u32 s3, s5, 2048
    buffer_store_dwordx4 v[104:107], v1, s[8:11], s3 offen sc1
    ds_read_b64_tr_b16 v[116:117], v25 offset:25600
    ds_read_b64_tr_b16 v[118:119], v25 offset:30720
    s_waitcnt lgkmcnt(4)
    s_add_u32 s3, s5, 3072
    buffer_store_dwordx4 v[108:111], v1, s[8:11], s3 offen sc1
    ds_read_b64_tr_b16 v[120:121], v25 offset:25608
    ds_read_b64_tr_b16 v[122:123], v25 offset:30728
    s_waitcnt lgkmcnt(4)
    s_add_u32 s3, s5, 4096
    buffer_store_dwordx4 v[112:115], v1, s[8:11], s3 offen sc1
    ds_read_b64_tr_b16 v[124:125], v25 offset:25664
    ds_read_b64_tr_b16 v[126:127], v25 offset:30784
    s_waitcnt lgkmcnt(4)
    s_add_u32 s3, s5, 5120
    buffer_store_dwordx4 v[116:119], v1, s[8:11], s3 offen sc1
    ds_read_b64_tr_b16 v[128:129], v25 offset:25672
    ds_read_b64_tr_b16 v[130:131], v25 offset:30792
    s_waitcnt lgkmcnt(4)
    s_add_u32 s3, s5, 6144
    buffer_store_dwordx4 v[120:123], v1, s[8:11], s3 offen sc1
    ds_read_b64_tr_b16 v[132:133], v22 offset:25728
    ds_read_b64_tr_b16 v[134:135], v22 offset:30848
    s_waitcnt lgkmcnt(4)
    s_add_u32 s3, s5, 7168
    buffer_store_dwordx4 v[124:127], v1, s[8:11], s3 offen sc1
    ds_read_b64_tr_b16 v[136:137], v26 offset:0
    ds_read_b64_tr_b16 v[138:139], v26 offset:5120
    s_waitcnt lgkmcnt(4)
    s_add_u32 s3, s5, 8192
    buffer_store_dwordx4 v[128:131], v1, s[8:11], s3 offen sc1
    ds_read_b64_tr_b16 v[140:141], v26 offset:8
    ds_read_b64_tr_b16 v[142:143], v26 offset:5128
    s_waitcnt lgkmcnt(4)
    s_add_u32 s3, s5, 9216
    buffer_store_dwordx4 v[132:135], v1, s[8:11], s3 offen sc1
    ds_read_b64_tr_b16 v[144:145], v26 offset:64
    ds_read_b64_tr_b16 v[146:147], v26 offset:5184
    s_waitcnt lgkmcnt(4)
    s_add_u32 s3, s5, 10240
    buffer_store_dwordx4 v[136:139], v1, s[8:11], s3 offen sc1
    s_waitcnt lgkmcnt(0)
    s_add_u32 s3, s5, 11264
    buffer_store_dwordx4 v[140:143], v1, s[8:11], s3 offen sc1
    s_add_u32 s3, s5, 12288
    buffer_store_dwordx4 v[144:147], v1, s[8:11], s3 offen sc1
    s_branch .Lpacked_37
.Lodd_36:
    ds_read_b64_tr_b16 v[96:97], v26 offset:72
    ds_read_b64_tr_b16 v[98:99], v26 offset:5192
    ds_read_b64_tr_b16 v[100:101], v23 offset:128
    ds_read_b64_tr_b16 v[102:103], v23 offset:5248
    ds_read_b64_tr_b16 v[104:105], v26 offset:25600
    ds_read_b64_tr_b16 v[106:107], v26 offset:30720
    s_waitcnt lgkmcnt(4)
    s_add_u32 s3, s5, 13312
    buffer_store_dwordx4 v[96:99], v1, s[8:11], s3 offen sc1
    ds_read_b64_tr_b16 v[108:109], v26 offset:25608
    ds_read_b64_tr_b16 v[110:111], v26 offset:30728
    s_waitcnt lgkmcnt(4)
    s_add_u32 s3, s5, 14336
    buffer_store_dwordx4 v[100:103], v1, s[8:11], s3 offen sc1
    ds_read_b64_tr_b16 v[112:113], v26 offset:25664
    ds_read_b64_tr_b16 v[114:115], v26 offset:30784
    s_waitcnt lgkmcnt(4)
    s_add_u32 s3, s5, 15360
    buffer_store_dwordx4 v[104:107], v1, s[8:11], s3 offen sc1
    ds_read_b64_tr_b16 v[116:117], v26 offset:25672
    ds_read_b64_tr_b16 v[118:119], v26 offset:30792
    s_waitcnt lgkmcnt(4)
    s_add_u32 s3, s5, 16384
    buffer_store_dwordx4 v[108:111], v1, s[8:11], s3 offen sc1
    ds_read_b64_tr_b16 v[120:121], v23 offset:25728
    ds_read_b64_tr_b16 v[122:123], v23 offset:30848
    s_waitcnt lgkmcnt(4)
    s_add_u32 s3, s5, 17408
    buffer_store_dwordx4 v[112:115], v1, s[8:11], s3 offen sc1
    ds_read_b64_tr_b16 v[124:125], v27 offset:0
    ds_read_b64_tr_b16 v[126:127], v27 offset:51200
    s_waitcnt lgkmcnt(4)
    s_add_u32 s3, s5, 18432
    buffer_store_dwordx4 v[116:119], v1, s[8:11], s3 offen sc1
    ds_read_b64_tr_b16 v[128:129], v27 offset:8
    ds_read_b64_tr_b16 v[130:131], v27 offset:51208
    s_waitcnt lgkmcnt(4)
    s_add_u32 s3, s5, 19456
    buffer_store_dwordx4 v[120:123], v1, s[8:11], s3 offen sc1
    ds_read_b64_tr_b16 v[132:133], v27 offset:64
    ds_read_b64_tr_b16 v[134:135], v27 offset:51264
    s_waitcnt lgkmcnt(4)
    s_add_u32 s3, s5, 20480
    buffer_store_dwordx4 v[124:127], v1, s[8:11], s3 offen sc1
    ds_read_b64_tr_b16 v[136:137], v27 offset:72
    ds_read_b64_tr_b16 v[138:139], v27 offset:51272
    s_waitcnt lgkmcnt(4)
    s_add_u32 s3, s5, 21504
    buffer_store_dwordx4 v[128:131], v1, s[8:11], s3 offen sc1
    ds_read_b64_tr_b16 v[140:141], v24 offset:128
    ds_read_b64_tr_b16 v[142:143], v24 offset:51328
    s_waitcnt lgkmcnt(4)
    s_add_u32 s3, s5, 22528
    buffer_store_dwordx4 v[132:135], v1, s[8:11], s3 offen sc1
    s_waitcnt lgkmcnt(0)
    s_add_u32 s3, s5, 23552
    buffer_store_dwordx4 v[136:139], v1, s[8:11], s3 offen sc1
    s_add_u32 s3, s5, 24576
    buffer_store_dwordx4 v[140:143], v1, s[8:11], s3 offen sc1
.Lpacked_37:
    s_barrier
    v_and_b32 v8, 7, v0
    v_lshlrev_b32 v8, 4, v8
    v_lshrrev_b32 v9, 3, v0
    v_mul_u32_u24 v10, 1280, v9
    v_add_u32 v10, v10, v8
    s_lshl_b32 s3, s88, 3
    s_add_u32 s6, s3, s16
    s_mul_i32 s4, s6, 20480
    s_add_u32 s5, s4, 10240
    s_waitcnt vmcnt(0)
    v_lshlrev_b32 v7, 3, v0
    s_mov_b64 exec, 0xffff
    buffer_store_dwordx2 v[2:3], v7, s[8:11], s89 offen sc1
    s_mov_b64 exec, -1
    buffer_load_dwordx4 v[176:179], v8, s[84:87], 0 offen offset:0
    buffer_load_dwordx4 v[96:99], v10, s[72:75], s4 offen offset:0
    buffer_load_dwordx4 v[100:103], v10, s[72:75], s5 offen offset:0
    buffer_load_dwordx4 v[180:183], v8, s[84:87], 0 offen offset:128
    buffer_load_dwordx4 v[104:107], v10, s[72:75], s4 offen offset:128
    buffer_load_dwordx4 v[108:111], v10, s[72:75], s5 offen offset:128
    buffer_load_dwordx4 v[184:187], v8, s[84:87], 0 offen offset:256
    buffer_load_dwordx4 v[112:115], v10, s[72:75], s4 offen offset:256
    buffer_load_dwordx4 v[116:119], v10, s[72:75], s5 offen offset:256
    buffer_load_dwordx4 v[188:191], v8, s[84:87], 0 offen offset:384
    buffer_load_dwordx4 v[120:123], v10, s[72:75], s4 offen offset:384
    buffer_load_dwordx4 v[124:127], v10, s[72:75], s5 offen offset:384
    buffer_load_dwordx4 v[192:195], v8, s[84:87], 0 offen offset:512
    buffer_load_dwordx4 v[128:131], v10, s[72:75], s4 offen offset:512
    buffer_load_dwordx4 v[132:135], v10, s[72:75], s5 offen offset:512
    buffer_load_dwordx4 v[196:199], v8, s[84:87], 0 offen offset:640
    buffer_load_dwordx4 v[136:139], v10, s[72:75], s4 offen offset:640
    buffer_load_dwordx4 v[140:143], v10, s[72:75], s5 offen offset:640
    buffer_load_dwordx4 v[200:203], v8, s[84:87], 0 offen offset:768
    buffer_load_dwordx4 v[144:147], v10, s[72:75], s4 offen offset:768
    buffer_load_dwordx4 v[148:151], v10, s[72:75], s5 offen offset:768
    buffer_load_dwordx4 v[204:207], v8, s[84:87], 0 offen offset:896
    buffer_load_dwordx4 v[152:155], v10, s[72:75], s4 offen offset:896
    buffer_load_dwordx4 v[156:159], v10, s[72:75], s5 offen offset:896
    buffer_load_dwordx4 v[208:211], v8, s[84:87], 0 offen offset:1024
    buffer_load_dwordx4 v[160:163], v10, s[72:75], s4 offen offset:1024
    buffer_load_dwordx4 v[164:167], v10, s[72:75], s5 offen offset:1024
    buffer_load_dwordx4 v[212:215], v8, s[84:87], 0 offen offset:1152
    buffer_load_dwordx4 v[168:171], v10, s[72:75], s4 offen offset:1152
    buffer_load_dwordx4 v[172:175], v10, s[72:75], s5 offen offset:1152
    v_mov_b32 v216, 0
    v_mov_b32 v217, 0
    s_waitcnt vmcnt(27)
    v_dot2_f32_bf16 v216, v96, v176, v216
    v_dot2_f32_bf16 v217, v100, v176, v217
    v_dot2_f32_bf16 v216, v97, v177, v216
    v_dot2_f32_bf16 v217, v101, v177, v217
    v_dot2_f32_bf16 v216, v98, v178, v216
    v_dot2_f32_bf16 v217, v102, v178, v217
    v_dot2_f32_bf16 v216, v99, v179, v216
    v_dot2_f32_bf16 v217, v103, v179, v217
    s_waitcnt vmcnt(24)
    v_dot2_f32_bf16 v216, v104, v180, v216
    v_dot2_f32_bf16 v217, v108, v180, v217
    v_dot2_f32_bf16 v216, v105, v181, v216
    v_dot2_f32_bf16 v217, v109, v181, v217
    v_dot2_f32_bf16 v216, v106, v182, v216
    v_dot2_f32_bf16 v217, v110, v182, v217
    v_dot2_f32_bf16 v216, v107, v183, v216
    v_dot2_f32_bf16 v217, v111, v183, v217
    s_waitcnt vmcnt(21)
    v_dot2_f32_bf16 v216, v112, v184, v216
    v_dot2_f32_bf16 v217, v116, v184, v217
    v_dot2_f32_bf16 v216, v113, v185, v216
    v_dot2_f32_bf16 v217, v117, v185, v217
    v_dot2_f32_bf16 v216, v114, v186, v216
    v_dot2_f32_bf16 v217, v118, v186, v217
    v_dot2_f32_bf16 v216, v115, v187, v216
    v_dot2_f32_bf16 v217, v119, v187, v217
    s_waitcnt vmcnt(18)
    v_dot2_f32_bf16 v216, v120, v188, v216
    v_dot2_f32_bf16 v217, v124, v188, v217
    v_dot2_f32_bf16 v216, v121, v189, v216
    v_dot2_f32_bf16 v217, v125, v189, v217
    v_dot2_f32_bf16 v216, v122, v190, v216
    v_dot2_f32_bf16 v217, v126, v190, v217
    v_dot2_f32_bf16 v216, v123, v191, v216
    v_dot2_f32_bf16 v217, v127, v191, v217
    s_waitcnt vmcnt(15)
    v_dot2_f32_bf16 v216, v128, v192, v216
    v_dot2_f32_bf16 v217, v132, v192, v217
    v_dot2_f32_bf16 v216, v129, v193, v216
    v_dot2_f32_bf16 v217, v133, v193, v217
    v_dot2_f32_bf16 v216, v130, v194, v216
    v_dot2_f32_bf16 v217, v134, v194, v217
    v_dot2_f32_bf16 v216, v131, v195, v216
    v_dot2_f32_bf16 v217, v135, v195, v217
    s_waitcnt vmcnt(12)
    v_dot2_f32_bf16 v216, v136, v196, v216
    v_dot2_f32_bf16 v217, v140, v196, v217
    v_dot2_f32_bf16 v216, v137, v197, v216
    v_dot2_f32_bf16 v217, v141, v197, v217
    v_dot2_f32_bf16 v216, v138, v198, v216
    v_dot2_f32_bf16 v217, v142, v198, v217
    v_dot2_f32_bf16 v216, v139, v199, v216
    v_dot2_f32_bf16 v217, v143, v199, v217
    s_waitcnt vmcnt(9)
    v_dot2_f32_bf16 v216, v144, v200, v216
    v_dot2_f32_bf16 v217, v148, v200, v217
    v_dot2_f32_bf16 v216, v145, v201, v216
    v_dot2_f32_bf16 v217, v149, v201, v217
    v_dot2_f32_bf16 v216, v146, v202, v216
    v_dot2_f32_bf16 v217, v150, v202, v217
    v_dot2_f32_bf16 v216, v147, v203, v216
    v_dot2_f32_bf16 v217, v151, v203, v217
    s_waitcnt vmcnt(6)
    v_dot2_f32_bf16 v216, v152, v204, v216
    v_dot2_f32_bf16 v217, v156, v204, v217
    v_dot2_f32_bf16 v216, v153, v205, v216
    v_dot2_f32_bf16 v217, v157, v205, v217
    v_dot2_f32_bf16 v216, v154, v206, v216
    v_dot2_f32_bf16 v217, v158, v206, v217
    v_dot2_f32_bf16 v216, v155, v207, v216
    v_dot2_f32_bf16 v217, v159, v207, v217
    s_waitcnt vmcnt(3)
    v_dot2_f32_bf16 v216, v160, v208, v216
    v_dot2_f32_bf16 v217, v164, v208, v217
    v_dot2_f32_bf16 v216, v161, v209, v216
    v_dot2_f32_bf16 v217, v165, v209, v217
    v_dot2_f32_bf16 v216, v162, v210, v216
    v_dot2_f32_bf16 v217, v166, v210, v217
    v_dot2_f32_bf16 v216, v163, v211, v216
    v_dot2_f32_bf16 v217, v167, v211, v217
    s_waitcnt vmcnt(0)
    v_dot2_f32_bf16 v216, v168, v212, v216
    v_dot2_f32_bf16 v217, v172, v212, v217
    v_dot2_f32_bf16 v216, v169, v213, v216
    v_dot2_f32_bf16 v217, v173, v213, v217
    v_dot2_f32_bf16 v216, v170, v214, v216
    v_dot2_f32_bf16 v217, v174, v214, v217
    v_dot2_f32_bf16 v216, v171, v215, v216
    v_dot2_f32_bf16 v217, v175, v215, v217
    s_nop 1
    v_add_f32_dpp v216, v216, v216 quad_perm:[1,0,3,2] row_mask:0xf bank_mask:0xf
    v_add_f32_dpp v217, v217, v217 quad_perm:[1,0,3,2] row_mask:0xf bank_mask:0xf
    s_nop 0
    v_add_f32_dpp v216, v216, v216 quad_perm:[2,3,0,1] row_mask:0xf bank_mask:0xf
    v_add_f32_dpp v217, v217, v217 quad_perm:[2,3,0,1] row_mask:0xf bank_mask:0xf
    s_nop 0
    v_add_f32_dpp v216, v216, v216 row_half_mirror row_mask:0xf bank_mask:0xf
    v_add_f32_dpp v217, v217, v217 row_half_mirror row_mask:0xf bank_mask:0xf
    v_and_b32 v8, 1, v0
    v_cmp_eq_u32 vcc, 0, v8
    v_lshl_add_u32 v9, v8, 3, v9
    v_lshlrev_b32 v9, 4, v9
    s_mov_b32 s7, 0xbfb8aa3b
    v_cndmask_b32 v7, v217, v216, vcc
    v_mul_f32 v7, s7, v7
    v_exp_f32 v7, v7
    v_mov_b32 v13, 0
    v_add_f32 v7, 1.0, v7
    v_rcp_f32 v12, v7
    v_mov_b32 v14, v2
    v_mov_b32 v15, v3
    s_lshl_b32 s3, s6, 8
    s_add_u32 s3, s3, 20971520
    s_mov_b32 exec_lo, 0x03030303
    s_mov_b32 exec_hi, 0x03030303
    buffer_store_dwordx4 v[12:15], v9, s[8:11], s3 offen sc1
    s_mov_b64 exec, -1
    s_cmp_lt_u32 s16, 4
    s_cbranch_scc1 .Lsp03_38
    v_mov_b32 v8, v64
    v_mov_b32 v9, v65
    v_mov_b32 v10, v66
    v_mov_b32 v11, v67
    v_mov_b32 v12, v68
    v_mov_b32 v13, v69
    v_mov_b32 v14, v70
    v_mov_b32 v15, v71
    v_mov_b32 v28, v72
    v_mov_b32 v29, v73
    v_mov_b32 v30, v74
    v_mov_b32 v31, v75
    v_mov_b32 v32, v76
    v_mov_b32 v33, v77
    v_mov_b32 v34, v78
    v_mov_b32 v35, v79
    v_mov_b32 v36, v80
    v_mov_b32 v37, v81
    v_mov_b32 v38, v82
    v_mov_b32 v39, v83
    s_mul_i32 s4, s21, 4088
    s_add_u32 s4, s4, 20967424
    s_lshl_b32 s5, s22, 9
    s_add_u32 s23, s5, s4
    s_mov_b32 s25, 1
    s_lshl_b32 s5, s16, 3
    s_add_u32 s5, s5, s90
    s_mul_i32 s5, s5, 25600
    s_add_u32 s24, s5, 21577728
    s_mov_b32 s82, 1
    v_mov_b32 v4, v2
    v_mov_b32 v5, v3
    s_mov_b64 exec, 0xf33ffff
    buffer_load_dwordx2 v[4:5], v92, s[8:11], 0 offen sc1
    s_mov_b64 exec, -1
    s_waitcnt vmcnt(0)
    s_branch .Lktail_3
.Lsp03_38:
    s_mov_b32 s68, 0xffff
    s_mov_b32 s69, 0xffff0
    s_mov_b32 s70, 0x3fffc
    s_mov_b32 s71, 0x3fffc0
    s_mov_b32 s72, 0xffff00
    s_mov_b32 s73, 0xffff000
    s_mov_b32 s74, 0x3fffc00
    s_mov_b32 s75, 0x3fffc000
    s_mov_b32 s76, 0xffff0000
    s_mov_b32 s77, 0xfff0000f
    s_mov_b32 s78, 0xfffc0003
    s_mov_b32 s79, 0xffc0003f
    s_mov_b32 s80, 0xff0000ff
    s_mov_b32 s81, 0xf0000fff
    s_mov_b32 s82, 0xfc0003ff
    s_mov_b32 s83, 0xc0003fff
    s_cmp_eq_u32 s22, 0
    s_cbranch_scc1 .Lvbfirst_40
.Lvbok_39:
    s_mul_i32 s4, s21, 4088
    s_add_u32 s4, s4, 20967424
    s_lshl_b32 s5, s22, 9
    s_add_u32 s23, s5, s4
    s_mov_b32 s25, 1
    s_lshl_b32 s5, s16, 3
    s_add_u32 s5, s5, s90
    s_mul_i32 s5, s5, 25600
    s_add_u32 s24, s5, 21577728
    s_branch .Lp2b_4
.Lend_1:
    s_endpgm
.Lg0_5:
    v_and_b32 v24, 15, v0
    v_lshrrev_b32 v25, 4, v0
    v_lshrrev_b32 v26, 1, v24
    v_xor_b32 v26, v26, v25
    v_lshlrev_b32 v26, 4, v26
    v_lshl_add_u32 v26, v24, 7, v26
    s_lshl_b32 s3, s16, 12
    s_add_u32 s3, s3, 99840
    v_add_u32 v2, s3, v26
    v_xor_b32 v3, 64, v2
    v_bfe_u32 v26, v0, 2, 3
    v_mul_u32_u24 v26, 2080, v26
    v_lshrrev_b32 v27, 5, v0
    v_lshl_add_u32 v26, v27, 10, v26
    v_and_b32 v28, 3, v0
    v_lshl_add_u32 v4, v28, 3, v26
    v_add_u32 v5, 66560, v4
    v_and_b32 v26, 31, v0
    v_lshlrev_b32 v26, 4, v26
    v_lshl_add_u32 v26, v27, 11, v26
    s_lshl_b32 s3, s16, 9
    v_add_u32 v1, s3, v26
    s_add_u32 s6, s23, s24
    s_mul_i32 s7, s6, 86
    s_lshr_b32 s7, s7, 8
    s_mul_i32 s7, s7, 3
    s_sub_u32 s6, s6, s7
    s_lshl_b32 s6, s6, 2
    s_lshr_b32 s6, 0x730, s6
    s_and_b32 s25, s6, 15
    s_and_b32 s6, s2, 7
    s_lshl_b32 s6, s6, 2
    s_lshr_b32 s6, 0x31203120, s6
    s_and_b32 s6, s6, 15
    s_add_u32 s6, s6, s25
    s_cmp_ge_u32 s6, 10
    s_cselect_b32 s7, 10, 0
    s_sub_u32 s25, s6, s7
    s_waitcnt lgkmcnt(0)
    s_mov_b32 s76, s44
    s_and_b32 s77, s45, 0xffff
    s_mov_b32 s78, 0x258000
    s_mov_b32 s79, 0x20000
    s_and_b32 s3, s23, 7
    s_lshl_b32 s3, s3, 2
    s_add_u32 s3, s3, s16
    s_mul_i32 s3, s3, 76800
    s_lshl_b32 s4, s24, 8
    s_add_u32 s75, s3, s4
    v_lshrrev_b32 v254, 1, v0
    v_mul_u32_u24 v254, 3840, v254
    v_and_b32 v255, 1, v0
    v_lshl_add_u32 v254, v255, 7, v254
    s_mov_b32 s8, s54
    s_and_b32 s9, s55, 0xffff
    s_mov_b32 s10, 0x2000000
    s_mov_b32 s11, 0x20000
    s_mov_b32 s12, s50
    s_and_b32 s13, s51, 0xffff
    s_mov_b32 s14, 0x280000
    s_mov_b32 s15, 0x20000
    s_mov_b32 s32, s52
    s_and_b32 s33, s53, 0xffff
    s_mov_b32 s34, 0x100
    s_mov_b32 s35, 0x20000
    s_and_b32 s3, s2, 7
    s_lshr_b32 s4, s2, 3
    s_and_b32 s7, s4, 3
    s_lshl_b32 s3, s3, 2
    s_add_u32 s18, s3, s7
    s_lshr_b32 s19, s4, 2
    s_bfe_u32 s3, s2, 0x20001
    s_lshl_b32 s3, s3, 3
    s_and_b32 s6, s4, 7
    s_add_u32 s99, s3, s6
    s_and_b32 s3, s2, 1
    s_lshl_b32 s3, s3, 2
    s_lshr_b32 s6, s4, 3
    s_add_u32 s90, s3, s6
    s_and_b32 s21, s18, 1
    s_lshr_b32 s3, s18, 1
    s_mul_i32 s3, s3, 5
    s_lshl_b32 s6, s21, 1
    s_add_u32 s20, s3, s6
    s_lshl_b32 s3, s19, 3
    s_add_u32 s22, s3, s16
    s_lshl_b32 s3, s2, 3
    s_add_u32 s3, s3, s16
    s_lshl_b32 s3, s3, 7
    s_add_u32 s17, s3, 21315584
    s_mov_b32 s36, 0xffffffff
    s_mov_b32 s37, 0xfffffff0
    s_mov_b32 s38, 0xfffffffe
    s_mov_b32 s39, 0xffffffe0
    s_mov_b32 s40, 0xfffffffc
    s_mov_b32 s41, 0xffffffc0
    s_mov_b32 s42, 0xfffffff8
    s_mov_b32 s43, 0xffffff80
    s_mov_b32 s44, 0xffffff00
    s_mov_b32 s45, 0xfffff000
    s_mov_b32 s46, 0xfffffe00
    s_mov_b32 s47, 0xffffe000
    s_mov_b32 s48, 0xfffffc00
    s_mov_b32 s49, 0xffffc000
    s_mov_b32 s50, 0xfffff800
    s_mov_b32 s51, 0xffff8000
    s_mov_b32 s52, 0xffff0000
    s_mov_b32 s53, 0xfff00000
    s_mov_b32 s54, 0xfffe0000
    s_mov_b32 s55, 0xffe00000
    s_mov_b32 s56, 0xfffc0000
    s_mov_b32 s57, 0xffc00000
    s_mov_b32 s58, 0xfff80000
    s_mov_b32 s59, 0xff800000
    s_mov_b32 s60, 0xff000000
    s_mov_b32 s61, 0xf0000000
    s_mov_b32 s62, 0xfe000000
    s_mov_b32 s63, 0xe0000000
    s_mov_b32 s64, 0xfc000000
    s_mov_b32 s65, 0xc0000000
    s_mov_b32 s66, 0xf8000000
    s_mov_b32 s67, 0x80000000
    s_xor_b32 s3, s2, 1
    s_or_b32 s3, s3, s16
    s_cbranch_scc1 .Lnononce_41
    s_memrealtime s[4:5]
    s_waitcnt lgkmcnt(0)
    s_or_b32 s4, s4, 1
    v_mov_b32 v8, s4
    v_mov_b32 v9, s5
    v_mov_b32 v10, 0
    v_mov_b32 v11, 0
    s_mov_b64 exec, 1
    buffer_atomic_cmpswap_x2 v[8:11], off, s[32:35], 0 sc1
    s_mov_b64 exec, -1
.Lnononce_41:
    s_mul_i32 s27, s23, 491520
    s_lshl_b32 s3, s24, 15
    s_add_u32 s27, s27, s3
    s_cmp_lt_u32 s24, 5
    s_cselect_b32 s0, 0x3ea52b5c, 1.0
    s_mov_b32 s1, s0
    s_lshl_b32 s3, s23, 2
    s_add_u32 s3, s3, s16
    s_lshl_b32 s4, s3, 4
    s_add_u32 s4, s4, s24
    s_lshl_b32 s5, s4, 7
    s_add_u32 s70, s5, 21004288
    s_add_u32 s17, s5, 21135360
    v_mov_b32 v8, 0
    v_mov_b32 v9, 0
    v_mov_b32 v10, 0
    v_mov_b32 v11, 0
    v_and_b32 v12, 7, v0
    v_lshlrev_b32 v12, 4, v12
    v_bfe_u32 v13, v0, 3, 1
    v_mul_u32_u24 v14, 131072, v13
    v_add_u32 v14, v14, v12
    s_mov_b64 exec, 0xffff
    buffer_store_dwordx4 v[8:11], v14, s[8:11], s70 offen sc1
    s_mov_b64 exec, -1
    s_and_b32 s3, s23, 1
    s_lshr_b32 s4, s24, 2
    s_or_b32 s3, s3, s4
    s_or_b32 s73, s3, s16
    s_lshl_b32 s3, s23, 1
    s_add_u32 s3, s3, s24
    s_lshl_b32 s3, s3, 10
    s_add_u32 s74, s3, 21266432
    s_lshl_b32 s71, s24, 8
    s_mul_i32 s68, s16, 2080
    s_lshl_b32 s5, s16, 3
    s_add_u32 s5, s5, s90
    s_mul_i32 s5, s5, 25600
    s_add_u32 s24, s5, 21577728
    s_sub_u32 s26, 8, s16
    s_cmp_eq_u32 s19, 0
    s_cselect_b32 s26, s26, 0
    s_lshr_b32 s3, s22, 2
    s_mul_i32 s3, s3, 491520
    s_and_b32 s4, s22, 3
    s_lshl_b32 s4, s4, 9
    s_add_u32 s3, s3, s4
    s_lshl_b32 s5, s20, 11
    s_add_u32 s5, s5, 7864320
    s_add_u32 s28, s3, s5
    s_sub_u32 s3, s22, 1
    s_max_i32 s4, s3, 0
    s_lshr_b32 s3, s4, 2
    s_mul_i32 s3, s3, 491520
    s_and_b32 s4, s4, 3
    s_lshl_b32 s4, s4, 9
    s_add_u32 s3, s3, s4
    s_add_u32 s29, s3, s5
    s_lshl_b32 s3, s22, 5
    s_add_u32 s3, s3, s18
    s_mul_i32 s4, s3, 1280
    s_add_u32 s30, s4, 15728640
    s_lshl_b32 s3, s19, 2
    s_lshr_b32 s4, s18, 3
    s_add_u32 s3, s3, s4
    s_lshl_b32 s3, s3, 2
    s_lshr_b32 s4, s16, 1
    s_add_u32 s3, s3, s4
    s_lshl_b32 s3, s3, 8
    s_add_u32 s31, s3, 21266432
    s_mul_i32 s4, s21, 4088
    s_add_u32 s4, s4, 20967424
    s_lshl_b32 s5, s22, 9
    s_add_u32 s23, s5, s4
    s_barrier
    ds_read_b128 v[96:99], v2 offset:0
    ds_read_b128 v[100:103], v2 offset:2048
    ds_read_b128 v[104:107], v3 offset:0
    ds_read_b128 v[108:111], v3 offset:2048
    ds_read_b64_tr_b16 v[8:9], v4 offset:0
    ds_read_b64_tr_b16 v[10:11], v4 offset:256
    ds_read_b64_tr_b16 v[12:13], v4 offset:32
    ds_read_b64_tr_b16 v[14:15], v4 offset:288
    ds_read_b64_tr_b16 v[16:17], v4 offset:64
    ds_read_b64_tr_b16 v[18:19], v4 offset:320
    ds_read_b64_tr_b16 v[20:21], v4 offset:96
    ds_read_b64_tr_b16 v[22:23], v4 offset:352
    ds_read_b64_tr_b16 v[24:25], v4 offset:128
    ds_read_b64_tr_b16 v[26:27], v4 offset:384
    s_waitcnt lgkmcnt(8)
    v_mfma_f32_16x16x32_bf16 v[32:35], v[8:11], v[96:99], 0
    ds_read_b64_tr_b16 v[28:29], v4 offset:160
    v_mfma_f32_16x16x32_bf16 v[36:39], v[8:11], v[100:103], 0
    ds_read_b64_tr_b16 v[30:31], v4 offset:416
    s_waitcnt lgkmcnt(8)
    v_mfma_f32_16x16x32_bf16 v[40:43], v[12:15], v[96:99], 0
    ds_read_b64_tr_b16 v[8:9], v4 offset:192
    v_mfma_f32_16x16x32_bf16 v[44:47], v[12:15], v[100:103], 0
    ds_read_b64_tr_b16 v[10:11], v4 offset:448
    s_waitcnt lgkmcnt(8)
    v_mfma_f32_16x16x32_bf16 v[48:51], v[16:19], v[96:99], 0
    ds_read_b64_tr_b16 v[12:13], v4 offset:224
    v_mfma_f32_16x16x32_bf16 v[52:55], v[16:19], v[100:103], 0
    ds_read_b64_tr_b16 v[14:15], v4 offset:480
    s_waitcnt lgkmcnt(8)
    v_mfma_f32_16x16x32_bf16 v[56:59], v[20:23], v[96:99], 0
    ds_read_b64_tr_b16 v[16:17], v4 offset:512
    v_mfma_f32_16x16x32_bf16 v[60:63], v[20:23], v[100:103], 0
    ds_read_b64_tr_b16 v[18:19], v4 offset:768
    s_waitcnt lgkmcnt(8)
    v_mfma_f32_16x16x32_bf16 v[64:67], v[24:27], v[96:99], 0
    ds_read_b64_tr_b16 v[20:21], v4 offset:544
    v_mfma_f32_16x16x32_bf16 v[68:71], v[24:27], v[100:103], 0
    ds_read_b64_tr_b16 v[22:23], v4 offset:800
    s_waitcnt lgkmcnt(8)
    v_mfma_f32_16x16x32_bf16 v[72:75], v[28:31], v[96:99], 0
    ds_read_b64_tr_b16 v[24:25], v4 offset:576
    v_mfma_f32_16x16x32_bf16 v[76:79], v[28:31], v[100:103], 0
    ds_read_b64_tr_b16 v[26:27], v4 offset:832
    s_waitcnt lgkmcnt(8)
    v_mfma_f32_16x16x32_bf16 v[80:83], v[8:11], v[96:99], 0
    ds_read_b64_tr_b16 v[28:29], v4 offset:608
    v_mfma_f32_16x16x32_bf16 v[84:87], v[8:11], v[100:103], 0
    ds_read_b64_tr_b16 v[30:31], v4 offset:864
    s_waitcnt lgkmcnt(8)
    v_mfma_f32_16x16x32_bf16 v[88:91], v[12:15], v[96:99], 0
    ds_read_b64_tr_b16 v[8:9], v4 offset:640
    v_mfma_f32_16x16x32_bf16 v[92:95], v[12:15], v[100:103], 0
    ds_read_b64_tr_b16 v[10:11], v4 offset:896
    s_waitcnt lgkmcnt(8)
    v_mfma_f32_16x16x32_bf16 v[32:35], v[16:19], v[104:107], v[32:35]
    ds_read_b64_tr_b16 v[12:13], v4 offset:672
    v_mfma_f32_16x16x32_bf16 v[36:39], v[16:19], v[108:111], v[36:39]
    ds_read_b64_tr_b16 v[14:15], v4 offset:928
    s_waitcnt lgkmcnt(8)
    v_mfma_f32_16x16x32_bf16 v[40:43], v[20:23], v[104:107], v[40:43]
    ds_read_b64_tr_b16 v[16:17], v4 offset:704
    v_mfma_f32_16x16x32_bf16 v[44:47], v[20:23], v[108:111], v[44:47]
    ds_read_b64_tr_b16 v[18:19], v4 offset:960
    s_waitcnt lgkmcnt(8)
    v_mfma_f32_16x16x32_bf16 v[48:51], v[24:27], v[104:107], v[48:51]
    ds_read_b64_tr_b16 v[20:21], v4 offset:736
    v_mfma_f32_16x16x32_bf16 v[52:55], v[24:27], v[108:111], v[52:55]
    ds_read_b64_tr_b16 v[22:23], v4 offset:992
    s_waitcnt lgkmcnt(8)
    v_mfma_f32_16x16x32_bf16 v[56:59], v[28:31], v[104:107], v[56:59]
    s_barrier
    ds_read_b128 v[112:115], v2 offset:16640
    ds_read_b128 v[116:119], v2 offset:18688
    ds_read_b128 v[120:123], v3 offset:16640
    ds_read_b128 v[124:127], v3 offset:18688
    ds_read_b64_tr_b16 v[24:25], v4 offset:16640
    v_mfma_f32_16x16x32_bf16 v[60:63], v[28:31], v[108:111], v[60:63]
    ds_read_b64_tr_b16 v[26:27], v4 offset:16896
    s_waitcnt lgkmcnt(12)
    v_mfma_f32_16x16x32_bf16 v[64:67], v[8:11], v[104:107], v[64:67]
    ds_read_b64_tr_b16 v[28:29], v4 offset:16672
    v_mfma_f32_16x16x32_bf16 v[68:71], v[8:11], v[108:111], v[68:71]
    ds_read_b64_tr_b16 v[30:31], v4 offset:16928
    s_cmp_eq_u32 s16, 0
    s_cbranch_scc1 .Lwdo_43
    s_cmp_lg_u32 s16, 1
    s_cbranch_scc1 .Lwskip_42
.Lwdo_43:
    s_mov_b32 exec_hi, 0xff
    buffer_load_dword v252, v254, s[76:79], s75 offen
    s_mov_b32 exec_hi, -1
.Lwskip_42:
    s_waitcnt lgkmcnt(12)
    v_mfma_f32_16x16x32_bf16 v[72:75], v[12:15], v[104:107], v[72:75]
    ds_read_b64_tr_b16 v[8:9], v4 offset:16704
    v_mfma_f32_16x16x32_bf16 v[76:79], v[12:15], v[108:111], v[76:79]
    ds_read_b64_tr_b16 v[10:11], v4 offset:16960
    s_waitcnt lgkmcnt(12)
    v_mfma_f32_16x16x32_bf16 v[80:83], v[16:19], v[104:107], v[80:83]
    ds_read_b64_tr_b16 v[12:13], v4 offset:16736
    v_mfma_f32_16x16x32_bf16 v[84:87], v[16:19], v[108:111], v[84:87]
    ds_read_b64_tr_b16 v[14:15], v4 offset:16992
    s_waitcnt lgkmcnt(12)
    v_mfma_f32_16x16x32_bf16 v[88:91], v[20:23], v[104:107], v[88:91]
    ds_read_b64_tr_b16 v[16:17], v4 offset:16768
    v_mfma_f32_16x16x32_bf16 v[92:95], v[20:23], v[108:111], v[92:95]
    ds_read_b64_tr_b16 v[18:19], v4 offset:17024
    s_waitcnt lgkmcnt(8)
    v_mfma_f32_16x16x32_bf16 v[32:35], v[24:27], v[112:115], v[32:35]
    ds_read_b64_tr_b16 v[20:21], v4 offset:16800
    v_mfma_f32_16x16x32_bf16 v[36:39], v[24:27], v[116:119], v[36:39]
    ds_read_b64_tr_b16 v[22:23], v4 offset:17056
    s_waitcnt lgkmcnt(8)
    v_mfma_f32_16x16x32_bf16 v[40:43], v[28:31], v[112:115], v[40:43]
    ds_read_b64_tr_b16 v[24:25], v4 offset:16832
    v_mfma_f32_16x16x32_bf16 v[44:47], v[28:31], v[116:119], v[44:47]
    ds_read_b64_tr_b16 v[26:27], v4 offset:17088
    s_waitcnt lgkmcnt(8)
    v_mfma_f32_16x16x32_bf16 v[48:51], v[8:11], v[112:115], v[48:51]
    ds_read_b64_tr_b16 v[28:29], v4 offset:16864
    v_mfma_f32_16x16x32_bf16 v[52:55], v[8:11], v[116:119], v[52:55]
    ds_read_b64_tr_b16 v[30:31], v4 offset:17120
    s_waitcnt lgkmcnt(8)
    v_mfma_f32_16x16x32_bf16 v[56:59], v[12:15], v[112:115], v[56:59]
    ds_read_b64_tr_b16 v[8:9], v4 offset:17152
    v_mfma_f32_16x16x32_bf16 v[60:63], v[12:15], v[116:119], v[60:63]
    ds_read_b64_tr_b16 v[10:11], v4 offset:17408
    s_waitcnt lgkmcnt(8)
    v_mfma_f32_16x16x32_bf16 v[64:67], v[16:19], v[112:115], v[64:67]
    ds_read_b64_tr_b16 v[12:13], v4 offset:17184
    v_mfma_f32_16x16x32_bf16 v[68:71], v[16:19], v[116:119], v[68:71]
    ds_read_b64_tr_b16 v[14:15], v4 offset:17440
    s_waitcnt lgkmcnt(8)
    v_mfma_f32_16x16x32_bf16 v[72:75], v[20:23], v[112:115], v[72:75]
    ds_read_b64_tr_b16 v[16:17], v4 offset:17216
    v_mfma_f32_16x16x32_bf16 v[76:79], v[20:23], v[116:119], v[76:79]
    ds_read_b64_tr_b16 v[18:19], v4 offset:17472
    s_waitcnt lgkmcnt(8)
    v_mfma_f32_16x16x32_bf16 v[80:83], v[24:27], v[112:115], v[80:83]
    ds_read_b64_tr_b16 v[20:21], v4 offset:17248
    v_mfma_f32_16x16x32_bf16 v[84:87], v[24:27], v[116:119], v[84:87]
    ds_read_b64_tr_b16 v[22:23], v4 offset:17504
    s_waitcnt lgkmcnt(8)
    v_mfma_f32_16x16x32_bf16 v[88:91], v[28:31], v[112:115], v[88:91]
    ds_read_b64_tr_b16 v[24:25], v4 offset:17280
    v_mfma_f32_16x16x32_bf16 v[92:95], v[28:31], v[116:119], v[92:95]
    ds_read_b64_tr_b16 v[26:27], v4 offset:17536
    s_waitcnt lgkmcnt(8)
    v_mfma_f32_16x16x32_bf16 v[32:35], v[8:11], v[120:123], v[32:35]
    ds_read_b64_tr_b16 v[28:29], v4 offset:17312
    v_mfma_f32_16x16x32_bf16 v[36:39], v[8:11], v[124:127], v[36:39]
    ds_read_b64_tr_b16 v[30:31], v4 offset:17568
    s_waitcnt lgkmcnt(8)
    v_mfma_f32_16x16x32_bf16 v[40:43], v[12:15], v[120:123], v[40:43]
    ds_read_b64_tr_b16 v[8:9], v4 offset:17344
    v_mfma_f32_16x16x32_bf16 v[44:47], v[12:15], v[124:127], v[44:47]
    ds_read_b64_tr_b16 v[10:11], v4 offset:17600
    s_waitcnt lgkmcnt(8)
    v_mfma_f32_16x16x32_bf16 v[48:51], v[16:19], v[120:123], v[48:51]
    ds_read_b64_tr_b16 v[12:13], v4 offset:17376
    v_mfma_f32_16x16x32_bf16 v[52:55], v[16:19], v[124:127], v[52:55]
    ds_read_b64_tr_b16 v[14:15], v4 offset:17632
    s_waitcnt lgkmcnt(8)
    v_mfma_f32_16x16x32_bf16 v[56:59], v[20:23], v[120:123], v[56:59]
    s_barrier
    ds_read_b128 v[128:131], v2 offset:33280
    ds_read_b128 v[132:135], v2 offset:35328
    ds_read_b128 v[136:139], v3 offset:33280
    ds_read_b128 v[140:143], v3 offset:35328
    ds_read_b64_tr_b16 v[16:17], v4 offset:33280
    v_mfma_f32_16x16x32_bf16 v[60:63], v[20:23], v[124:127], v[60:63]
    ds_read_b64_tr_b16 v[18:19], v4 offset:33536
    s_waitcnt lgkmcnt(12)
    v_mfma_f32_16x16x32_bf16 v[64:67], v[24:27], v[120:123], v[64:67]
    ds_read_b64_tr_b16 v[20:21], v4 offset:33312
    v_mfma_f32_16x16x32_bf16 v[68:71], v[24:27], v[124:127], v[68:71]
    ds_read_b64_tr_b16 v[22:23], v4 offset:33568
    s_waitcnt lgkmcnt(12)
    v_mfma_f32_16x16x32_bf16 v[72:75], v[28:31], v[120:123], v[72:75]
    ds_read_b64_tr_b16 v[24:25], v4 offset:33344
    v_mfma_f32_16x16x32_bf16 v[76:79], v[28:31], v[124:127], v[76:79]
    ds_read_b64_tr_b16 v[26:27], v4 offset:33600
    s_waitcnt lgkmcnt(12)
    v_mfma_f32_16x16x32_bf16 v[80:83], v[8:11], v[120:123], v[80:83]
    ds_read_b64_tr_b16 v[28:29], v4 offset:33376
    v_mfma_f32_16x16x32_bf16 v[84:87], v[8:11], v[124:127], v[84:87]
    ds_read_b64_tr_b16 v[30:31], v4 offset:33632
    s_waitcnt lgkmcnt(12)
    v_mfma_f32_16x16x32_bf16 v[88:91], v[12:15], v[120:123], v[88:91]
    ds_read_b64_tr_b16 v[8:9], v4 offset:33408
    v_mfma_f32_16x16x32_bf16 v[92:95], v[12:15], v[124:127], v[92:95]
    ds_read_b64_tr_b16 v[10:11], v4 offset:33664
    s_waitcnt lgkmcnt(8)
    v_mfma_f32_16x16x32_bf16 v[32:35], v[16:19], v[128:131], v[32:35]
    ds_read_b64_tr_b16 v[12:13], v4 offset:33440
    v_mfma_f32_16x16x32_bf16 v[36:39], v[16:19], v[132:135], v[36:39]
    ds_read_b64_tr_b16 v[14:15], v4 offset:33696
    s_waitcnt lgkmcnt(8)
    v_mfma_f32_16x16x32_bf16 v[40:43], v[20:23], v[128:131], v[40:43]
    ds_read_b64_tr_b16 v[16:17], v4 offset:33472
    v_mfma_f32_16x16x32_bf16 v[44:47], v[20:23], v[132:135], v[44:47]
    ds_read_b64_tr_b16 v[18:19], v4 offset:33728
    s_waitcnt lgkmcnt(8)
    v_mfma_f32_16x16x32_bf16 v[48:51], v[24:27], v[128:131], v[48:51]
    ds_read_b64_tr_b16 v[20:21], v4 offset:33504
    v_mfma_f32_16x16x32_bf16 v[52:55], v[24:27], v[132:135], v[52:55]
    ds_read_b64_tr_b16 v[22:23], v4 offset:33760
    s_waitcnt lgkmcnt(8)
    v_mfma_f32_16x16x32_bf16 v[56:59], v[28:31], v[128:131], v[56:59]
    ds_read_b64_tr_b16 v[24:25], v4 offset:33792
    v_mfma_f32_16x16x32_bf16 v[60:63], v[28:31], v[132:135], v[60:63]
    ds_read_b64_tr_b16 v[26:27], v4 offset:34048
    s_waitcnt lgkmcnt(8)
    v_mfma_f32_16x16x32_bf16 v[64:67], v[8:11], v[128:131], v[64:67]
    ds_read_b64_tr_b16 v[28:29], v4 offset:33824
    v_mfma_f32_16x16x32_bf16 v[68:71], v[8:11], v[132:135], v[68:71]
    ds_read_b64_tr_b16 v[30:31], v4 offset:34080
    s_waitcnt lgkmcnt(8)
    v_mfma_f32_16x16x32_bf16 v[72:75], v[12:15], v[128:131], v[72:75]
    ds_read_b64_tr_b16 v[8:9], v4 offset:33856
    v_mfma_f32_16x16x32_bf16 v[76:79], v[12:15], v[132:135], v[76:79]
    ds_read_b64_tr_b16 v[10:11], v4 offset:34112
    s_waitcnt lgkmcnt(8)
    v_mfma_f32_16x16x32_bf16 v[80:83], v[16:19], v[128:131], v[80:83]
    ds_read_b64_tr_b16 v[12:13], v4 offset:33888
    v_mfma_f32_16x16x32_bf16 v[84:87], v[16:19], v[132:135], v[84:87]
    ds_read_b64_tr_b16 v[14:15], v4 offset:34144
    s_waitcnt lgkmcnt(8)
    v_mfma_f32_16x16x32_bf16 v[88:91], v[20:23], v[128:131], v[88:91]
    ds_read_b64_tr_b16 v[16:17], v4 offset:33920
    v_mfma_f32_16x16x32_bf16 v[92:95], v[20:23], v[132:135], v[92:95]
    ds_read_b64_tr_b16 v[18:19], v4 offset:34176
    s_waitcnt lgkmcnt(8)
    v_mfma_f32_16x16x32_bf16 v[32:35], v[24:27], v[136:139], v[32:35]
    ds_read_b64_tr_b16 v[20:21], v4 offset:33952
    v_mfma_f32_16x16x32_bf16 v[36:39], v[24:27], v[140:143], v[36:39]
    ds_read_b64_tr_b16 v[22:23], v4 offset:34208
    s_waitcnt lgkmcnt(8)
    v_mfma_f32_16x16x32_bf16 v[40:43], v[28:31], v[136:139], v[40:43]
    ds_read_b64_tr_b16 v[24:25], v4 offset:33984
    v_mfma_f32_16x16x32_bf16 v[44:47], v[28:31], v[140:143], v[44:47]
    ds_read_b64_tr_b16 v[26:27], v4 offset:34240
    s_waitcnt lgkmcnt(8)
    v_mfma_f32_16x16x32_bf16 v[48:51], v[8:11], v[136:139], v[48:51]
    ds_read_b64_tr_b16 v[28:29], v4 offset:34016
    v_mfma_f32_16x16x32_bf16 v[52:55], v[8:11], v[140:143], v[52:55]
    ds_read_b64_tr_b16 v[30:31], v4 offset:34272
    s_waitcnt lgkmcnt(8)
    v_mfma_f32_16x16x32_bf16 v[56:59], v[12:15], v[136:139], v[56:59]
    s_barrier
    ds_read_b128 v[144:147], v2 offset:0
    ds_read_b128 v[148:151], v2 offset:2048
    ds_read_b128 v[152:155], v3 offset:0
    ds_read_b128 v[156:159], v3 offset:2048
    ds_read_b64_tr_b16 v[8:9], v4 offset:49920
    v_mfma_f32_16x16x32_bf16 v[60:63], v[12:15], v[140:143], v[60:63]
    ds_read_b64_tr_b16 v[10:11], v4 offset:50176
    s_waitcnt lgkmcnt(12)
    v_mfma_f32_16x16x32_bf16 v[64:67], v[16:19], v[136:139], v[64:67]
    ds_read_b64_tr_b16 v[12:13], v4 offset:49952
    v_mfma_f32_16x16x32_bf16 v[68:71], v[16:19], v[140:143], v[68:71]
    ds_read_b64_tr_b16 v[14:15], v4 offset:50208
    s_cmp_eq_u32 s16, 2
    s_cbranch_scc1 .Lwdo_45
    s_cmp_lg_u32 s16, 3
    s_cbranch_scc1 .Lwskip_44
.Lwdo_45:
    s_mov_b32 exec_hi, 0xff
    buffer_load_dword v252, v254, s[76:79], s75 offen
    s_mov_b32 exec_hi, -1
.Lwskip_44:
    s_waitcnt lgkmcnt(12)
    v_mfma_f32_16x16x32_bf16 v[72:75], v[20:23], v[136:139], v[72:75]
    ds_read_b64_tr_b16 v[16:17], v4 offset:49984
    v_mfma_f32_16x16x32_bf16 v[76:79], v[20:23], v[140:143], v[76:79]
    ds_read_b64_tr_b16 v[18:19], v4 offset:50240
    s_waitcnt lgkmcnt(12)
    v_mfma_f32_16x16x32_bf16 v[80:83], v[24:27], v[136:139], v[80:83]
    ds_read_b64_tr_b16 v[20:21], v4 offset:50016
    v_mfma_f32_16x16x32_bf16 v[84:87], v[24:27], v[140:143], v[84:87]
    ds_read_b64_tr_b16 v[22:23], v4 offset:50272
    s_waitcnt lgkmcnt(12)
    v_mfma_f32_16x16x32_bf16 v[88:91], v[28:31], v[136:139], v[88:91]
    ds_read_b64_tr_b16 v[24:25], v4 offset:50048
    v_mfma_f32_16x16x32_bf16 v[92:95], v[28:31], v[140:143], v[92:95]
    ds_read_b64_tr_b16 v[26:27], v4 offset:50304
    s_waitcnt lgkmcnt(8)
    v_mfma_f32_16x16x32_bf16 v[32:35], v[8:11], v[144:147], v[32:35]
    ds_read_b64_tr_b16 v[28:29], v4 offset:50080
    v_mfma_f32_16x16x32_bf16 v[36:39], v[8:11], v[148:151], v[36:39]
    ds_read_b64_tr_b16 v[30:31], v4 offset:50336
    s_waitcnt lgkmcnt(8)
    v_mfma_f32_16x16x32_bf16 v[40:43], v[12:15], v[144:147], v[40:43]
    ds_read_b64_tr_b16 v[8:9], v4 offset:50112
    v_mfma_f32_16x16x32_bf16 v[44:47], v[12:15], v[148:151], v[44:47]
    ds_read_b64_tr_b16 v[10:11], v4 offset:50368
    s_waitcnt lgkmcnt(8)
    v_mfma_f32_16x16x32_bf16 v[48:51], v[16:19], v[144:147], v[48:51]
    ds_read_b64_tr_b16 v[12:13], v4 offset:50144
    v_mfma_f32_16x16x32_bf16 v[52:55], v[16:19], v[148:151], v[52:55]
    ds_read_b64_tr_b16 v[14:15], v4 offset:50400
    s_waitcnt lgkmcnt(8)
    v_mfma_f32_16x16x32_bf16 v[56:59], v[20:23], v[144:147], v[56:59]
    ds_read_b64_tr_b16 v[16:17], v4 offset:50432
    v_mfma_f32_16x16x32_bf16 v[60:63], v[20:23], v[148:151], v[60:63]
    ds_read_b64_tr_b16 v[18:19], v4 offset:50688
    s_waitcnt lgkmcnt(8)
    v_mfma_f32_16x16x32_bf16 v[64:67], v[24:27], v[144:147], v[64:67]
    ds_read_b64_tr_b16 v[20:21], v4 offset:50464
    v_mfma_f32_16x16x32_bf16 v[68:71], v[24:27], v[148:151], v[68:71]
    ds_read_b64_tr_b16 v[22:23], v4 offset:50720
    s_waitcnt lgkmcnt(8)
    v_mfma_f32_16x16x32_bf16 v[72:75], v[28:31], v[144:147], v[72:75]
    ds_read_b64_tr_b16 v[24:25], v4 offset:50496
    v_mfma_f32_16x16x32_bf16 v[76:79], v[28:31], v[148:151], v[76:79]
    ds_read_b64_tr_b16 v[26:27], v4 offset:50752
    s_waitcnt lgkmcnt(8)
    v_mfma_f32_16x16x32_bf16 v[80:83], v[8:11], v[144:147], v[80:83]
    ds_read_b64_tr_b16 v[28:29], v4 offset:50528
    v_mfma_f32_16x16x32_bf16 v[84:87], v[8:11], v[148:151], v[84:87]
    ds_read_b64_tr_b16 v[30:31], v4 offset:50784
    s_waitcnt lgkmcnt(8)
    v_mfma_f32_16x16x32_bf16 v[88:91], v[12:15], v[144:147], v[88:91]
    ds_read_b64_tr_b16 v[8:9], v4 offset:50560
    v_mfma_f32_16x16x32_bf16 v[92:95], v[12:15], v[148:151], v[92:95]
    ds_read_b64_tr_b16 v[10:11], v4 offset:50816
    s_waitcnt lgkmcnt(8)
    v_mfma_f32_16x16x32_bf16 v[32:35], v[16:19], v[152:155], v[32:35]
    ds_read_b64_tr_b16 v[12:13], v4 offset:50592
    v_mfma_f32_16x16x32_bf16 v[36:39], v[16:19], v[156:159], v[36:39]
    ds_read_b64_tr_b16 v[14:15], v4 offset:50848
    s_waitcnt lgkmcnt(8)
    v_mfma_f32_16x16x32_bf16 v[40:43], v[20:23], v[152:155], v[40:43]
    ds_read_b64_tr_b16 v[16:17], v4 offset:50624
    v_mfma_f32_16x16x32_bf16 v[44:47], v[20:23], v[156:159], v[44:47]
    ds_read_b64_tr_b16 v[18:19], v4 offset:50880
    s_waitcnt lgkmcnt(8)
    v_mfma_f32_16x16x32_bf16 v[48:51], v[24:27], v[152:155], v[48:51]
    ds_read_b64_tr_b16 v[20:21], v4 offset:50656
    v_mfma_f32_16x16x32_bf16 v[52:55], v[24:27], v[156:159], v[52:55]
    ds_read_b64_tr_b16 v[22:23], v4 offset:50912
    s_waitcnt lgkmcnt(8)
    v_mfma_f32_16x16x32_bf16 v[56:59], v[28:31], v[152:155], v[56:59]
    s_barrier
    ds_read_b128 v[160:163], v2 offset:16640
    ds_read_b128 v[164:167], v2 offset:18688
    ds_read_b128 v[168:171], v3 offset:16640
    ds_read_b128 v[172:175], v3 offset:18688
    ds_read_b64_tr_b16 v[24:25], v5 offset:0
    v_mfma_f32_16x16x32_bf16 v[60:63], v[28:31], v[156:159], v[60:63]
    ds_read_b64_tr_b16 v[26:27], v5 offset:256
    s_waitcnt lgkmcnt(12)
    v_mfma_f32_16x16x32_bf16 v[64:67], v[8:11], v[152:155], v[64:67]
    ds_read_b64_tr_b16 v[28:29], v5 offset:32
    v_mfma_f32_16x16x32_bf16 v[68:71], v[8:11], v[156:159], v[68:71]
    ds_read_b64_tr_b16 v[30:31], v5 offset:288
    s_waitcnt lgkmcnt(12)
    v_mfma_f32_16x16x32_bf16 v[72:75], v[12:15], v[152:155], v[72:75]
    ds_read_b64_tr_b16 v[8:9], v5 offset:64
    v_mfma_f32_16x16x32_bf16 v[76:79], v[12:15], v[156:159], v[76:79]
    ds_read_b64_tr_b16 v[10:11], v5 offset:320
    s_waitcnt lgkmcnt(12)
    v_mfma_f32_16x16x32_bf16 v[80:83], v[16:19], v[152:155], v[80:83]
    ds_read_b64_tr_b16 v[12:13], v5 offset:96
    v_mfma_f32_16x16x32_bf16 v[84:87], v[16:19], v[156:159], v[84:87]
    ds_read_b64_tr_b16 v[14:15], v5 offset:352
    s_waitcnt lgkmcnt(12)
    v_mfma_f32_16x16x32_bf16 v[88:91], v[20:23], v[152:155], v[88:91]
    ds_read_b64_tr_b16 v[16:17], v5 offset:128
    v_mfma_f32_16x16x32_bf16 v[92:95], v[20:23], v[156:159], v[92:95]
    ds_read_b64_tr_b16 v[18:19], v5 offset:384
    s_waitcnt lgkmcnt(8)
    v_mfma_f32_16x16x32_bf16 v[32:35], v[24:27], v[160:163], v[32:35]
    ds_read_b64_tr_b16 v[20:21], v5 offset:160
    v_mfma_f32_16x16x32_bf16 v[36:39], v[24:27], v[164:167], v[36:39]
    ds_read_b64_tr_b16 v[22:23], v5 offset:416
    s_waitcnt lgkmcnt(8)
    v_mfma_f32_16x16x32_bf16 v[40:43], v[28:31], v[160:163], v[40:43]
    ds_read_b64_tr_b16 v[24:25], v5 offset:192
    v_mfma_f32_16x16x32_bf16 v[44:47], v[28:31], v[164:167], v[44:47]
    ds_read_b64_tr_b16 v[26:27], v5 offset:448
    s_waitcnt lgkmcnt(8)
    v_mfma_f32_16x16x32_bf16 v[48:51], v[8:11], v[160:163], v[48:51]
    ds_read_b64_tr_b16 v[28:29], v5 offset:224
    v_mfma_f32_16x16x32_bf16 v[52:55], v[8:11], v[164:167], v[52:55]
    ds_read_b64_tr_b16 v[30:31], v5 offset:480
    s_waitcnt lgkmcnt(8)
    v_mfma_f32_16x16x32_bf16 v[56:59], v[12:15], v[160:163], v[56:59]
    ds_read_b64_tr_b16 v[8:9], v5 offset:512
    v_mfma_f32_16x16x32_bf16 v[60:63], v[12:15], v[164:167], v[60:63]
    ds_read_b64_tr_b16 v[10:11], v5 offset:768
    s_waitcnt lgkmcnt(8)
    v_mfma_f32_16x16x32_bf16 v[64:67], v[16:19], v[160:163], v[64:67]
    ds_read_b64_tr_b16 v[12:13], v5 offset:544
    v_mfma_f32_16x16x32_bf16 v[68:71], v[16:19], v[164:167], v[68:71]
    ds_read_b64_tr_b16 v[14:15], v5 offset:800
    s_waitcnt lgkmcnt(8)
    v_mfma_f32_16x16x32_bf16 v[72:75], v[20:23], v[160:163], v[72:75]
    ds_read_b64_tr_b16 v[16:17], v5 offset:576
    v_mfma_f32_16x16x32_bf16 v[76:79], v[20:23], v[164:167], v[76:79]
    ds_read_b64_tr_b16 v[18:19], v5 offset:832
    s_waitcnt lgkmcnt(8)
    v_mfma_f32_16x16x32_bf16 v[80:83], v[24:27], v[160:163], v[80:83]
    ds_read_b64_tr_b16 v[20:21], v5 offset:608
    v_mfma_f32_16x16x32_bf16 v[84:87], v[24:27], v[164:167], v[84:87]
    ds_read_b64_tr_b16 v[22:23], v5 offset:864
    s_waitcnt lgkmcnt(8)
    v_mfma_f32_16x16x32_bf16 v[88:91], v[28:31], v[160:163], v[88:91]
    ds_read_b64_tr_b16 v[24:25], v5 offset:640
    v_mfma_f32_16x16x32_bf16 v[92:95], v[28:31], v[164:167], v[92:95]
    ds_read_b64_tr_b16 v[26:27], v5 offset:896
    s_waitcnt lgkmcnt(8)
    v_mfma_f32_16x16x32_bf16 v[32:35], v[8:11], v[168:171], v[32:35]
    ds_read_b64_tr_b16 v[28:29], v5 offset:672
    v_mfma_f32_16x16x32_bf16 v[36:39], v[8:11], v[172:175], v[36:39]
    ds_read_b64_tr_b16 v[30:31], v5 offset:928
    s_waitcnt lgkmcnt(8)
    v_mfma_f32_16x16x32_bf16 v[40:43], v[12:15], v[168:171], v[40:43]
    ds_read_b64_tr_b16 v[8:9], v5 offset:704
    v_mfma_f32_16x16x32_bf16 v[44:47], v[12:15], v[172:175], v[44:47]
    ds_read_b64_tr_b16 v[10:11], v5 offset:960
    s_waitcnt lgkmcnt(8)
    v_mfma_f32_16x16x32_bf16 v[48:51], v[16:19], v[168:171], v[48:51]
    ds_read_b64_tr_b16 v[12:13], v5 offset:736
    v_mfma_f32_16x16x32_bf16 v[52:55], v[16:19], v[172:175], v[52:55]
    ds_read_b64_tr_b16 v[14:15], v5 offset:992
    s_waitcnt lgkmcnt(8)
    v_mfma_f32_16x16x32_bf16 v[56:59], v[20:23], v[168:171], v[56:59]
    s_barrier
    ds_read_b128 v[176:179], v2 offset:33280
    ds_read_b128 v[180:183], v2 offset:35328
    ds_read_b128 v[184:187], v3 offset:33280
    ds_read_b128 v[188:191], v3 offset:35328
    ds_read_b64_tr_b16 v[16:17], v5 offset:16640
    v_mfma_f32_16x16x32_bf16 v[60:63], v[20:23], v[172:175], v[60:63]
    ds_read_b64_tr_b16 v[18:19], v5 offset:16896
    s_waitcnt lgkmcnt(12)
    v_mfma_f32_16x16x32_bf16 v[64:67], v[24:27], v[168:171], v[64:67]
    ds_read_b64_tr_b16 v[20:21], v5 offset:16672
    v_mfma_f32_16x16x32_bf16 v[68:71], v[24:27], v[172:175], v[68:71]
    ds_read_b64_tr_b16 v[22:23], v5 offset:16928
    s_waitcnt lgkmcnt(12)
    v_mfma_f32_16x16x32_bf16 v[72:75], v[28:31], v[168:171], v[72:75]
    ds_read_b64_tr_b16 v[24:25], v5 offset:16704
    v_mfma_f32_16x16x32_bf16 v[76:79], v[28:31], v[172:175], v[76:79]
    ds_read_b64_tr_b16 v[26:27], v5 offset:16960
    s_waitcnt lgkmcnt(12)
    v_mfma_f32_16x16x32_bf16 v[80:83], v[8:11], v[168:171], v[80:83]
    ds_read_b64_tr_b16 v[28:29], v5 offset:16736
    v_mfma_f32_16x16x32_bf16 v[84:87], v[8:11], v[172:175], v[84:87]
    ds_read_b64_tr_b16 v[30:31], v5 offset:16992
    s_waitcnt lgkmcnt(12)
    v_mfma_f32_16x16x32_bf16 v[88:91], v[12:15], v[168:171], v[88:91]
    ds_read_b64_tr_b16 v[8:9], v5 offset:16768
    v_mfma_f32_16x16x32_bf16 v[92:95], v[12:15], v[172:175], v[92:95]
    ds_read_b64_tr_b16 v[10:11], v5 offset:17024
    s_waitcnt lgkmcnt(8)
    v_mfma_f32_16x16x32_bf16 v[32:35], v[16:19], v[176:179], v[32:35]
    ds_read_b64_tr_b16 v[12:13], v5 offset:16800
    v_mfma_f32_16x16x32_bf16 v[36:39], v[16:19], v[180:183], v[36:39]
    ds_read_b64_tr_b16 v[14:15], v5 offset:17056
    s_waitcnt lgkmcnt(8)
    v_mfma_f32_16x16x32_bf16 v[40:43], v[20:23], v[176:179], v[40:43]
    ds_read_b64_tr_b16 v[16:17], v5 offset:16832
    v_mfma_f32_16x16x32_bf16 v[44:47], v[20:23], v[180:183], v[44:47]
    ds_read_b64_tr_b16 v[18:19], v5 offset:17088
    s_waitcnt lgkmcnt(8)
    v_mfma_f32_16x16x32_bf16 v[48:51], v[24:27], v[176:179], v[48:51]
    ds_read_b64_tr_b16 v[20:21], v5 offset:16864
    v_mfma_f32_16x16x32_bf16 v[52:55], v[24:27], v[180:183], v[52:55]
    ds_read_b64_tr_b16 v[22:23], v5 offset:17120
    s_waitcnt lgkmcnt(8)
    v_mfma_f32_16x16x32_bf16 v[56:59], v[28:31], v[176:179], v[56:59]
    ds_read_b64_tr_b16 v[24:25], v5 offset:17152
    v_mfma_f32_16x16x32_bf16 v[60:63], v[28:31], v[180:183], v[60:63]
    ds_read_b64_tr_b16 v[26:27], v5 offset:17408
    s_waitcnt lgkmcnt(8)
    v_mfma_f32_16x16x32_bf16 v[64:67], v[8:11], v[176:179], v[64:67]
    ds_read_b64_tr_b16 v[28:29], v5 offset:17184
    v_mfma_f32_16x16x32_bf16 v[68:71], v[8:11], v[180:183], v[68:71]
    ds_read_b64_tr_b16 v[30:31], v5 offset:17440
    s_waitcnt lgkmcnt(8)
    v_mfma_f32_16x16x32_bf16 v[72:75], v[12:15], v[176:179], v[72:75]
    ds_read_b64_tr_b16 v[8:9], v5 offset:17216
    v_mfma_f32_16x16x32_bf16 v[76:79], v[12:15], v[180:183], v[76:79]
    ds_read_b64_tr_b16 v[10:11], v5 offset:17472
    s_waitcnt lgkmcnt(8)
    v_mfma_f32_16x16x32_bf16 v[80:83], v[16:19], v[176:179], v[80:83]
    ds_read_b64_tr_b16 v[12:13], v5 offset:17248
    v_mfma_f32_16x16x32_bf16 v[84:87], v[16:19], v[180:183], v[84:87]
    ds_read_b64_tr_b16 v[14:15], v5 offset:17504
    s_waitcnt lgkmcnt(8)
    v_mfma_f32_16x16x32_bf16 v[88:91], v[20:23], v[176:179], v[88:91]
    ds_read_b64_tr_b16 v[16:17], v5 offset:17280
    v_mfma_f32_16x16x32_bf16 v[92:95], v[20:23], v[180:183], v[92:95]
    ds_read_b64_tr_b16 v[18:19], v5 offset:17536
    s_waitcnt lgkmcnt(8)
    v_mfma_f32_16x16x32_bf16 v[32:35], v[24:27], v[184:187], v[32:35]
    ds_read_b64_tr_b16 v[20:21], v5 offset:17312
    v_mfma_f32_16x16x32_bf16 v[36:39], v[24:27], v[188:191], v[36:39]
    ds_read_b64_tr_b16 v[22:23], v5 offset:17568
    s_waitcnt lgkmcnt(8)
    v_mfma_f32_16x16x32_bf16 v[40:43], v[28:31], v[184:187], v[40:43]
    ds_read_b64_tr_b16 v[24:25], v5 offset:17344
    v_mfma_f32_16x16x32_bf16 v[44:47], v[28:31], v[188:191], v[44:47]
    ds_read_b64_tr_b16 v[26:27], v5 offset:17600
    s_waitcnt lgkmcnt(8)
    v_mfma_f32_16x16x32_bf16 v[48:51], v[8:11], v[184:187], v[48:51]
    ds_read_b64_tr_b16 v[28:29], v5 offset:17376
    v_mfma_f32_16x16x32_bf16 v[52:55], v[8:11], v[188:191], v[52:55]
    ds_read_b64_tr_b16 v[30:31], v5 offset:17632
    s_waitcnt lgkmcnt(8)
    v_mfma_f32_16x16x32_bf16 v[56:59], v[12:15], v[184:187], v[56:59]
    s_barrier
    ds_read_b128 v[192:195], v2 offset:0
    ds_read_b128 v[196:199], v2 offset:2048
    ds_read_b128 v[200:203], v3 offset:0
    ds_read_b128 v[204:207], v3 offset:2048
    ds_read_b64_tr_b16 v[8:9], v4 offset:0
    v_mfma_f32_16x16x32_bf16 v[60:63], v[12:15], v[188:191], v[60:63]
    ds_read_b64_tr_b16 v[10:11], v4 offset:256
    s_waitcnt lgkmcnt(12)
    v_mfma_f32_16x16x32_bf16 v[64:67], v[16:19], v[184:187], v[64:67]
    ds_read_b64_tr_b16 v[12:13], v4 offset:32
    v_mfma_f32_16x16x32_bf16 v[68:71], v[16:19], v[188:191], v[68:71]
    ds_read_b64_tr_b16 v[14:15], v4 offset:288
    s_waitcnt lgkmcnt(12)
    v_mfma_f32_16x16x32_bf16 v[72:75], v[20:23], v[184:187], v[72:75]
    ds_read_b64_tr_b16 v[16:17], v4 offset:64
    v_mfma_f32_16x16x32_bf16 v[76:79], v[20:23], v[188:191], v[76:79]
    ds_read_b64_tr_b16 v[18:19], v4 offset:320
    s_waitcnt lgkmcnt(12)
    v_mfma_f32_16x16x32_bf16 v[80:83], v[24:27], v[184:187], v[80:83]
    ds_read_b64_tr_b16 v[20:21], v4 offset:96
    v_mfma_f32_16x16x32_bf16 v[84:87], v[24:27], v[188:191], v[84:87]
    ds_read_b64_tr_b16 v[22:23], v4 offset:352
    s_waitcnt lgkmcnt(12)
    v_mfma_f32_16x16x32_bf16 v[88:91], v[28:31], v[184:187], v[88:91]
    ds_read_b64_tr_b16 v[24:25], v4 offset:128
    v_mfma_f32_16x16x32_bf16 v[92:95], v[28:31], v[188:191], v[92:95]
    ds_read_b64_tr_b16 v[26:27], v4 offset:384
    s_waitcnt lgkmcnt(8)
    v_mfma_f32_16x16x32_bf16 v[32:35], v[8:11], v[192:195], v[32:35]
    ds_read_b64_tr_b16 v[28:29], v4 offset:160
    v_mfma_f32_16x16x32_bf16 v[36:39], v[8:11], v[196:199], v[36:39]
    ds_read_b64_tr_b16 v[30:31], v4 offset:416
    s_waitcnt lgkmcnt(8)
    v_mfma_f32_16x16x32_bf16 v[40:43], v[12:15], v[192:195], v[40:43]
    ds_read_b64_tr_b16 v[8:9], v4 offset:192
    v_mfma_f32_16x16x32_bf16 v[44:47], v[12:15], v[196:199], v[44:47]
    ds_read_b64_tr_b16 v[10:11], v4 offset:448
    s_waitcnt lgkmcnt(8)
    v_mfma_f32_16x16x32_bf16 v[48:51], v[16:19], v[192:195], v[48:51]
    ds_read_b64_tr_b16 v[12:13], v4 offset:224
    v_mfma_f32_16x16x32_bf16 v[52:55], v[16:19], v[196:199], v[52:55]
    ds_read_b64_tr_b16 v[14:15], v4 offset:480
    s_waitcnt lgkmcnt(8)
    v_mfma_f32_16x16x32_bf16 v[56:59], v[20:23], v[192:195], v[56:59]
    ds_read_b64_tr_b16 v[16:17], v4 offset:512
    v_mfma_f32_16x16x32_bf16 v[60:63], v[20:23], v[196:199], v[60:63]
    ds_read_b64_tr_b16 v[18:19], v4 offset:768
    s_waitcnt lgkmcnt(8)
    v_mfma_f32_16x16x32_bf16 v[64:67], v[24:27], v[192:195], v[64:67]
    ds_read_b64_tr_b16 v[20:21], v4 offset:544
    v_mfma_f32_16x16x32_bf16 v[68:71], v[24:27], v[196:199], v[68:71]
    ds_read_b64_tr_b16 v[22:23], v4 offset:800
    s_waitcnt lgkmcnt(8)
    v_mfma_f32_16x16x32_bf16 v[72:75], v[28:31], v[192:195], v[72:75]
    ds_read_b64_tr_b16 v[24:25], v4 offset:576
    v_mfma_f32_16x16x32_bf16 v[76:79], v[28:31], v[196:199], v[76:79]
    ds_read_b64_tr_b16 v[26:27], v4 offset:832
    s_waitcnt lgkmcnt(8)
    v_mfma_f32_16x16x32_bf16 v[80:83], v[8:11], v[192:195], v[80:83]
    ds_read_b64_tr_b16 v[28:29], v4 offset:608
    v_mfma_f32_16x16x32_bf16 v[84:87], v[8:11], v[196:199], v[84:87]
    ds_read_b64_tr_b16 v[30:31], v4 offset:864
    s_waitcnt lgkmcnt(8)
    v_mfma_f32_16x16x32_bf16 v[88:91], v[12:15], v[192:195], v[88:91]
    ds_read_b64_tr_b16 v[8:9], v4 offset:640
    v_mfma_f32_16x16x32_bf16 v[92:95], v[12:15], v[196:199], v[92:95]
    ds_read_b64_tr_b16 v[10:11], v4 offset:896
    s_waitcnt lgkmcnt(8)
    v_mfma_f32_16x16x32_bf16 v[32:35], v[16:19], v[200:203], v[32:35]
    ds_read_b64_tr_b16 v[12:13], v4 offset:672
    v_mfma_f32_16x16x32_bf16 v[36:39], v[16:19], v[204:207], v[36:39]
    ds_read_b64_tr_b16 v[14:15], v4 offset:928
    s_waitcnt lgkmcnt(8)
    v_mfma_f32_16x16x32_bf16 v[40:43], v[20:23], v[200:203], v[40:43]
    ds_read_b64_tr_b16 v[16:17], v4 offset:704
    v_mfma_f32_16x16x32_bf16 v[44:47], v[20:23], v[204:207], v[44:47]
    ds_read_b64_tr_b16 v[18:19], v4 offset:960
    s_waitcnt lgkmcnt(8)
    v_mfma_f32_16x16x32_bf16 v[48:51], v[24:27], v[200:203], v[48:51]
    ds_read_b64_tr_b16 v[20:21], v4 offset:736
    v_mfma_f32_16x16x32_bf16 v[52:55], v[24:27], v[204:207], v[52:55]
    ds_read_b64_tr_b16 v[22:23], v4 offset:992
    s_waitcnt lgkmcnt(8)
    v_mfma_f32_16x16x32_bf16 v[56:59], v[28:31], v[200:203], v[56:59]
    s_barrier
    ds_read_b128 v[208:211], v2 offset:16640
    ds_read_b128 v[212:215], v2 offset:18688
    ds_read_b128 v[216:219], v3 offset:16640
    ds_read_b128 v[220:223], v3 offset:18688
    ds_read_b64_tr_b16 v[24:25], v4 offset:16640
    v_mfma_f32_16x16x32_bf16 v[60:63], v[28:31], v[204:207], v[60:63]
    ds_read_b64_tr_b16 v[26:27], v4 offset:16896
    s_waitcnt lgkmcnt(12)
    v_mfma_f32_16x16x32_bf16 v[64:67], v[8:11], v[200:203], v[64:67]
    ds_read_b64_tr_b16 v[28:29], v4 offset:16672
    v_mfma_f32_16x16x32_bf16 v[68:71], v[8:11], v[204:207], v[68:71]
    ds_read_b64_tr_b16 v[30:31], v4 offset:16928
    s_waitcnt lgkmcnt(12)
    v_mfma_f32_16x16x32_bf16 v[72:75], v[12:15], v[200:203], v[72:75]
    ds_read_b64_tr_b16 v[8:9], v4 offset:16704
    v_mfma_f32_16x16x32_bf16 v[76:79], v[12:15], v[204:207], v[76:79]
    ds_read_b64_tr_b16 v[10:11], v4 offset:16960
    s_waitcnt lgkmcnt(12)
    v_mfma_f32_16x16x32_bf16 v[80:83], v[16:19], v[200:203], v[80:83]
    ds_read_b64_tr_b16 v[12:13], v4 offset:16736
    v_mfma_f32_16x16x32_bf16 v[84:87], v[16:19], v[204:207], v[84:87]
    ds_read_b64_tr_b16 v[14:15], v4 offset:16992
    s_waitcnt lgkmcnt(12)
    v_mfma_f32_16x16x32_bf16 v[88:91], v[20:23], v[200:203], v[88:91]
    ds_read_b64_tr_b16 v[16:17], v4 offset:16768
    v_mfma_f32_16x16x32_bf16 v[92:95], v[20:23], v[204:207], v[92:95]
    ds_read_b64_tr_b16 v[18:19], v4 offset:17024
    s_waitcnt lgkmcnt(8)
    v_mfma_f32_16x16x32_bf16 v[32:35], v[24:27], v[208:211], v[32:35]
    ds_read_b64_tr_b16 v[20:21], v4 offset:16800
    v_mfma_f32_16x16x32_bf16 v[36:39], v[24:27], v[212:215], v[36:39]
    ds_read_b64_tr_b16 v[22:23], v4 offset:17056
    s_waitcnt lgkmcnt(8)
    v_mfma_f32_16x16x32_bf16 v[40:43], v[28:31], v[208:211], v[40:43]
    ds_read_b64_tr_b16 v[24:25], v4 offset:16832
    v_mfma_f32_16x16x32_bf16 v[44:47], v[28:31], v[212:215], v[44:47]
    ds_read_b64_tr_b16 v[26:27], v4 offset:17088
    s_waitcnt lgkmcnt(8)
    v_mfma_f32_16x16x32_bf16 v[48:51], v[8:11], v[208:211], v[48:51]
    ds_read_b64_tr_b16 v[28:29], v4 offset:16864
    v_mfma_f32_16x16x32_bf16 v[52:55], v[8:11], v[212:215], v[52:55]
    ds_read_b64_tr_b16 v[30:31], v4 offset:17120
    s_waitcnt lgkmcnt(8)
    v_mfma_f32_16x16x32_bf16 v[56:59], v[12:15], v[208:211], v[56:59]
    ds_read_b64_tr_b16 v[8:9], v4 offset:17152
    v_mfma_f32_16x16x32_bf16 v[60:63], v[12:15], v[212:215], v[60:63]
    ds_read_b64_tr_b16 v[10:11], v4 offset:17408
    s_waitcnt lgkmcnt(8)
    v_mfma_f32_16x16x32_bf16 v[64:67], v[16:19], v[208:211], v[64:67]
    ds_read_b64_tr_b16 v[12:13], v4 offset:17184
    v_mfma_f32_16x16x32_bf16 v[68:71], v[16:19], v[212:215], v[68:71]
    ds_read_b64_tr_b16 v[14:15], v4 offset:17440
    s_waitcnt lgkmcnt(8)
    v_mfma_f32_16x16x32_bf16 v[72:75], v[20:23], v[208:211], v[72:75]
    ds_read_b64_tr_b16 v[16:17], v4 offset:17216
    v_mfma_f32_16x16x32_bf16 v[76:79], v[20:23], v[212:215], v[76:79]
    ds_read_b64_tr_b16 v[18:19], v4 offset:17472
    s_waitcnt lgkmcnt(8)
    v_mfma_f32_16x16x32_bf16 v[80:83], v[24:27], v[208:211], v[80:83]
    ds_read_b64_tr_b16 v[20:21], v4 offset:17248
    v_mfma_f32_16x16x32_bf16 v[84:87], v[24:27], v[212:215], v[84:87]
    ds_read_b64_tr_b16 v[22:23], v4 offset:17504
    s_waitcnt lgkmcnt(8)
    v_mfma_f32_16x16x32_bf16 v[88:91], v[28:31], v[208:211], v[88:91]
    ds_read_b64_tr_b16 v[24:25], v4 offset:17280
    v_mfma_f32_16x16x32_bf16 v[92:95], v[28:31], v[212:215], v[92:95]
    ds_read_b64_tr_b16 v[26:27], v4 offset:17536
    s_waitcnt lgkmcnt(8)
    v_mfma_f32_16x16x32_bf16 v[32:35], v[8:11], v[216:219], v[32:35]
    ds_read_b64_tr_b16 v[28:29], v4 offset:17312
    v_mfma_f32_16x16x32_bf16 v[36:39], v[8:11], v[220:223], v[36:39]
    ds_read_b64_tr_b16 v[30:31], v4 offset:17568
    s_waitcnt lgkmcnt(8)
    v_mfma_f32_16x16x32_bf16 v[40:43], v[12:15], v[216:219], v[40:43]
    ds_read_b64_tr_b16 v[8:9], v4 offset:17344
    v_mfma_f32_16x16x32_bf16 v[44:47], v[12:15], v[220:223], v[44:47]
    ds_read_b64_tr_b16 v[10:11], v4 offset:17600
    s_waitcnt lgkmcnt(8)
    v_mfma_f32_16x16x32_bf16 v[48:51], v[16:19], v[216:219], v[48:51]
    ds_read_b64_tr_b16 v[12:13], v4 offset:17376
    v_mfma_f32_16x16x32_bf16 v[52:55], v[16:19], v[220:223], v[52:55]
    ds_read_b64_tr_b16 v[14:15], v4 offset:17632
    s_waitcnt lgkmcnt(8)
    v_mfma_f32_16x16x32_bf16 v[56:59], v[20:23], v[216:219], v[56:59]
    s_barrier
    ds_read_b128 v[224:227], v2 offset:33280
    ds_read_b128 v[228:231], v2 offset:35328
    ds_read_b128 v[232:235], v3 offset:33280
    ds_read_b128 v[236:239], v3 offset:35328
    ds_read_b64_tr_b16 v[16:17], v4 offset:33280
    v_mfma_f32_16x16x32_bf16 v[60:63], v[20:23], v[220:223], v[60:63]
    ds_read_b64_tr_b16 v[18:19], v4 offset:33536
    s_waitcnt lgkmcnt(12)
    v_mfma_f32_16x16x32_bf16 v[64:67], v[24:27], v[216:219], v[64:67]
    ds_read_b64_tr_b16 v[20:21], v4 offset:33312
    v_mfma_f32_16x16x32_bf16 v[68:71], v[24:27], v[220:223], v[68:71]
    ds_read_b64_tr_b16 v[22:23], v4 offset:33568
    s_waitcnt lgkmcnt(12)
    v_mfma_f32_16x16x32_bf16 v[72:75], v[28:31], v[216:219], v[72:75]
    ds_read_b64_tr_b16 v[24:25], v4 offset:33344
    v_mfma_f32_16x16x32_bf16 v[76:79], v[28:31], v[220:223], v[76:79]
    ds_read_b64_tr_b16 v[26:27], v4 offset:33600
    s_waitcnt lgkmcnt(12)
    v_mfma_f32_16x16x32_bf16 v[80:83], v[8:11], v[216:219], v[80:83]
    ds_read_b64_tr_b16 v[28:29], v4 offset:33376
    v_mfma_f32_16x16x32_bf16 v[84:87], v[8:11], v[220:223], v[84:87]
    ds_read_b64_tr_b16 v[30:31], v4 offset:33632
    s_waitcnt lgkmcnt(12)
    v_mfma_f32_16x16x32_bf16 v[88:91], v[12:15], v[216:219], v[88:91]
    ds_read_b64_tr_b16 v[8:9], v4 offset:33408
    v_mfma_f32_16x16x32_bf16 v[92:95], v[12:15], v[220:223], v[92:95]
    ds_read_b64_tr_b16 v[10:11], v4 offset:33664
    s_waitcnt lgkmcnt(8)
    v_mfma_f32_16x16x32_bf16 v[32:35], v[16:19], v[224:227], v[32:35]
    ds_read_b64_tr_b16 v[12:13], v4 offset:33440
    v_mfma_f32_16x16x32_bf16 v[36:39], v[16:19], v[228:231], v[36:39]
    ds_read_b64_tr_b16 v[14:15], v4 offset:33696
    s_waitcnt lgkmcnt(8)
    v_mfma_f32_16x16x32_bf16 v[40:43], v[20:23], v[224:227], v[40:43]
    ds_read_b64_tr_b16 v[16:17], v4 offset:33472
    v_mfma_f32_16x16x32_bf16 v[44:47], v[20:23], v[228:231], v[44:47]
    ds_read_b64_tr_b16 v[18:19], v4 offset:33728
    s_waitcnt lgkmcnt(8)
    v_mfma_f32_16x16x32_bf16 v[48:51], v[24:27], v[224:227], v[48:51]
    ds_read_b64_tr_b16 v[20:21], v4 offset:33504
    v_mfma_f32_16x16x32_bf16 v[52:55], v[24:27], v[228:231], v[52:55]
    ds_read_b64_tr_b16 v[22:23], v4 offset:33760
    s_waitcnt vmcnt(0)
    s_waitcnt lgkmcnt(8)
    v_mfma_f32_16x16x32_bf16 v[56:59], v[28:31], v[224:227], v[56:59]
    ds_read_b64_tr_b16 v[24:25], v4 offset:33792
    v_mfma_f32_16x16x32_bf16 v[60:63], v[28:31], v[228:231], v[60:63]
    ds_read_b64_tr_b16 v[26:27], v4 offset:34048
    s_waitcnt lgkmcnt(8)
    v_mfma_f32_16x16x32_bf16 v[64:67], v[8:11], v[224:227], v[64:67]
    ds_read_b64_tr_b16 v[28:29], v4 offset:33824
    v_mfma_f32_16x16x32_bf16 v[68:71], v[8:11], v[228:231], v[68:71]
    ds_read_b64_tr_b16 v[30:31], v4 offset:34080
    s_waitcnt lgkmcnt(8)
    v_mfma_f32_16x16x32_bf16 v[72:75], v[12:15], v[224:227], v[72:75]
    ds_read_b64_tr_b16 v[8:9], v4 offset:33856
    v_mfma_f32_16x16x32_bf16 v[76:79], v[12:15], v[228:231], v[76:79]
    ds_read_b64_tr_b16 v[10:11], v4 offset:34112
    s_waitcnt lgkmcnt(8)
    v_mfma_f32_16x16x32_bf16 v[80:83], v[16:19], v[224:227], v[80:83]
    ds_read_b64_tr_b16 v[12:13], v4 offset:33888
    v_mfma_f32_16x16x32_bf16 v[84:87], v[16:19], v[228:231], v[84:87]
    ds_read_b64_tr_b16 v[14:15], v4 offset:34144
    s_waitcnt lgkmcnt(8)
    v_mfma_f32_16x16x32_bf16 v[88:91], v[20:23], v[224:227], v[88:91]
    ds_read_b64_tr_b16 v[16:17], v4 offset:33920
    v_mfma_f32_16x16x32_bf16 v[92:95], v[20:23], v[228:231], v[92:95]
    ds_read_b64_tr_b16 v[18:19], v4 offset:34176
    s_waitcnt lgkmcnt(8)
    v_mfma_f32_16x16x32_bf16 v[32:35], v[24:27], v[232:235], v[32:35]
    ds_read_b64_tr_b16 v[20:21], v4 offset:33952
    v_mfma_f32_16x16x32_bf16 v[36:39], v[24:27], v[236:239], v[36:39]
    ds_read_b64_tr_b16 v[22:23], v4 offset:34208
    s_waitcnt lgkmcnt(8)
    v_mfma_f32_16x16x32_bf16 v[40:43], v[28:31], v[232:235], v[40:43]
    ds_read_b64_tr_b16 v[24:25], v4 offset:33984
    v_mfma_f32_16x16x32_bf16 v[44:47], v[28:31], v[236:239], v[44:47]
    ds_read_b64_tr_b16 v[26:27], v4 offset:34240
    s_waitcnt lgkmcnt(8)
    v_mfma_f32_16x16x32_bf16 v[48:51], v[8:11], v[232:235], v[48:51]
    ds_read_b64_tr_b16 v[28:29], v4 offset:34016
    v_mfma_f32_16x16x32_bf16 v[52:55], v[8:11], v[236:239], v[52:55]
    ds_read_b64_tr_b16 v[30:31], v4 offset:34272
    s_waitcnt lgkmcnt(8)
    v_mfma_f32_16x16x32_bf16 v[56:59], v[12:15], v[232:235], v[56:59]
    s_barrier
    ds_read_b128 v[240:243], v2 offset:0
    ds_read_b128 v[244:247], v2 offset:2048
    ds_read_b128 v[248:251], v3 offset:0
    ds_read_b128 v[252:255], v3 offset:2048
    ds_read_b64_tr_b16 v[8:9], v4 offset:49920
    v_mfma_f32_16x16x32_bf16 v[60:63], v[12:15], v[236:239], v[60:63]
    ds_read_b64_tr_b16 v[10:11], v4 offset:50176
    s_waitcnt lgkmcnt(12)
    v_mfma_f32_16x16x32_bf16 v[64:67], v[16:19], v[232:235], v[64:67]
    ds_read_b64_tr_b16 v[12:13], v4 offset:49952
    v_mfma_f32_16x16x32_bf16 v[68:71], v[16:19], v[236:239], v[68:71]
    ds_read_b64_tr_b16 v[14:15], v4 offset:50208
    s_waitcnt lgkmcnt(12)
    v_mfma_f32_16x16x32_bf16 v[72:75], v[20:23], v[232:235], v[72:75]
    ds_read_b64_tr_b16 v[16:17], v4 offset:49984
    v_mfma_f32_16x16x32_bf16 v[76:79], v[20:23], v[236:239], v[76:79]
    ds_read_b64_tr_b16 v[18:19], v4 offset:50240
    s_waitcnt lgkmcnt(12)
    v_mfma_f32_16x16x32_bf16 v[80:83], v[24:27], v[232:235], v[80:83]
    ds_read_b64_tr_b16 v[20:21], v4 offset:50016
    v_mfma_f32_16x16x32_bf16 v[84:87], v[24:27], v[236:239], v[84:87]
    ds_read_b64_tr_b16 v[22:23], v4 offset:50272
    buffer_load_dwordx2 v[2:3], off, s[32:35], 0 sc1
    s_waitcnt lgkmcnt(12)
    v_mfma_f32_16x16x32_bf16 v[88:91], v[28:31], v[232:235], v[88:91]
    ds_read_b64_tr_b16 v[24:25], v4 offset:50048
    v_mfma_f32_16x16x32_bf16 v[92:95], v[28:31], v[236:239], v[92:95]
    ds_read_b64_tr_b16 v[26:27], v4 offset:50304
    s_waitcnt lgkmcnt(8)
    v_mfma_f32_16x16x32_bf16 v[32:35], v[8:11], v[240:243], v[32:35]
    ds_read_b64_tr_b16 v[28:29], v4 offset:50080
    v_mfma_f32_16x16x32_bf16 v[36:39], v[8:11], v[244:247], v[36:39]
    ds_read_b64_tr_b16 v[30:31], v4 offset:50336
    s_waitcnt lgkmcnt(8)
    v_mfma_f32_16x16x32_bf16 v[40:43], v[12:15], v[240:243], v[40:43]
    ds_read_b64_tr_b16 v[8:9], v4 offset:50112
    v_mfma_f32_16x16x32_bf16 v[44:47], v[12:15], v[244:247], v[44:47]
    ds_read_b64_tr_b16 v[10:11], v4 offset:50368
    s_waitcnt lgkmcnt(8)
    v_mfma_f32_16x16x32_bf16 v[48:51], v[16:19], v[240:243], v[48:51]
    ds_read_b64_tr_b16 v[12:13], v4 offset:50144
    v_mfma_f32_16x16x32_bf16 v[52:55], v[16:19], v[244:247], v[52:55]
    ds_read_b64_tr_b16 v[14:15], v4 offset:50400
    s_waitcnt lgkmcnt(8)
    v_mfma_f32_16x16x32_bf16 v[56:59], v[20:23], v[240:243], v[56:59]
    ds_read_b64_tr_b16 v[16:17], v4 offset:50432
    v_mfma_f32_16x16x32_bf16 v[60:63], v[20:23], v[244:247], v[60:63]
    ds_read_b64_tr_b16 v[18:19], v4 offset:50688
    s_waitcnt lgkmcnt(8)
    v_mfma_f32_16x16x32_bf16 v[64:67], v[24:27], v[240:243], v[64:67]
    ds_read_b64_tr_b16 v[20:21], v4 offset:50464
    v_mfma_f32_16x16x32_bf16 v[68:71], v[24:27], v[244:247], v[68:71]
    ds_read_b64_tr_b16 v[22:23], v4 offset:50720
    s_waitcnt lgkmcnt(8)
    v_mfma_f32_16x16x32_bf16 v[72:75], v[28:31], v[240:243], v[72:75]
    ds_read_b64_tr_b16 v[24:25], v4 offset:50496
    v_mfma_f32_16x16x32_bf16 v[76:79], v[28:31], v[244:247], v[76:79]
    ds_read_b64_tr_b16 v[26:27], v4 offset:50752
    s_waitcnt lgkmcnt(8)
    v_mfma_f32_16x16x32_bf16 v[80:83], v[8:11], v[240:243], v[80:83]
    ds_read_b64_tr_b16 v[28:29], v4 offset:50528
    v_mfma_f32_16x16x32_bf16 v[84:87], v[8:11], v[244:247], v[84:87]
    ds_read_b64_tr_b16 v[30:31], v4 offset:50784
    s_waitcnt lgkmcnt(8)
    v_mfma_f32_16x16x32_bf16 v[88:91], v[12:15], v[240:243], v[88:91]
    ds_read_b64_tr_b16 v[8:9], v4 offset:50560
    v_mfma_f32_16x16x32_bf16 v[92:95], v[12:15], v[244:247], v[92:95]
    ds_read_b64_tr_b16 v[10:11], v4 offset:50816
    s_waitcnt lgkmcnt(8)
    v_mfma_f32_16x16x32_bf16 v[32:35], v[16:19], v[248:251], v[32:35]
    ds_read_b64_tr_b16 v[12:13], v4 offset:50592
    v_mfma_f32_16x16x32_bf16 v[36:39], v[16:19], v[252:255], v[36:39]
    ds_read_b64_tr_b16 v[14:15], v4 offset:50848
    s_waitcnt lgkmcnt(8)
    v_mfma_f32_16x16x32_bf16 v[40:43], v[20:23], v[248:251], v[40:43]
    ds_read_b64_tr_b16 v[16:17], v4 offset:50624
    v_mfma_f32_16x16x32_bf16 v[44:47], v[20:23], v[252:255], v[44:47]
    ds_read_b64_tr_b16 v[18:19], v4 offset:50880
    s_waitcnt lgkmcnt(8)
    v_mfma_f32_16x16x32_bf16 v[48:51], v[24:27], v[248:251], v[48:51]
    ds_read_b64_tr_b16 v[20:21], v4 offset:50656
    v_mfma_f32_16x16x32_bf16 v[52:55], v[24:27], v[252:255], v[52:55]
    ds_read_b64_tr_b16 v[22:23], v4 offset:50912
    s_waitcnt lgkmcnt(8)
    v_mfma_f32_16x16x32_bf16 v[56:59], v[28:31], v[248:251], v[56:59]
    v_mfma_f32_16x16x32_bf16 v[60:63], v[28:31], v[252:255], v[60:63]
    s_waitcnt lgkmcnt(6)
    v_mfma_f32_16x16x32_bf16 v[64:67], v[8:11], v[248:251], v[64:67]
    v_mfma_f32_16x16x32_bf16 v[68:71], v[8:11], v[252:255], v[68:71]
    s_waitcnt lgkmcnt(4)
    v_mfma_f32_16x16x32_bf16 v[72:75], v[12:15], v[248:251], v[72:75]
    v_mfma_f32_16x16x32_bf16 v[76:79], v[12:15], v[252:255], v[76:79]
    s_waitcnt lgkmcnt(2)
    v_mfma_f32_16x16x32_bf16 v[80:83], v[16:19], v[248:251], v[80:83]
    v_mfma_f32_16x16x32_bf16 v[84:87], v[16:19], v[252:255], v[84:87]
    s_waitcnt lgkmcnt(0)
    v_mfma_f32_16x16x32_bf16 v[88:91], v[20:23], v[248:251], v[88:91]
    v_mfma_f32_16x16x32_bf16 v[92:95], v[20:23], v[252:255], v[92:95]
    s_setprio 2
    v_cvt_pk_bf16_f32 v32, v32, v33
    v_cvt_pk_bf16_f32 v33, v34, v35
    v_cvt_pk_bf16_f32 v34, v36, v37
    v_cvt_pk_bf16_f32 v35, v38, v39
    v_cvt_pk_bf16_f32 v40, v40, v41
    v_cvt_pk_bf16_f32 v41, v42, v43
    v_permlane16_swap_b32 v32, v34
    v_permlane16_swap_b32 v33, v35
    s_add_u32 s3, s27, 0
    buffer_store_dwordx4 v[32:35], v1, s[8:11], s3 offen sc1
    v_cvt_pk_bf16_f32 v42, v44, v45
    v_cvt_pk_bf16_f32 v43, v46, v47
    v_cvt_pk_bf16_f32 v48, v48, v49
    v_cvt_pk_bf16_f32 v49, v50, v51
    v_permlane16_swap_b32 v40, v42
    v_permlane16_swap_b32 v41, v43
    s_add_u32 s3, s27, 4096
    buffer_store_dwordx4 v[40:43], v1, s[8:11], s3 offen sc1
    v_cvt_pk_bf16_f32 v50, v52, v53
    v_cvt_pk_bf16_f32 v51, v54, v55
    v_cvt_pk_bf16_f32 v56, v56, v57
    v_cvt_pk_bf16_f32 v57, v58, v59
    v_permlane16_swap_b32 v48, v50
    v_permlane16_swap_b32 v49, v51
    s_add_u32 s3, s27, 8192
    buffer_store_dwordx4 v[48:51], v1, s[8:11], s3 offen sc1
    s_waitcnt vmcnt(3)
    v_cmp_eq_u32 vcc, 0, v2
    s_nop 1
    s_cbranch_vccnz .Lnsp_47
.Lnok_46:
    s_mov_b32 s34, s70
    s_cmp_eq_u32 s73, 0
    s_cbranch_scc1 .Lcinit_48
.Lcinited_49:
    v_cvt_pk_bf16_f32 v58, v60, v61
    v_cvt_pk_bf16_f32 v59, v62, v63
    v_cvt_pk_bf16_f32 v64, v64, v65
    v_cvt_pk_bf16_f32 v65, v66, v67
    v_permlane16_swap_b32 v56, v58
    v_permlane16_swap_b32 v57, v59
    s_add_u32 s3, s27, 12288
    buffer_store_dwordx4 v[56:59], v1, s[8:11], s3 offen sc1
    s_barrier
    v_lshrrev_b32 v20, 4, v0
    v_lshlrev_b32 v20, 5, v20
    v_bfe_u32 v21, v0, 3, 1
    v_lshl_add_u32 v20, v21, 2, v20
    v_add_u32 v20, s16, v20
    v_mul_u32_u24 v20, 3840, v20
    v_and_b32 v21, 7, v0
    v_lshl_add_u32 v10, v21, 4, v20
    v_mov_b32 v30, v10
    v_cmp_gt_u32 vcc, 32, v0
    v_add_u32 v20, 2211840, v10
    v_subrev_u32 v21, 245760, v10
    v_cndmask_b32 v31, v21, v20, vcc
    s_add_u32 s3, s25, 0
    s_cmp_ge_u32 s3, 10
    s_cselect_b32 s4, 10, 0
    s_sub_u32 s3, s3, s4
    s_mul_i32 s4, s3, 245760
    s_add_u32 s72, s4, s71
    s_cmp_eq_u32 s3, 9
    s_cselect_b32 s72, s71, s72
    s_cselect_b64 vcc, -1, 0
    v_cndmask_b32 v10, v30, v31, vcc
    s_add_u32 m0, s68, 16640
    s_add_u32 s3, s72, 128
    buffer_load_dwordx4 v10, s[76:79], s3 offen  lds
    s_add_u32 m0, s68, 24960
    s_add_u32 s3, s72, 30848
    buffer_load_dwordx4 v10, s[76:79], s3 offen  lds
    s_add_u32 m0, s68, 17664
    s_add_u32 s3, s72, 61568
    buffer_load_dwordx4 v10, s[76:79], s3 offen  lds
    s_add_u32 m0, s68, 25984
    s_add_u32 s3, s72, 92288
    buffer_load_dwordx4 v10, s[76:79], s3 offen  lds
    s_add_u32 s3, s25, 2
    s_cmp_ge_u32 s3, 10
    s_cselect_b32 s4, 10, 0
    s_sub_u32 s3, s3, s4
    s_mul_i32 s4, s3, 245760
    s_add_u32 s72, s4, s71
    s_cmp_eq_u32 s3, 9
    s_cselect_b32 s72, s71, s72
    s_cselect_b64 vcc, -1, 0
    v_cndmask_b32 v10, v30, v31, vcc
    s_add_u32 m0, s68, 33280
    s_add_u32 s3, s72, 128
    buffer_load_dwordx4 v10, s[76:79], s3 offen  lds
    s_add_u32 m0, s68, 41600
    s_add_u32 s3, s72, 30848
    buffer_load_dwordx4 v10, s[76:79], s3 offen  lds
    s_add_u32 m0, s68, 34304
    s_add_u32 s3, s72, 61568
    buffer_load_dwordx4 v10, s[76:79], s3 offen  lds
    s_add_u32 m0, s68, 42624
    s_add_u32 s3, s72, 92288
    buffer_load_dwordx4 v10, s[76:79], s3 offen  lds
    s_barrier
    v_cvt_pk_bf16_f32 v66, v68, v69
    v_cvt_pk_bf16_f32 v67, v70, v71
    v_cvt_pk_bf16_f32 v72, v72, v73
    v_cvt_pk_bf16_f32 v73, v74, v75
    v_permlane16_swap_b32 v64, v66
    v_permlane16_swap_b32 v65, v67
    s_add_u32 s3, s27, 16384
    buffer_store_dwordx4 v[64:67], v1, s[8:11], s3 offen sc1
    v_cvt_pk_bf16_f32 v74, v76, v77
    v_cvt_pk_bf16_f32 v75, v78, v79
    v_cvt_pk_bf16_f32 v80, v80, v81
    v_cvt_pk_bf16_f32 v81, v82, v83
    v_permlane16_swap_b32 v72, v74
    v_permlane16_swap_b32 v73, v75
    s_add_u32 s3, s27, 20480
    buffer_store_dwordx4 v[72:75], v1, s[8:11], s3 offen sc1
    v_cvt_pk_bf16_f32 v82, v84, v85
    v_cvt_pk_bf16_f32 v83, v86, v87
    v_cvt_pk_bf16_f32 v88, v88, v89
    v_cvt_pk_bf16_f32 v89, v90, v91
    v_permlane16_swap_b32 v80, v82
    v_permlane16_swap_b32 v81, v83
    s_add_u32 s3, s27, 24576
    buffer_store_dwordx4 v[80:83], v1, s[8:11], s3 offen sc1
    v_cvt_pk_bf16_f32 v90, v92, v93
    v_cvt_pk_bf16_f32 v91, v94, v95
    s_nop 0
    v_permlane16_swap_b32 v88, v90
    v_permlane16_swap_b32 v89, v91
    s_add_u32 s3, s27, 28672
    buffer_store_dwordx4 v[88:91], v1, s[8:11], s3 offen sc1
    s_add_u32 s3, s25, 4
    s_cmp_ge_u32 s3, 10
    s_cselect_b32 s4, 10, 0
    s_sub_u32 s3, s3, s4
    s_mul_i32 s4, s3, 245760
    s_add_u32 s72, s4, s71
    s_cmp_eq_u32 s3, 9
    s_cselect_b32 s72, s71, s72
    s_cselect_b64 vcc, -1, 0
    v_cndmask_b32 v10, v30, v31, vcc
    s_add_u32 m0, s68, 49920
    s_add_u32 s3, s72, 128
    buffer_load_dwordx4 v10, s[76:79], s3 offen  lds
    s_add_u32 m0, s68, 58240
    s_add_u32 s3, s72, 30848
    buffer_load_dwordx4 v10, s[76:79], s3 offen  lds
    s_add_u32 m0, s68, 50944
    s_add_u32 s3, s72, 61568
    buffer_load_dwordx4 v10, s[76:79], s3 offen  lds
    s_add_u32 m0, s68, 59264
    s_add_u32 s3, s72, 92288
    buffer_load_dwordx4 v10, s[76:79], s3 offen  lds
    s_add_u32 s3, s25, 6
    s_cmp_ge_u32 s3, 10
    s_cselect_b32 s4, 10, 0
    s_sub_u32 s3, s3, s4
    s_mul_i32 s4, s3, 245760
    s_add_u32 s72, s4, s71
    s_cmp_eq_u32 s3, 9
    s_cselect_b32 s72, s71, s72
    s_cselect_b64 vcc, -1, 0
    v_cndmask_b32 v10, v30, v31, vcc
    s_add_u32 m0, s68, 66560
    s_add_u32 s3, s72, 128
    buffer_load_dwordx4 v10, s[76:79], s3 offen  lds
    s_add_u32 m0, s68, 74880
    s_add_u32 s3, s72, 30848
    buffer_load_dwordx4 v10, s[76:79], s3 offen  lds
    s_add_u32 m0, s68, 67584
    s_add_u32 s3, s72, 61568
    buffer_load_dwordx4 v10, s[76:79], s3 offen  lds
    s_add_u32 m0, s68, 75904
    s_add_u32 s3, s72, 92288
    buffer_load_dwordx4 v10, s[76:79], s3 offen  lds
    s_waitcnt vmcnt(8)
    v_lshlrev_b32 v7, 3, v0
    s_mov_b64 exec, 0xffff
    buffer_store_dwordx2 v[2:3], v7, s[8:11], s34 offen sc1
    s_mov_b64 exec, -1
    s_barrier
    s_add_u32 s3, s25, 8
    s_cmp_ge_u32 s3, 10
    s_cselect_b32 s4, 10, 0
    s_sub_u32 s3, s3, s4
    s_mul_i32 s4, s3, 245760
    s_add_u32 s72, s4, s71
    s_cmp_eq_u32 s3, 9
    s_cselect_b32 s72, s71, s72
    s_cselect_b64 vcc, -1, 0
    v_cndmask_b32 v10, v30, v31, vcc
    s_add_u32 m0, s68, 83200
    s_add_u32 s3, s72, 128
    buffer_load_dwordx4 v10, s[76:79], s3 offen  lds
    s_add_u32 m0, s68, 91520
    s_add_u32 s3, s72, 30848
    buffer_load_dwordx4 v10, s[76:79], s3 offen  lds
    s_add_u32 m0, s68, 84224
    s_add_u32 s3, s72, 61568
    buffer_load_dwordx4 v10, s[76:79], s3 offen  lds
    s_add_u32 m0, s68, 92544
    s_add_u32 s3, s72, 92288
    buffer_load_dwordx4 v10, s[76:79], s3 offen  lds
    s_mov_b32 s68, 0xffff
    s_mov_b32 s69, 0xffff0
    s_mov_b32 s70, 0x3fffc
    s_mov_b32 s71, 0x3fffc0
    s_mov_b32 s72, 0xffff00
    s_mov_b32 s73, 0xffff000
    s_mov_b32 s74, 0x3fffc00
    s_mov_b32 s75, 0x3fffc000
    s_mov_b32 s76, 0xffff0000
    s_mov_b32 s77, 0xfff0000f
    s_mov_b32 s78, 0xfffc0003
    s_mov_b32 s79, 0xffc0003f
    s_mov_b32 s80, 0xff0000ff
    s_mov_b32 s81, 0xf0000fff
    s_mov_b32 s82, 0xfc0003ff
    s_mov_b32 s83, 0xc0003fff
    s_cmp_eq_u32 s22, 0
    s_cbranch_scc1 .Lvbfirst_51
.Lvbok_50:
    s_mov_b32 s25, 1
    s_setprio 0
    s_barrier
    ds_read_b64_tr_b16 v[8:9], v4 offset:16640
    ds_read_b64_tr_b16 v[10:11], v4 offset:16768
    ds_read_b64_tr_b16 v[12:13], v4 offset:16672
    ds_read_b64_tr_b16 v[14:15], v4 offset:16800
    ds_read_b64_tr_b16 v[16:17], v4 offset:16704
    ds_read_b64_tr_b16 v[18:19], v4 offset:16832
    ds_read_b64_tr_b16 v[20:21], v4 offset:16736
    ds_read_b64_tr_b16 v[22:23], v4 offset:16864
    ds_read_b64_tr_b16 v[24:25], v4 offset:16896
    ds_read_b64_tr_b16 v[26:27], v4 offset:17024
    ds_read_b64_tr_b16 v[28:29], v4 offset:16928
    ds_read_b64_tr_b16 v[30:31], v4 offset:17056
    ds_read_b64_tr_b16 v[32:33], v4 offset:16960
    ds_read_b64_tr_b16 v[34:35], v4 offset:17088
    s_waitcnt lgkmcnt(12)
    v_mfma_f32_16x16x32_bf16 v[64:67], v[8:11], v[96:99], 0
    ds_read_b64_tr_b16 v[36:37], v4 offset:16992
    v_mfma_f32_16x16x32_bf16 v[68:71], v[8:11], v[100:103], 0
    ds_read_b64_tr_b16 v[38:39], v4 offset:17120
    s_waitcnt lgkmcnt(12)
    v_mfma_f32_16x16x32_bf16 v[72:75], v[12:15], v[96:99], 0
    ds_read_b64_tr_b16 v[8:9], v4 offset:17152
    v_mfma_f32_16x16x32_bf16 v[76:79], v[12:15], v[100:103], 0
    ds_read_b64_tr_b16 v[10:11], v4 offset:17280
    s_waitcnt lgkmcnt(12)
    v_mfma_f32_16x16x32_bf16 v[80:83], v[16:19], v[96:99], 0
    ds_read_b64_tr_b16 v[12:13], v4 offset:17184
    v_mfma_f32_16x16x32_bf16 v[84:87], v[16:19], v[100:103], 0
    ds_read_b64_tr_b16 v[14:15], v4 offset:17312
    s_waitcnt lgkmcnt(12)
    v_mfma_f32_16x16x32_bf16 v[88:91], v[20:23], v[96:99], 0
    ds_read_b64_tr_b16 v[16:17], v4 offset:17216
    v_mfma_f32_16x16x32_bf16 v[92:95], v[20:23], v[100:103], 0
    ds_read_b64_tr_b16 v[18:19], v4 offset:17344
    s_waitcnt lgkmcnt(12)
    v_mfma_f32_16x16x32_bf16 v[64:67], v[24:27], v[104:107], v[64:67]
    ds_read_b64_tr_b16 v[20:21], v4 offset:17248
    v_mfma_f32_16x16x32_bf16 v[68:71], v[24:27], v[108:111], v[68:71]
    ds_read_b64_tr_b16 v[22:23], v4 offset:17376
    s_waitcnt lgkmcnt(12)
    v_mfma_f32_16x16x32_bf16 v[72:75], v[28:31], v[104:107], v[72:75]
    ds_read_b64_tr_b16 v[24:25], v4 offset:17408
    v_mfma_f32_16x16x32_bf16 v[76:79], v[28:31], v[108:111], v[76:79]
    ds_read_b64_tr_b16 v[26:27], v4 offset:17536
    s_waitcnt lgkmcnt(12)
    v_mfma_f32_16x16x32_bf16 v[80:83], v[32:35], v[104:107], v[80:83]
    ds_read_b64_tr_b16 v[28:29], v4 offset:17440
    v_mfma_f32_16x16x32_bf16 v[84:87], v[32:35], v[108:111], v[84:87]
    ds_read_b64_tr_b16 v[30:31], v4 offset:17568
    s_waitcnt lgkmcnt(12)
    v_mfma_f32_16x16x32_bf16 v[88:91], v[36:39], v[104:107], v[88:91]
    ds_read_b64_tr_b16 v[32:33], v4 offset:17472
    v_mfma_f32_16x16x32_bf16 v[92:95], v[36:39], v[108:111], v[92:95]
    ds_read_b64_tr_b16 v[34:35], v4 offset:17600
    s_waitcnt lgkmcnt(12)
    v_mfma_f32_16x16x32_bf16 v[64:67], v[8:11], v[112:115], v[64:67]
    ds_read_b64_tr_b16 v[36:37], v4 offset:17504
    v_mfma_f32_16x16x32_bf16 v[68:71], v[8:11], v[116:119], v[68:71]
    ds_read_b64_tr_b16 v[38:39], v4 offset:17632
    s_waitcnt lgkmcnt(12)
    v_mfma_f32_16x16x32_bf16 v[72:75], v[12:15], v[112:115], v[72:75]
    s_waitcnt vmcnt(0)
    s_barrier
    ds_read_b64_tr_b16 v[8:9], v4 offset:33280
    v_mfma_f32_16x16x32_bf16 v[76:79], v[12:15], v[116:119], v[76:79]
    ds_read_b64_tr_b16 v[10:11], v4 offset:33408
    s_waitcnt lgkmcnt(12)
    v_mfma_f32_16x16x32_bf16 v[80:83], v[16:19], v[112:115], v[80:83]
    ds_read_b64_tr_b16 v[12:13], v4 offset:33312
    v_mfma_f32_16x16x32_bf16 v[84:87], v[16:19], v[116:119], v[84:87]
    ds_read_b64_tr_b16 v[14:15], v4 offset:33440
    s_waitcnt lgkmcnt(12)
    v_mfma_f32_16x16x32_bf16 v[88:91], v[20:23], v[112:115], v[88:91]
    ds_read_b64_tr_b16 v[16:17], v4 offset:33344
    v_mfma_f32_16x16x32_bf16 v[92:95], v[20:23], v[116:119], v[92:95]
    ds_read_b64_tr_b16 v[18:19], v4 offset:33472
    s_waitcnt lgkmcnt(12)
    v_mfma_f32_16x16x32_bf16 v[64:67], v[24:27], v[120:123], v[64:67]
    ds_read_b64_tr_b16 v[20:21], v4 offset:33376
    v_mfma_f32_16x16x32_bf16 v[68:71], v[24:27], v[124:127], v[68:71]
    ds_read_b64_tr_b16 v[22:23], v4 offset:33504
    s_waitcnt lgkmcnt(12)
    v_mfma_f32_16x16x32_bf16 v[72:75], v[28:31], v[120:123], v[72:75]
    ds_read_b64_tr_b16 v[24:25], v4 offset:33536
    v_mfma_f32_16x16x32_bf16 v[76:79], v[28:31], v[124:127], v[76:79]
    ds_read_b64_tr_b16 v[26:27], v4 offset:33664
    s_waitcnt lgkmcnt(12)
    v_mfma_f32_16x16x32_bf16 v[80:83], v[32:35], v[120:123], v[80:83]
    ds_read_b64_tr_b16 v[28:29], v4 offset:33568
    v_mfma_f32_16x16x32_bf16 v[84:87], v[32:35], v[124:127], v[84:87]
    ds_read_b64_tr_b16 v[30:31], v4 offset:33696
    s_waitcnt lgkmcnt(12)
    v_mfma_f32_16x16x32_bf16 v[88:91], v[36:39], v[120:123], v[88:91]
    ds_read_b64_tr_b16 v[32:33], v4 offset:33600
    v_mfma_f32_16x16x32_bf16 v[92:95], v[36:39], v[124:127], v[92:95]
    ds_read_b64_tr_b16 v[34:35], v4 offset:33728
    s_waitcnt lgkmcnt(12)
    v_mfma_f32_16x16x32_bf16 v[64:67], v[8:11], v[128:131], v[64:67]
    ds_read_b64_tr_b16 v[36:37], v4 offset:33632
    v_mfma_f32_16x16x32_bf16 v[68:71], v[8:11], v[132:135], v[68:71]
    ds_read_b64_tr_b16 v[38:39], v4 offset:33760
    s_waitcnt lgkmcnt(12)
    v_mfma_f32_16x16x32_bf16 v[72:75], v[12:15], v[128:131], v[72:75]
    ds_read_b64_tr_b16 v[8:9], v4 offset:33792
    v_mfma_f32_16x16x32_bf16 v[76:79], v[12:15], v[132:135], v[76:79]
    ds_read_b64_tr_b16 v[10:11], v4 offset:33920
    s_waitcnt lgkmcnt(12)
    v_mfma_f32_16x16x32_bf16 v[80:83], v[16:19], v[128:131], v[80:83]
    ds_read_b64_tr_b16 v[12:13], v4 offset:33824
    v_mfma_f32_16x16x32_bf16 v[84:87], v[16:19], v[132:135], v[84:87]
    ds_read_b64_tr_b16 v[14:15], v4 offset:33952
    s_waitcnt lgkmcnt(12)
    v_mfma_f32_16x16x32_bf16 v[88:91], v[20:23], v[128:131], v[88:91]
    ds_read_b64_tr_b16 v[16:17], v4 offset:33856
    v_mfma_f32_16x16x32_bf16 v[92:95], v[20:23], v[132:135], v[92:95]
    ds_read_b64_tr_b16 v[18:19], v4 offset:33984
    s_waitcnt lgkmcnt(12)
    v_mfma_f32_16x16x32_bf16 v[64:67], v[24:27], v[136:139], v[64:67]
    ds_read_b64_tr_b16 v[20:21], v4 offset:33888
    v_mfma_f32_16x16x32_bf16 v[68:71], v[24:27], v[140:143], v[68:71]
    ds_read_b64_tr_b16 v[22:23], v4 offset:34016
    s_waitcnt lgkmcnt(12)
    v_mfma_f32_16x16x32_bf16 v[72:75], v[28:31], v[136:139], v[72:75]
    ds_read_b64_tr_b16 v[24:25], v4 offset:34048
    v_mfma_f32_16x16x32_bf16 v[76:79], v[28:31], v[140:143], v[76:79]
    ds_read_b64_tr_b16 v[26:27], v4 offset:34176
    s_waitcnt lgkmcnt(12)
    v_mfma_f32_16x16x32_bf16 v[80:83], v[32:35], v[136:139], v[80:83]
    ds_read_b64_tr_b16 v[28:29], v4 offset:34080
    v_mfma_f32_16x16x32_bf16 v[84:87], v[32:35], v[140:143], v[84:87]
    ds_read_b64_tr_b16 v[30:31], v4 offset:34208
    s_waitcnt lgkmcnt(12)
    v_mfma_f32_16x16x32_bf16 v[88:91], v[36:39], v[136:139], v[88:91]
    ds_read_b64_tr_b16 v[32:33], v4 offset:34112
    v_mfma_f32_16x16x32_bf16 v[92:95], v[36:39], v[140:143], v[92:95]
    ds_read_b64_tr_b16 v[34:35], v4 offset:34240
    s_waitcnt lgkmcnt(12)
    v_mfma_f32_16x16x32_bf16 v[64:67], v[8:11], v[144:147], v[64:67]
    ds_read_b64_tr_b16 v[36:37], v4 offset:34144
    v_mfma_f32_16x16x32_bf16 v[68:71], v[8:11], v[148:151], v[68:71]
    ds_read_b64_tr_b16 v[38:39], v4 offset:34272
    s_waitcnt lgkmcnt(12)
    v_mfma_f32_16x16x32_bf16 v[72:75], v[12:15], v[144:147], v[72:75]
    ds_read_b64_tr_b16 v[8:9], v4 offset:49920
    v_mfma_f32_16x16x32_bf16 v[76:79], v[12:15], v[148:151], v[76:79]
    ds_read_b64_tr_b16 v[10:11], v4 offset:50048
    s_waitcnt lgkmcnt(12)
    v_mfma_f32_16x16x32_bf16 v[80:83], v[16:19], v[144:147], v[80:83]
    ds_read_b64_tr_b16 v[12:13], v4 offset:49952
    v_mfma_f32_16x16x32_bf16 v[84:87], v[16:19], v[148:151], v[84:87]
    ds_read_b64_tr_b16 v[14:15], v4 offset:50080
    s_waitcnt lgkmcnt(12)
    v_mfma_f32_16x16x32_bf16 v[88:91], v[20:23], v[144:147], v[88:91]
    ds_read_b64_tr_b16 v[16:17], v4 offset:49984
    v_mfma_f32_16x16x32_bf16 v[92:95], v[20:23], v[148:151], v[92:95]
    ds_read_b64_tr_b16 v[18:19], v4 offset:50112
    s_waitcnt lgkmcnt(12)
    v_mfma_f32_16x16x32_bf16 v[64:67], v[24:27], v[152:155], v[64:67]
    ds_read_b64_tr_b16 v[20:21], v4 offset:50016
    v_mfma_f32_16x16x32_bf16 v[68:71], v[24:27], v[156:159], v[68:71]
    ds_read_b64_tr_b16 v[22:23], v4 offset:50144
    s_waitcnt lgkmcnt(12)
    v_mfma_f32_16x16x32_bf16 v[72:75], v[28:31], v[152:155], v[72:75]
    ds_read_b64_tr_b16 v[24:25], v4 offset:50176
    v_mfma_f32_16x16x32_bf16 v[76:79], v[28:31], v[156:159], v[76:79]
    ds_read_b64_tr_b16 v[26:27], v4 offset:50304
    s_waitcnt lgkmcnt(12)
    v_mfma_f32_16x16x32_bf16 v[80:83], v[32:35], v[152:155], v[80:83]
    ds_read_b64_tr_b16 v[28:29], v4 offset:50208
    v_mfma_f32_16x16x32_bf16 v[84:87], v[32:35], v[156:159], v[84:87]
    ds_read_b64_tr_b16 v[30:31], v4 offset:50336
    s_waitcnt lgkmcnt(12)
    v_mfma_f32_16x16x32_bf16 v[88:91], v[36:39], v[152:155], v[88:91]
    ds_read_b64_tr_b16 v[32:33], v4 offset:50240
    v_mfma_f32_16x16x32_bf16 v[92:95], v[36:39], v[156:159], v[92:95]
    ds_read_b64_tr_b16 v[34:35], v4 offset:50368
    s_waitcnt lgkmcnt(12)
    v_mfma_f32_16x16x32_bf16 v[64:67], v[8:11], v[160:163], v[64:67]
    ds_read_b64_tr_b16 v[36:37], v4 offset:50272
    v_mfma_f32_16x16x32_bf16 v[68:71], v[8:11], v[164:167], v[68:71]
    ds_read_b64_tr_b16 v[38:39], v4 offset:50400
    s_waitcnt lgkmcnt(12)
    v_mfma_f32_16x16x32_bf16 v[72:75], v[12:15], v[160:163], v[72:75]
    ds_read_b64_tr_b16 v[8:9], v4 offset:50432
    v_mfma_f32_16x16x32_bf16 v[76:79], v[12:15], v[164:167], v[76:79]
    ds_read_b64_tr_b16 v[10:11], v4 offset:50560
    s_waitcnt lgkmcnt(12)
    v_mfma_f32_16x16x32_bf16 v[80:83], v[16:19], v[160:163], v[80:83]
    ds_read_b64_tr_b16 v[12:13], v4 offset:50464
    v_mfma_f32_16x16x32_bf16 v[84:87], v[16:19], v[164:167], v[84:87]
    ds_read_b64_tr_b16 v[14:15], v4 offset:50592
    s_waitcnt lgkmcnt(12)
    v_mfma_f32_16x16x32_bf16 v[88:91], v[20:23], v[160:163], v[88:91]
    ds_read_b64_tr_b16 v[16:17], v4 offset:50496
    v_mfma_f32_16x16x32_bf16 v[92:95], v[20:23], v[164:167], v[92:95]
    ds_read_b64_tr_b16 v[18:19], v4 offset:50624
    s_waitcnt lgkmcnt(12)
    v_mfma_f32_16x16x32_bf16 v[64:67], v[24:27], v[168:171], v[64:67]
    ds_read_b64_tr_b16 v[20:21], v4 offset:50528
    v_mfma_f32_16x16x32_bf16 v[68:71], v[24:27], v[172:175], v[68:71]
    ds_read_b64_tr_b16 v[22:23], v4 offset:50656
    s_waitcnt lgkmcnt(12)
    v_mfma_f32_16x16x32_bf16 v[72:75], v[28:31], v[168:171], v[72:75]
    ds_read_b64_tr_b16 v[24:25], v4 offset:50688
    v_mfma_f32_16x16x32_bf16 v[76:79], v[28:31], v[172:175], v[76:79]
    ds_read_b64_tr_b16 v[26:27], v4 offset:50816
    s_waitcnt lgkmcnt(12)
    v_mfma_f32_16x16x32_bf16 v[80:83], v[32:35], v[168:171], v[80:83]
    ds_read_b64_tr_b16 v[28:29], v4 offset:50720
    v_mfma_f32_16x16x32_bf16 v[84:87], v[32:35], v[172:175], v[84:87]
    ds_read_b64_tr_b16 v[30:31], v4 offset:50848
    s_waitcnt lgkmcnt(12)
    v_mfma_f32_16x16x32_bf16 v[88:91], v[36:39], v[168:171], v[88:91]
    ds_read_b64_tr_b16 v[32:33], v4 offset:50752
    v_mfma_f32_16x16x32_bf16 v[92:95], v[36:39], v[172:175], v[92:95]
    ds_read_b64_tr_b16 v[34:35], v4 offset:50880
    s_waitcnt lgkmcnt(12)
    v_mfma_f32_16x16x32_bf16 v[64:67], v[8:11], v[176:179], v[64:67]
    ds_read_b64_tr_b16 v[36:37], v4 offset:50784
    v_mfma_f32_16x16x32_bf16 v[68:71], v[8:11], v[180:183], v[68:71]
    ds_read_b64_tr_b16 v[38:39], v4 offset:50912
    s_waitcnt lgkmcnt(12)
    v_mfma_f32_16x16x32_bf16 v[72:75], v[12:15], v[176:179], v[72:75]
    ds_read_b64_tr_b16 v[8:9], v5 offset:0
    v_mfma_f32_16x16x32_bf16 v[76:79], v[12:15], v[180:183], v[76:79]
    ds_read_b64_tr_b16 v[10:11], v5 offset:128
    s_waitcnt lgkmcnt(12)
    v_mfma_f32_16x16x32_bf16 v[80:83], v[16:19], v[176:179], v[80:83]
    ds_read_b64_tr_b16 v[12:13], v5 offset:32
    v_mfma_f32_16x16x32_bf16 v[84:87], v[16:19], v[180:183], v[84:87]
    ds_read_b64_tr_b16 v[14:15], v5 offset:160
    s_waitcnt lgkmcnt(12)
    v_mfma_f32_16x16x32_bf16 v[88:91], v[20:23], v[176:179], v[88:91]
    ds_read_b64_tr_b16 v[16:17], v5 offset:64
    v_mfma_f32_16x16x32_bf16 v[92:95], v[20:23], v[180:183], v[92:95]
    ds_read_b64_tr_b16 v[18:19], v5 offset:192
    s_waitcnt lgkmcnt(12)
    v_mfma_f32_16x16x32_bf16 v[64:67], v[24:27], v[184:187], v[64:67]
    ds_read_b64_tr_b16 v[20:21], v5 offset:96
    v_mfma_f32_16x16x32_bf16 v[68:71], v[24:27], v[188:191], v[68:71]
    ds_read_b64_tr_b16 v[22:23], v5 offset:224
    s_waitcnt lgkmcnt(12)
    v_mfma_f32_16x16x32_bf16 v[72:75], v[28:31], v[184:187], v[72:75]
    ds_read_b64_tr_b16 v[24:25], v5 offset:256
    v_mfma_f32_16x16x32_bf16 v[76:79], v[28:31], v[188:191], v[76:79]
    ds_read_b64_tr_b16 v[26:27], v5 offset:384
    s_waitcnt lgkmcnt(12)
    v_mfma_f32_16x16x32_bf16 v[80:83], v[32:35], v[184:187], v[80:83]
    ds_read_b64_tr_b16 v[28:29], v5 offset:288
    v_mfma_f32_16x16x32_bf16 v[84:87], v[32:35], v[188:191], v[84:87]
    ds_read_b64_tr_b16 v[30:31], v5 offset:416
    s_waitcnt lgkmcnt(12)
    v_mfma_f32_16x16x32_bf16 v[88:91], v[36:39], v[184:187], v[88:91]
    ds_read_b64_tr_b16 v[32:33], v5 offset:320
    v_mfma_f32_16x16x32_bf16 v[92:95], v[36:39], v[188:191], v[92:95]
    ds_read_b64_tr_b16 v[34:35], v5 offset:448
    s_waitcnt lgkmcnt(12)
    v_mfma_f32_16x16x32_bf16 v[64:67], v[8:11], v[192:195], v[64:67]
    ds_read_b64_tr_b16 v[36:37], v5 offset:352
    v_mfma_f32_16x16x32_bf16 v[68:71], v[8:11], v[196:199], v[68:71]
    ds_read_b64_tr_b16 v[38:39], v5 offset:480
    s_waitcnt lgkmcnt(12)
    v_mfma_f32_16x16x32_bf16 v[72:75], v[12:15], v[192:195], v[72:75]
    ds_read_b64_tr_b16 v[8:9], v5 offset:512
    v_mfma_f32_16x16x32_bf16 v[76:79], v[12:15], v[196:199], v[76:79]
    ds_read_b64_tr_b16 v[10:11], v5 offset:640
    s_waitcnt lgkmcnt(12)
    v_mfma_f32_16x16x32_bf16 v[80:83], v[16:19], v[192:195], v[80:83]
    ds_read_b64_tr_b16 v[12:13], v5 offset:544
    v_mfma_f32_16x16x32_bf16 v[84:87], v[16:19], v[196:199], v[84:87]
    ds_read_b64_tr_b16 v[14:15], v5 offset:672
    s_waitcnt lgkmcnt(12)
    v_mfma_f32_16x16x32_bf16 v[88:91], v[20:23], v[192:195], v[88:91]
    ds_read_b64_tr_b16 v[16:17], v5 offset:576
    v_mfma_f32_16x16x32_bf16 v[92:95], v[20:23], v[196:199], v[92:95]
    ds_read_b64_tr_b16 v[18:19], v5 offset:704
    s_waitcnt lgkmcnt(12)
    v_mfma_f32_16x16x32_bf16 v[64:67], v[24:27], v[200:203], v[64:67]
    ds_read_b64_tr_b16 v[20:21], v5 offset:608
    v_mfma_f32_16x16x32_bf16 v[68:71], v[24:27], v[204:207], v[68:71]
    ds_read_b64_tr_b16 v[22:23], v5 offset:736
    s_waitcnt lgkmcnt(12)
    v_mfma_f32_16x16x32_bf16 v[72:75], v[28:31], v[200:203], v[72:75]
    ds_read_b64_tr_b16 v[24:25], v5 offset:768
    v_mfma_f32_16x16x32_bf16 v[76:79], v[28:31], v[204:207], v[76:79]
    ds_read_b64_tr_b16 v[26:27], v5 offset:896
    s_waitcnt lgkmcnt(12)
    v_mfma_f32_16x16x32_bf16 v[80:83], v[32:35], v[200:203], v[80:83]
    ds_read_b64_tr_b16 v[28:29], v5 offset:800
    v_mfma_f32_16x16x32_bf16 v[84:87], v[32:35], v[204:207], v[84:87]
    ds_read_b64_tr_b16 v[30:31], v5 offset:928
    s_waitcnt lgkmcnt(12)
    v_mfma_f32_16x16x32_bf16 v[88:91], v[36:39], v[200:203], v[88:91]
    ds_read_b64_tr_b16 v[32:33], v5 offset:832
    v_mfma_f32_16x16x32_bf16 v[92:95], v[36:39], v[204:207], v[92:95]
    ds_read_b64_tr_b16 v[34:35], v5 offset:960
    s_waitcnt lgkmcnt(12)
    v_mfma_f32_16x16x32_bf16 v[64:67], v[8:11], v[208:211], v[64:67]
    ds_read_b64_tr_b16 v[36:37], v5 offset:864
    v_mfma_f32_16x16x32_bf16 v[68:71], v[8:11], v[212:215], v[68:71]
    ds_read_b64_tr_b16 v[38:39], v5 offset:992
    s_waitcnt lgkmcnt(12)
    v_mfma_f32_16x16x32_bf16 v[72:75], v[12:15], v[208:211], v[72:75]
    ds_read_b64_tr_b16 v[8:9], v5 offset:16640
    v_mfma_f32_16x16x32_bf16 v[76:79], v[12:15], v[212:215], v[76:79]
    ds_read_b64_tr_b16 v[10:11], v5 offset:16768
    s_waitcnt lgkmcnt(12)
    v_mfma_f32_16x16x32_bf16 v[80:83], v[16:19], v[208:211], v[80:83]
    ds_read_b64_tr_b16 v[12:13], v5 offset:16672
    v_mfma_f32_16x16x32_bf16 v[84:87], v[16:19], v[212:215], v[84:87]
    ds_read_b64_tr_b16 v[14:15], v5 offset:16800
    s_waitcnt lgkmcnt(12)
    v_mfma_f32_16x16x32_bf16 v[88:91], v[20:23], v[208:211], v[88:91]
    ds_read_b64_tr_b16 v[16:17], v5 offset:16704
    v_mfma_f32_16x16x32_bf16 v[92:95], v[20:23], v[212:215], v[92:95]
    ds_read_b64_tr_b16 v[18:19], v5 offset:16832
    s_waitcnt lgkmcnt(12)
    v_mfma_f32_16x16x32_bf16 v[64:67], v[24:27], v[216:219], v[64:67]
    ds_read_b64_tr_b16 v[20:21], v5 offset:16736
    v_mfma_f32_16x16x32_bf16 v[68:71], v[24:27], v[220:223], v[68:71]
    ds_read_b64_tr_b16 v[22:23], v5 offset:16864
    s_waitcnt lgkmcnt(12)
    v_mfma_f32_16x16x32_bf16 v[72:75], v[28:31], v[216:219], v[72:75]
    ds_read_b64_tr_b16 v[24:25], v5 offset:16896
    v_mfma_f32_16x16x32_bf16 v[76:79], v[28:31], v[220:223], v[76:79]
    ds_read_b64_tr_b16 v[26:27], v5 offset:17024
    s_waitcnt lgkmcnt(12)
    v_mfma_f32_16x16x32_bf16 v[80:83], v[32:35], v[216:219], v[80:83]
    ds_read_b64_tr_b16 v[28:29], v5 offset:16928
    v_mfma_f32_16x16x32_bf16 v[84:87], v[32:35], v[220:223], v[84:87]
    ds_read_b64_tr_b16 v[30:31], v5 offset:17056
    s_waitcnt lgkmcnt(12)
    v_mfma_f32_16x16x32_bf16 v[88:91], v[36:39], v[216:219], v[88:91]
    ds_read_b64_tr_b16 v[32:33], v5 offset:16960
    v_mfma_f32_16x16x32_bf16 v[92:95], v[36:39], v[220:223], v[92:95]
    ds_read_b64_tr_b16 v[34:35], v5 offset:17088
    s_waitcnt lgkmcnt(12)
    v_mfma_f32_16x16x32_bf16 v[64:67], v[8:11], v[224:227], v[64:67]
    ds_read_b64_tr_b16 v[36:37], v5 offset:16992
    v_mfma_f32_16x16x32_bf16 v[68:71], v[8:11], v[228:231], v[68:71]
    ds_read_b64_tr_b16 v[38:39], v5 offset:17120
    s_waitcnt lgkmcnt(12)
    v_mfma_f32_16x16x32_bf16 v[72:75], v[12:15], v[224:227], v[72:75]
    ds_read_b64_tr_b16 v[8:9], v5 offset:17152
    v_mfma_f32_16x16x32_bf16 v[76:79], v[12:15], v[228:231], v[76:79]
    ds_read_b64_tr_b16 v[10:11], v5 offset:17280
    s_waitcnt lgkmcnt(12)
    v_mfma_f32_16x16x32_bf16 v[80:83], v[16:19], v[224:227], v[80:83]
    ds_read_b64_tr_b16 v[12:13], v5 offset:17184
    v_mfma_f32_16x16x32_bf16 v[84:87], v[16:19], v[228:231], v[84:87]
    ds_read_b64_tr_b16 v[14:15], v5 offset:17312
    s_waitcnt lgkmcnt(12)
    v_mfma_f32_16x16x32_bf16 v[88:91], v[20:23], v[224:227], v[88:91]
    ds_read_b64_tr_b16 v[16:17], v5 offset:17216
    v_mfma_f32_16x16x32_bf16 v[92:95], v[20:23], v[228:231], v[92:95]
    ds_read_b64_tr_b16 v[18:19], v5 offset:17344
    s_waitcnt lgkmcnt(12)
    v_mfma_f32_16x16x32_bf16 v[64:67], v[24:27], v[232:235], v[64:67]
    ds_read_b64_tr_b16 v[20:21], v5 offset:17248
    v_mfma_f32_16x16x32_bf16 v[68:71], v[24:27], v[236:239], v[68:71]
    ds_read_b64_tr_b16 v[22:23], v5 offset:17376
    s_waitcnt lgkmcnt(12)
    v_mfma_f32_16x16x32_bf16 v[72:75], v[28:31], v[232:235], v[72:75]
    ds_read_b64_tr_b16 v[24:25], v5 offset:17408
    v_mfma_f32_16x16x32_bf16 v[76:79], v[28:31], v[236:239], v[76:79]
    ds_read_b64_tr_b16 v[26:27], v5 offset:17536
    s_waitcnt lgkmcnt(12)
    v_mfma_f32_16x16x32_bf16 v[80:83], v[32:35], v[232:235], v[80:83]
    ds_read_b64_tr_b16 v[28:29], v5 offset:17440
    v_mfma_f32_16x16x32_bf16 v[84:87], v[32:35], v[236:239], v[84:87]
    ds_read_b64_tr_b16 v[30:31], v5 offset:17568
    s_waitcnt lgkmcnt(12)
    v_mfma_f32_16x16x32_bf16 v[88:91], v[36:39], v[232:235], v[88:91]
    ds_read_b64_tr_b16 v[32:33], v5 offset:17472
    v_mfma_f32_16x16x32_bf16 v[92:95], v[36:39], v[236:239], v[92:95]
    ds_read_b64_tr_b16 v[34:35], v5 offset:17600
    s_waitcnt lgkmcnt(12)
    v_mfma_f32_16x16x32_bf16 v[64:67], v[8:11], v[240:243], v[64:67]
    ds_read_b64_tr_b16 v[36:37], v5 offset:17504
    v_mfma_f32_16x16x32_bf16 v[68:71], v[8:11], v[244:247], v[68:71]
    ds_read_b64_tr_b16 v[38:39], v5 offset:17632
    s_waitcnt lgkmcnt(12)
    v_mfma_f32_16x16x32_bf16 v[72:75], v[12:15], v[240:243], v[72:75]
    v_mfma_f32_16x16x32_bf16 v[76:79], v[12:15], v[244:247], v[76:79]
    s_waitcnt lgkmcnt(10)
    v_mfma_f32_16x16x32_bf16 v[80:83], v[16:19], v[240:243], v[80:83]
    v_mfma_f32_16x16x32_bf16 v[84:87], v[16:19], v[244:247], v[84:87]
    s_waitcnt lgkmcnt(8)
    v_mfma_f32_16x16x32_bf16 v[88:91], v[20:23], v[240:243], v[88:91]
    v_mfma_f32_16x16x32_bf16 v[92:95], v[20:23], v[244:247], v[92:95]
    s_waitcnt lgkmcnt(6)
    v_mfma_f32_16x16x32_bf16 v[64:67], v[24:27], v[248:251], v[64:67]
    v_mfma_f32_16x16x32_bf16 v[68:71], v[24:27], v[252:255], v[68:71]
    s_waitcnt lgkmcnt(4)
    v_mfma_f32_16x16x32_bf16 v[72:75], v[28:31], v[248:251], v[72:75]
    v_mfma_f32_16x16x32_bf16 v[76:79], v[28:31], v[252:255], v[76:79]
    s_waitcnt lgkmcnt(2)
    v_mfma_f32_16x16x32_bf16 v[80:83], v[32:35], v[248:251], v[80:83]
    v_mfma_f32_16x16x32_bf16 v[84:87], v[32:35], v[252:255], v[84:87]
    s_waitcnt lgkmcnt(0)
    v_mfma_f32_16x16x32_bf16 v[88:91], v[36:39], v[248:251], v[88:91]
    v_mfma_f32_16x16x32_bf16 v[92:95], v[36:39], v[252:255], v[92:95]
    s_setprio 1
    v_pk_mul_f32 v[64:65], v[64:65], s[0:1]
    v_pk_mul_f32 v[66:67], v[66:67], s[0:1]
    v_pk_mul_f32 v[68:69], v[68:69], s[0:1]
    v_pk_mul_f32 v[70:71], v[70:71], s[0:1]
    v_cvt_pk_bf16_f32 v64, v64, v65
    v_cvt_pk_bf16_f32 v65, v66, v67
    v_cvt_pk_bf16_f32 v66, v68, v69
    v_cvt_pk_bf16_f32 v67, v70, v71
    v_pk_mul_f32 v[72:73], v[72:73], s[0:1]
    v_pk_mul_f32 v[74:75], v[74:75], s[0:1]
    v_pk_mul_f32 v[76:77], v[76:77], s[0:1]
    v_pk_mul_f32 v[78:79], v[78:79], s[0:1]
    v_permlane16_swap_b32 v64, v66
    v_permlane16_swap_b32 v65, v67
    v_cvt_pk_bf16_f32 v72, v72, v73
    v_cvt_pk_bf16_f32 v73, v74, v75
    s_add_u32 s3, s27, 7880704
    buffer_store_dwordx4 v[64:67], v1, s[8:11], s3 offen sc1
    v_cvt_pk_bf16_f32 v74, v76, v77
    v_cvt_pk_bf16_f32 v75, v78, v79
    v_pk_mul_f32 v[80:81], v[80:81], s[0:1]
    v_pk_mul_f32 v[82:83], v[82:83], s[0:1]
    v_pk_mul_f32 v[84:85], v[84:85], s[0:1]
    v_pk_mul_f32 v[86:87], v[86:87], s[0:1]
    v_permlane16_swap_b32 v72, v74
    v_permlane16_swap_b32 v73, v75
    v_cvt_pk_bf16_f32 v80, v80, v81
    v_cvt_pk_bf16_f32 v81, v82, v83
    s_add_u32 s3, s27, 7884800
    buffer_store_dwordx4 v[72:75], v1, s[8:11], s3 offen sc1
    v_cvt_pk_bf16_f32 v82, v84, v85
    v_cvt_pk_bf16_f32 v83, v86, v87
    v_pk_mul_f32 v[88:89], v[88:89], s[0:1]
    v_pk_mul_f32 v[90:91], v[90:91], s[0:1]
    v_pk_mul_f32 v[92:93], v[92:93], s[0:1]
    v_pk_mul_f32 v[94:95], v[94:95], s[0:1]
    v_permlane16_swap_b32 v80, v82
    v_permlane16_swap_b32 v81, v83
    v_cvt_pk_bf16_f32 v88, v88, v89
    v_cvt_pk_bf16_f32 v89, v90, v91
    s_add_u32 s3, s27, 7888896
    buffer_store_dwordx4 v[80:83], v1, s[8:11], s3 offen sc1
    v_cvt_pk_bf16_f32 v90, v92, v93
    v_cvt_pk_bf16_f32 v91, v94, v95
    s_nop 0
    v_permlane16_swap_b32 v88, v90
    v_permlane16_swap_b32 v89, v91
    s_add_u32 s3, s27, 7892992
    buffer_store_dwordx4 v[88:91], v1, s[8:11], s3 offen sc1
.Lp2b_4:
    v_lshlrev_b32 v1, 4, v0
    v_add_u32 v16, 153856, v1
    s_lshl_b32 s3, s16, 10
    v_add_u32 v17, s3, v16
    ds_read_b128 v[8:11], v16
    ds_read_b128 v[12:15], v17 offset:4096
    ds_read_b128 v[28:31], v16 offset:1024
    ds_read_b128 v[32:35], v16 offset:2048
    ds_read_b128 v[36:39], v16 offset:3072
    s_lshl_b32 s3, s16, 9
    s_lshl_b32 s4, s16, 8
    s_waitcnt lgkmcnt(0)
    v_add_u32 v8, s3, v8
    v_add_u32 v9, s4, v9
    v_add_u32 v10, s3, v10
    v_add_u32 v11, s3, v11
    s_barrier
    s_setprio 3
    ds_read_b128 v[24:27], v10
    ds_read_b128 v[40:43], v8 offset:512
    s_mov_b32 exec_hi, 0
    ds_read_b64 v[28:29], v11
    s_mov_b32 exec_hi, -1
    ds_read_b64 v[44:45], v9 offset:256
    ds_read_b128 v[48:51], v8 offset:0
    ds_read_b64 v[52:53], v9 offset:0
    ds_read_b128 v[88:91], v8 offset:4096
    ds_read_b64 v[92:93], v9 offset:2048
    v_mov_b32_e64 v18, 0
    v_mov_b32 v19, 0
    s_waitcnt lgkmcnt(6)
    v_mfma_f32_32x32x16_bf16 v[104:119], v[40:43], v[24:27], 0
    s_waitcnt lgkmcnt(4)
    v_mfma_f32_32x32x8_bf16 v[104:119], v[44:45], v[28:29], v[104:119]
    ds_read_b128 v[40:43], v8 offset:1024
    ds_read_b64 v[44:45], v9 offset:512
    s_waitcnt lgkmcnt(2)
    v_mfma_f32_32x32x16_bf16 v[120:135], v[48:51], v[24:27], 0
    buffer_load_dwordx4 v[156:159], v1, s[8:11], s24 offen offset:0 sc1
    v_mfma_f32_32x32x8_bf16 v[120:135], v[52:53], v[28:29], v[120:135]
    buffer_load_dwordx4 v[160:163], v1, s[8:11], s24 offen offset:1024 sc1
    v_mfma_f32_32x32x16_bf16 v[136:151], v[88:91], v[24:27], 0
    s_nop 3
    v_exp_f32 v104, v104
    v_exp_f32 v105, v105
    v_exp_f32 v106, v106
    v_exp_f32_e64 v107, v107
    v_mfma_f32_32x32x8_bf16 v[136:151], v[92:93], v[28:29], v[136:151]
    buffer_load_dwordx4 v[164:167], v1, s[8:11], s24 offen offset:2048 sc1
    v_exp_f32 v108, v108
    v_exp_f32 v109, v109
    v_exp_f32 v110, v110
    v_exp_f32 v111, v111
    v_cvt_pk_bf16_f32 v80, v104, v105
    v_cvt_pk_bf16_f32 v81, v106, v107
    buffer_load_dwordx4 v[168:171], v1, s[8:11], s24 offen offset:3072 sc1
    v_exp_f32 v112, v112
    v_exp_f32 v113, v113
    v_exp_f32 v114, v114
    v_exp_f32 v115, v115
    v_cvt_pk_bf16_f32 v82, v108, v109
    v_cvt_pk_bf16_f32 v83, v110, v111
    s_add_u32 s24, s24, 4096
    buffer_load_dwordx4 v[172:175], v1, s[8:11], s24 offen offset:0 sc1
    v_exp_f32 v116, v116
    v_exp_f32 v117, v117
    v_exp_f32 v118, v118
    v_exp_f32 v119, v119
    v_cvt_pk_bf16_f32 v84, v112, v113
    v_cvt_pk_bf16_f32 v85, v114, v115
    buffer_load_dwordx4 v[176:179], v1, s[8:11], s24 offen offset:1024 sc1
    v_cvt_pk_bf16_f32 v86, v116, v117
    v_cvt_pk_bf16_f32 v87, v118, v119
    s_waitcnt vmcnt(6)
    v_lshlrev_b32 v7, 3, v0
    s_mov_b64 exec, 0xffff
    buffer_store_dwordx2 v[2:3], v7, s[8:11], s17 offen sc1
    s_mov_b64 exec, -1
    s_waitcnt lgkmcnt(0)
    s_barrier
    v_mfma_f32_32x32x16_bf16 v[104:119], v[40:43], v[24:27], 0
    ds_read_b64_tr_b16 v[64:65], v13 offset:512
    ds_read_b64_tr_b16 v[66:67], v13 offset:640
    ds_read_b64_tr_b16 v[68:69], v13 offset:768
    ds_read_b64_tr_b16 v[70:71], v13 offset:896
    ds_read_b64_tr_b16 v[56:57], v13 offset:4096
    ds_read_b64_tr_b16 v[58:59], v13 offset:4224
    ds_read_b64_tr_b16 v[60:61], v13 offset:4352
    ds_read_b64_tr_b16 v[62:63], v13 offset:4480
    ds_read_b128 v[48:51], v8 offset:1536
    ds_read_b64 v[52:53], v9 offset:768
    v_cndmask_b32 v136, v120, v136, s[36:37]
    buffer_load_dwordx4 v[180:183], v1, s[8:11], s24 offen offset:2048 sc1
    v_cndmask_b32 v137, v121, v137, s[38:39]
    v_cndmask_b32 v138, v122, v138, s[40:41]
    v_cndmask_b32 v139, v123, v139, s[42:43]
    v_cndmask_b32 v140, v124, v140, s[44:45]
    v_cndmask_b32 v141, v125, v141, s[46:47]
    v_cndmask_b32 v142, v126, v142, s[48:49]
    v_cndmask_b32 v143, v127, v143, s[50:51]
    v_cndmask_b32 v144, v128, v144, s[52:53]
    v_cndmask_b32 v145, v129, v145, s[54:55]
    v_mfma_f32_32x32x8_bf16 v[104:119], v[44:45], v[28:29], v[104:119]
    v_cndmask_b32 v146, v130, v146, s[56:57]
    v_cndmask_b32 v147, v131, v147, s[58:59]
    buffer_load_dwordx4 v[184:187], v1, s[8:11], s24 offen offset:3072 sc1
    v_cndmask_b32 v148, v132, v148, s[60:61]
    v_cndmask_b32 v149, v133, v149, s[62:63]
    v_cndmask_b32 v150, v134, v150, s[64:65]
    v_cndmask_b32 v151, v135, v151, s[66:67]
    v_exp_f32 v136, v136
    v_exp_f32 v137, v137
    v_exp_f32 v138, v138
    v_exp_f32_e64 v139, v139
    v_exp_f32 v140, v140
    s_waitcnt lgkmcnt(6)
    v_mfma_f32_32x32x16_bf16 v[88:103], v[64:67], v[80:83], 0
    v_exp_f32 v141, v141
    v_exp_f32 v142, v142
    s_add_u32 s24, s24, 4096
    buffer_load_dwordx4 v[188:191], v1, s[8:11], s24 offen offset:0 sc1
    v_exp_f32 v143, v143
    v_exp_f32 v144, v144
    v_exp_f32 v145, v145
    v_exp_f32 v146, v146
    v_mfma_f32_32x32x16_bf16 v[88:103], v[68:71], v[84:87], v[88:103]
    ds_read_b64_tr_b16 v[64:65], v13 offset:0
    ds_read_b64_tr_b16 v[66:67], v13 offset:128
    ds_read_b64_tr_b16 v[68:69], v13 offset:256
    ds_read_b64_tr_b16 v[70:71], v13 offset:384
    v_exp_f32 v147, v147
    v_exp_f32 v148, v148
    v_exp_f32_e64 v149, v149
    buffer_load_dwordx4 v[192:195], v1, s[8:11], s24 offen offset:1024 sc1
    v_exp_f32 v150, v150
    v_exp_f32 v151, v151
    v_cvt_pk_bf16_f32 v80, v136, v137
    v_cvt_pk_bf16_f32 v81, v138, v139
    v_cvt_pk_bf16_f32 v82, v140, v141
    v_cvt_pk_bf16_f32 v83, v142, v143
    v_cvt_pk_bf16_f32 v84, v144, v145
    v_cvt_pk_bf16_f32 v85, v146, v147
    v_cvt_pk_bf16_f32 v86, v148, v149
    v_cvt_pk_bf16_f32 v87, v150, v151
    v_and_b32 v72, v80, v32
    v_and_b32 v73, v81, v33
    buffer_load_dwordx4 v[196:199], v1, s[8:11], s24 offen offset:2048 sc1
    v_and_b32 v74, v82, v34
    v_and_b32 v75, v83, v35
    v_and_b32 v76, v84, v36
    v_and_b32 v77, v85, v37
    v_and_b32 v78, v86, v38
    v_and_b32 v79, v87, v39
    v_xor_b32 v80, v80, v72
    v_xor_b32 v81, v81, v73
    v_xor_b32 v82, v82, v74
    v_xor_b32 v83, v83, v75
    v_xor_b32 v84, v84, v76
    v_xor_b32 v85, v85, v77
    buffer_load_dwordx4 v[200:203], v1, s[8:11], s24 offen offset:3072 sc1
    v_xor_b32 v86, v86, v78
    v_xor_b32 v87, v87, v79
    s_setprio 2
    s_waitcnt lgkmcnt(0)
    v_mfma_f32_32x32x16_bf16 v[88:103], v[56:59], v[72:75], v[88:103]
    ds_read_b128 v[40:43], v8 offset:2048
    ds_read_b64 v[44:45], v9 offset:1024
    v_exp_f32 v104, v104
    v_exp_f32 v105, v105
    v_exp_f32_e64 v106, v106
    v_mfma_f32_32x32x16_bf16 v[88:103], v[60:63], v[76:79], v[88:103]
    s_add_u32 s24, s24, 4096
    buffer_load_dwordx4 v[204:207], v1, s[8:11], s24 offen offset:0 sc1
    ds_read_b64_tr_b16 v[56:57], v13 offset:1024
    ds_read_b64_tr_b16 v[58:59], v13 offset:1152
    ds_read_b64_tr_b16 v[60:61], v13 offset:1280
    ds_read_b64_tr_b16 v[62:63], v13 offset:1408
    v_exp_f32 v107, v107
    v_exp_f32 v108, v108
    v_exp_f32_e64 v109, v109
    buffer_load_dwordx4 v[208:211], v1, s[8:11], s24 offen offset:1024 sc1
    v_mfma_f32_32x32x16_bf16 v[120:135], v[48:51], v[24:27], 0
    v_exp_f32 v110, v110
    v_exp_f32 v111, v111
    v_exp_f32_e64 v112, v112
    v_mfma_f32_32x32x8_bf16 v[120:135], v[52:53], v[28:29], v[120:135]
    v_exp_f32 v113, v113
    v_exp_f32 v114, v114
    buffer_load_dwordx4 v[212:215], v1, s[8:11], s24 offen offset:2048 sc1
    v_exp_f32_e64 v115, v115
    v_mfma_f32_32x32x16_bf16 v[88:103], v[64:67], v[80:83], v[88:103]
    v_exp_f32 v116, v116
    v_exp_f32 v117, v117
    v_exp_f32 v118, v118
    v_exp_f32 v119, v119
    v_mfma_f32_32x32x16_bf16 v[88:103], v[68:71], v[84:87], v[88:103]
    buffer_load_dwordx4 v[216:219], v1, s[8:11], s24 offen offset:3072 sc1
    v_cvt_pk_bf16_f32 v72, v104, v105
    v_cvt_pk_bf16_f32 v73, v106, v107
    v_cvt_pk_bf16_f32 v74, v108, v109
    v_cvt_pk_bf16_f32 v75, v110, v111
    v_cvt_pk_bf16_f32 v76, v112, v113
    v_cvt_pk_bf16_f32 v77, v114, v115
    v_cvt_pk_bf16_f32 v78, v116, v117
    s_add_u32 s24, s24, 4096
    buffer_load_dwordx4 v[220:223], v1, s[8:11], s24 offen offset:0 sc1
    v_cvt_pk_bf16_f32 v79, v118, v119
    s_waitcnt lgkmcnt(0)
    v_mfma_f32_32x32x16_bf16 v[104:119], v[40:43], v[24:27], 0
    ds_read_b128 v[48:51], v8 offset:2560
    ds_read_b64 v[52:53], v9 offset:1280
    ds_read_b64_tr_b16 v[64:65], v13 offset:1536
    ds_read_b64_tr_b16 v[66:67], v13 offset:1664
    ds_read_b64_tr_b16 v[68:69], v13 offset:1792
    ds_read_b64_tr_b16 v[70:71], v13 offset:1920
    v_exp_f32 v120, v120
    buffer_load_dwordx4 v[224:227], v1, s[8:11], s24 offen offset:1024 sc1
    v_exp_f32 v121, v121
    v_exp_f32 v122, v122
    v_exp_f32_e64 v123, v123
    v_mfma_f32_32x32x16_bf16 v[88:103], v[56:59], v[72:75], v[88:103]
    v_exp_f32 v124, v124
    v_exp_f32 v125, v125
    v_exp_f32 v126, v126
    v_exp_f32 v127, v127
    buffer_load_dwordx4 v[228:231], v1, s[8:11], s24 offen offset:2048 sc1
    v_cvt_pk_bf16_f32 v80, v120, v121
    v_cvt_pk_bf16_f32 v81, v122, v123
    v_mfma_f32_32x32x8_bf16 v[104:119], v[44:45], v[28:29], v[104:119]
    v_exp_f32 v128, v128
    v_exp_f32 v129, v129
    v_exp_f32 v130, v130
    v_exp_f32 v131, v131
    v_cvt_pk_bf16_f32 v82, v124, v125
    buffer_load_dwordx4 v[232:235], v1, s[8:11], s24 offen offset:3072 sc1
    v_cvt_pk_bf16_f32 v83, v126, v127
    v_mfma_f32_32x32x16_bf16 v[88:103], v[60:63], v[76:79], v[88:103]
    v_exp_f32 v132, v132
    v_exp_f32 v133, v133
    v_exp_f32 v134, v134
    v_exp_f32 v135, v135
    v_cvt_pk_bf16_f32 v84, v128, v129
    v_cvt_pk_bf16_f32 v85, v130, v131
    s_add_u32 s24, s24, 4096
    buffer_load_dwordx4 v[236:239], v1, s[8:11], s24 offen offset:0 sc1
    v_cvt_pk_bf16_f32 v86, v132, v133
    v_cvt_pk_bf16_f32 v87, v134, v135
    buffer_load_dwordx4 v[20:23], v31, s[8:11], s23 offen sc1
    v_mov_b32 v4, v2
    v_mov_b32 v5, v3
    s_mov_b64 exec, 0x1ff5
    buffer_load_dwordx2 v[4:5], v12, s[8:11], 0 offen sc1
    s_mov_b64 exec, -1
    s_waitcnt lgkmcnt(0)
    v_mfma_f32_32x32x16_bf16 v[120:135], v[48:51], v[24:27], 0
    ds_read_b128 v[40:43], v8 offset:3072
    ds_read_b64 v[44:45], v9 offset:1536
    ds_read_b64_tr_b16 v[56:57], v13 offset:2048
    ds_read_b64_tr_b16 v[58:59], v13 offset:2176
    ds_read_b64_tr_b16 v[60:61], v13 offset:2304
    ds_read_b64_tr_b16 v[62:63], v13 offset:2432
    v_exp_f32 v104, v104
    v_exp_f32 v105, v105
    v_exp_f32 v106, v106
    v_exp_f32 v107, v107
    v_mfma_f32_32x32x16_bf16 v[88:103], v[64:67], v[80:83], v[88:103]
    v_exp_f32 v108, v108
    v_exp_f32 v109, v109
    v_exp_f32 v110, v110
    v_exp_f32 v111, v111
    v_cvt_pk_bf16_f32 v72, v104, v105
    v_cvt_pk_bf16_f32 v73, v106, v107
    v_mfma_f32_32x32x8_bf16 v[120:135], v[52:53], v[28:29], v[120:135]
    v_exp_f32 v112, v112
    v_exp_f32 v113, v113
    v_exp_f32 v114, v114
    v_exp_f32 v115, v115
    v_cvt_pk_bf16_f32 v74, v108, v109
    v_cvt_pk_bf16_f32 v75, v110, v111
    v_mfma_f32_32x32x16_bf16 v[88:103], v[68:71], v[84:87], v[88:103]
    v_exp_f32 v116, v116
    v_exp_f32 v117, v117
    v_exp_f32 v118, v118
    v_exp_f32 v119, v119
    v_cvt_pk_bf16_f32 v76, v112, v113
    v_cvt_pk_bf16_f32 v77, v114, v115
    v_cvt_pk_bf16_f32 v78, v116, v117
    v_cvt_pk_bf16_f32 v79, v118, v119
    s_waitcnt vmcnt(0)
    v_cmp_ne_u64 vcc, v[4:5], v[2:3]
    s_nop 1
    s_cbranch_vccnz .Lchance_54
    s_mov_b32 s25, 0
    s_add_u32 s5, s28, 163840
    s_add_u32 s6, s29, 163840
    buffer_load_dwordx4 v[152:155], v30, s[8:11], s28 offen sc1
    s_mov_b32 exec_hi, 0
    buffer_load_dwordx2 v[18:19], v31, s[8:11], s28 offen sc1
    s_mov_b32 exec_hi, -1
    buffer_load_dwordx4 v[144:147], v30, s[8:11], s5 offen sc1
    buffer_load_dwordx2 v[148:149], v31, s[8:11], s5 offen sc1
    s_mov_b32 exec_lo, 0xffff0000
    s_mov_b32 exec_hi, 0xffff0000
    buffer_load_dwordx4 v[136:139], v30, s[8:11], s6 offen sc1
    buffer_load_dwordx2 v[140:141], v31, s[8:11], s6 offen sc1
    s_mov_b32 exec_hi, -1
    s_mul_i32 s4, s16, 3328
    s_add_u32 m0, s4, 33344
    s_add_u32 s3, s29, 327680
    buffer_load_dwordx4 v15, s[8:11], s3 offen sc1 lds
    s_add_u32 m0, s4, 34432
    s_add_u32 s3, s29, 329728
    buffer_load_dwordx4 v15, s[8:11], s3 offen sc1 lds
    s_add_u32 m0, s4, 35520
    s_add_u32 s3, s29, 331776
    buffer_load_dwordx4 v15, s[8:11], s3 offen sc1 lds
    s_mov_b32 exec_lo, -1
.Lchback_55:
    s_setprio 1
    s_waitcnt lgkmcnt(0)
    v_mfma_f32_32x32x16_bf16 v[104:119], v[40:43], v[24:27], 0
    ds_read_b128 v[48:51], v8 offset:3584
    ds_read_b64 v[52:53], v9 offset:1792
    ds_read_b64_tr_b16 v[64:65], v13 offset:2560
    ds_read_b64_tr_b16 v[66:67], v13 offset:2688
    ds_read_b64_tr_b16 v[68:69], v13 offset:2816
    ds_read_b64_tr_b16 v[70:71], v13 offset:2944
    v_exp_f32 v120, v120
    v_exp_f32 v121, v121
    v_exp_f32 v122, v122
    v_exp_f32_e64 v123, v123
    v_mfma_f32_32x32x16_bf16 v[88:103], v[56:59], v[72:75], v[88:103]
    v_exp_f32 v124, v124
    v_exp_f32 v125, v125
    v_exp_f32 v126, v126
    v_exp_f32 v127, v127
    v_cvt_pk_bf16_f32 v80, v120, v121
    v_cvt_pk_bf16_f32 v81, v122, v123
    v_mfma_f32_32x32x8_bf16 v[104:119], v[44:45], v[28:29], v[104:119]
    v_exp_f32 v128, v128
    v_exp_f32 v129, v129
    v_exp_f32 v130, v130
    v_exp_f32 v131, v131
    v_cvt_pk_bf16_f32 v82, v124, v125
    v_cvt_pk_bf16_f32 v83, v126, v127
    v_mfma_f32_32x32x16_bf16 v[88:103], v[60:63], v[76:79], v[88:103]
    v_exp_f32 v132, v132
    v_exp_f32 v133, v133
    v_exp_f32 v134, v134
    v_exp_f32 v135, v135
    v_cvt_pk_bf16_f32 v84, v128, v129
    v_cvt_pk_bf16_f32 v85, v130, v131
    v_cvt_pk_bf16_f32 v86, v132, v133
    v_cvt_pk_bf16_f32 v87, v134, v135
    s_cmp_lg_u32 s25, 0
    s_cbranch_scc1 .Lchance_56
.Lchback_57:
    s_waitcnt lgkmcnt(0)
    v_mfma_f32_32x32x16_bf16 v[120:135], v[48:51], v[24:27], 0
    ds_read_b64_tr_b16 v[56:57], v13 offset:3072
    ds_read_b64_tr_b16 v[58:59], v13 offset:3200
    ds_read_b64_tr_b16 v[60:61], v13 offset:3328
    ds_read_b64_tr_b16 v[62:63], v13 offset:3456
    v_exp_f32 v104, v104
    v_exp_f32 v105, v105
    v_exp_f32 v106, v106
    v_exp_f32_e64 v107, v107
    v_mfma_f32_32x32x16_bf16 v[88:103], v[64:67], v[80:83], v[88:103]
    v_exp_f32 v108, v108
    v_exp_f32 v109, v109
    v_exp_f32 v110, v110
    v_exp_f32 v111, v111
    v_cvt_pk_bf16_f32 v72, v104, v105
    v_cvt_pk_bf16_f32 v73, v106, v107
    v_mfma_f32_32x32x8_bf16 v[120:135], v[52:53], v[28:29], v[120:135]
    v_exp_f32 v112, v112
    v_exp_f32 v113, v113
    v_exp_f32 v114, v114
    v_exp_f32 v115, v115
    v_cvt_pk_bf16_f32 v74, v108, v109
    v_cvt_pk_bf16_f32 v75, v110, v111
    v_mfma_f32_32x32x16_bf16 v[88:103], v[68:71], v[84:87], v[88:103]
    v_exp_f32 v116, v116
    v_exp_f32 v117, v117
    v_exp_f32 v118, v118
    v_exp_f32 v119, v119
    v_cvt_pk_bf16_f32 v76, v112, v113
    v_cvt_pk_bf16_f32 v77, v114, v115
    v_cvt_pk_bf16_f32 v78, v116, v117
    v_cvt_pk_bf16_f32 v79, v118, v119
    s_cmp_lg_u32 s25, 0
    s_cbranch_scc1 .Lchance_58
.Lchback_59:
    s_waitcnt lgkmcnt(0)
    v_mfma_f32_32x32x16_bf16 v[88:103], v[56:59], v[72:75], v[88:103]
    ds_read_b64_tr_b16 v[64:65], v13 offset:3584
    ds_read_b64_tr_b16 v[66:67], v13 offset:3712
    ds_read_b64_tr_b16 v[68:69], v13 offset:3840
    ds_read_b64_tr_b16 v[70:71], v13 offset:3968
    v_exp_f32 v120, v120
    v_exp_f32 v121, v121
    v_exp_f32 v122, v122
    v_exp_f32_e64 v123, v123
    v_mfma_f32_32x32x16_bf16 v[88:103], v[60:63], v[76:79], v[88:103]
    v_exp_f32 v124, v124
    v_exp_f32 v125, v125
    v_exp_f32 v126, v126
    v_exp_f32 v127, v127
    v_cvt_pk_bf16_f32 v80, v120, v121
    v_cvt_pk_bf16_f32 v81, v122, v123
    v_exp_f32 v128, v128
    v_exp_f32 v129, v129
    v_exp_f32 v130, v130
    v_exp_f32 v131, v131
    v_cvt_pk_bf16_f32 v82, v124, v125
    v_cvt_pk_bf16_f32 v83, v126, v127
    v_exp_f32 v132, v132
    v_exp_f32 v133, v133
    v_exp_f32 v134, v134
    v_exp_f32 v135, v135
    v_cvt_pk_bf16_f32 v84, v128, v129
    v_cvt_pk_bf16_f32 v85, v130, v131
    v_cvt_pk_bf16_f32 v86, v132, v133
    v_cvt_pk_bf16_f32 v87, v134, v135
    s_waitcnt lgkmcnt(0)
    v_mfma_f32_32x32x16_bf16 v[88:103], v[64:67], v[80:83], v[88:103]
    v_mfma_f32_32x32x16_bf16 v[88:103], v[68:71], v[84:87], v[88:103]
    s_cmp_lg_u32 s25, 0
    s_cbranch_scc1 .Lchance_60
.Lchback_61:
    v_cmp_ne_u64 vcc, v[22:23], v[2:3]
    s_nop 1
    s_cbranch_vccz .Lpok_62
    s_mov_b32 s3, 131072
.Lpsp_63:
    buffer_load_dwordx4 v[20:23], v31, s[8:11], s23 offen sc1
    s_sub_u32 s3, s3, 1
    s_waitcnt vmcnt(0)
    s_cbranch_scc1 .Lpok_62
    v_cmp_ne_u64 vcc, v[22:23], v[2:3]
    s_nop 1
    s_cbranch_vccnz .Lpsp_63
.Lpok_62:
    s_nop 5
    v_rcp_f32 v7, v100
    s_nop 0
    v_mul_f32 v16, v7, v20
    v_mul_f32 v104, v16, v88
    v_mul_f32 v105, v16, v89
    v_mul_f32 v106, v16, v90
    v_mul_f32 v107, v16, v91
    v_mul_f32 v108, v16, v92
    v_mul_f32 v109, v16, v93
    v_mul_f32 v110, v16, v94
    v_mul_f32 v111, v16, v95
    v_cvt_pk_bf16_f32 v72, v104, v105
    v_cvt_pk_bf16_f32 v73, v106, v107
    v_cvt_pk_bf16_f32 v74, v108, v109
    v_cvt_pk_bf16_f32 v75, v110, v111
    buffer_store_dwordx4 v[72:75], v1, s[8:11], s30 offen sc1
    v_mul_f32 v112, v16, v96
    v_mul_f32 v113, v16, v97
    v_mul_f32 v114, v16, v98
    v_mul_f32 v115, v16, v99
    v_lshlrev_b32_e64 v7, 3, v0
    v_cvt_pk_bf16_f32 v76, v112, v113
    v_cvt_pk_bf16_f32 v77, v114, v115
    s_mov_b32 exec_hi, 0
    buffer_store_dwordx2 v[76:77], v7, s[8:11], s30 offen offset:1024 sc1
    s_mov_b32 exec_hi, -1
    v_fma_f32 v7, v100, v100, v88
    v_fma_f32 v16, v89, v90, v91
    v_cmp_lt_f32 vcc, 0x21800000, v100
    v_fma_f32 v7, v92, v93, v7
    v_fma_f32 v16, v94, v95, v16
    v_fma_f32 v7, v96, v97, v7
    v_fma_f32 v16, v98, v99, v16
    s_mov_b32 s3, 0x7f800000
    v_add_f32_e64 v7, v7, v16
    v_cmp_gt_f32 s[4:5], s3, abs(v7)
    s_nop 1
    s_and_b64 s[4:5], s[4:5], vcc
    s_cmp_eq_u64 s[4:5], -1
    s_cbranch_scc0 .Lsafe_52
.Lback_53:
    s_cmp_lg_u32 s25, 0
    s_cbranch_scc1 .Llate_64
.Llateb_65:
    s_setprio 0
    s_waitcnt vmcnt(2)
    v_mfma_f32_32x32x16_bf16 v[104:119], v[136:139], v[152:155], 0
    ds_read_b64_tr_b16 v[68:69], v14 offset:256
    ds_read_b64_tr_b16 v[70:71], v14 offset:384
    v_mfma_f32_32x32x8_bf16 v[104:119], v[140:141], v[18:19], v[104:119]
    buffer_load_dwordx4 v[240:243], v1, s[8:11], s24 offen offset:1024 sc1
    ds_read_b64_tr_b16 v[56:57], v14 offset:512
    ds_read_b64_tr_b16 v[58:59], v14 offset:640
    ds_read_b64_tr_b16 v[60:61], v14 offset:768
    ds_read_b64_tr_b16 v[62:63], v14 offset:896
    v_mfma_f32_32x32x16_bf16 v[120:135], v[144:147], v[152:155], 0
    buffer_load_dwordx4 v[244:247], v1, s[8:11], s24 offen offset:2048 sc1
    s_lshr_b32 s4, s16, 2
    s_and_b32 s5, s16, 3
    s_lshl_b32 s3, s99, 3
    s_add_u32 s3, s3, s5
    s_mul_i32 s6, s3, 10240
    s_mul_i32 s7, s4, 2621440
    s_add_u32 s6, s6, s7
    s_add_u32 s27, s6, 15728640
    v_mfma_f32_32x32x8_bf16 v[120:135], v[148:149], v[18:19], v[120:135]
    buffer_load_dwordx4 v[248:251], v1, s[8:11], s24 offen offset:3072 sc1
    s_and_b32 s3, s99, 28
    s_add_u32 s3, s3, s5
    s_lshl_b32 s3, s3, 2
    s_and_b32 s6, s99, 3
    s_add_u32 s3, s3, s6
    s_lshl_b32 s3, s3, 1
    s_add_u32 s3, s3, s4
    s_lshl_b32 s3, s3, 7
    s_add_u32 s35, s3, 21266432
    s_mov_b32 vcc_lo, 0xaaaaaaaa
    s_mov_b32 vcc_hi, 0xaaaaaaaa
    v_mov_b32 v7, 0xffff
    v_not_b32 v16, v7
    v_cndmask_b32_e64 v11, v7, v16, vcc
    v_mov_b32 v7, 0xff800000
    s_add_u32 s24, s24, 4096
    buffer_load_dwordx4 v[252:255], v1, s[8:11], s24 offen offset:0 sc1
    v_cndmask_b32 v108, v112, v113, vcc
    v_cndmask_b32 v109, v114, v115, vcc
    v_cndmask_b32 v110, v116, v117, vcc
    v_cndmask_b32 v111, v118, v119, vcc
    v_cndmask_b32 v120, v120, v121, vcc
    v_cndmask_b32 v121, v122, v123, vcc
    v_cndmask_b32 v122, v124, v125, vcc
    v_cndmask_b32 v123, v126, v127, vcc
    v_cndmask_b32 v124, v128, v129, vcc
    v_cndmask_b32 v125, v130, v131, vcc
    v_cndmask_b32 v126, v132, v133, vcc
    v_cndmask_b32 v127, v134, v135, vcc
    v_cndmask_b32 v108, v108, v124, s[52:53]
    v_cndmask_b32 v109, v109, v125, s[56:57]
    v_cndmask_b32 v110, v110, v126, s[60:61]
    v_cndmask_b32 v111, v111, v127, s[64:65]
    v_cndmask_b32 v104, v7, v120, s[68:69]
    v_cndmask_b32 v105, v7, v121, s[70:71]
    v_cndmask_b32 v106, v7, v122, s[72:73]
    v_cndmask_b32 v107, v7, v123, s[74:75]
    v_cndmask_b32 v108, v7, v108, s[76:77]
    v_cndmask_b32 v109, v7, v109, s[78:79]
    v_cndmask_b32 v110, v7, v110, s[80:81]
    v_cndmask_b32 v111, v7, v111, s[82:83]
    v_max3_f32 v16, v104, v105, v106
    v_max3_f32 v17, v107, v108, v109
    v_max3_f32 v16, v16, v110, v111
    v_max_f32 v16, v16, v17
    v_mov_b32 v17, v16
    s_nop 1
    v_permlane32_swap_b32 v16, v17
    v_max_f32 v16, v16, v17
    v_sub_f32 v104, v104, v16
    v_sub_f32 v105, v105, v16
    v_sub_f32 v106, v106, v16
    v_sub_f32 v107, v107, v16
    v_sub_f32 v108, v108, v16
    v_sub_f32 v109, v109, v16
    v_sub_f32 v110, v110, v16
    v_sub_f32 v111, v111, v16
    v_exp_f32 v104, v104
    v_exp_f32 v105, v105
    v_exp_f32 v106, v106
    v_exp_f32 v107, v107
    v_exp_f32 v108, v108
    v_exp_f32 v109, v109
    v_exp_f32 v110, v110
    v_exp_f32_e64 v111, v111
    v_cvt_pk_bf16_f32 v104, v104, v104
    v_cvt_pk_bf16_f32 v105, v105, v105
    v_cvt_pk_bf16_f32 v106, v106, v106
    v_cvt_pk_bf16_f32 v107, v107, v107
    v_cvt_pk_bf16_f32 v108, v108, v108
    v_cvt_pk_bf16_f32 v109, v109, v109
    v_cvt_pk_bf16_f32 v110, v110, v110
    v_cvt_pk_bf16_f32 v111, v111, v111
    v_bitop3_b32 v72, v104, v11, v32 bitop3:0x80
    v_bitop3_b32 v73, v105, v11, v33 bitop3:0x80
    v_bitop3_b32 v74, v106, v11, v34 bitop3:0x80
    v_bitop3_b32 v75, v107, v11, v35 bitop3:0x80
    v_bitop3_b32 v76, v108, v11, v36 bitop3:0x80
    v_bitop3_b32 v77, v109, v11, v37 bitop3:0x80
    v_bitop3_b32 v78, v110, v11, v38 bitop3:0x80
    v_bitop3_b32 v79, v111, v11, v39 bitop3:0x80
    s_waitcnt lgkmcnt(0)
    v_mfma_f32_32x32x16_bf16 v[88:103], v[56:59], v[72:75], 0
    v_bitop3_b32 v84, v108, v11, v36 bitop3:0x40
    v_bitop3_b32 v85, v109, v11, v37 bitop3:0x40
    v_bitop3_b32 v86, v110, v11, v38 bitop3:0x40
    v_bitop3_b32 v87, v111, v11, v39 bitop3:0x40
    v_mfma_f32_32x32x16_bf16 v[88:103], v[60:63], v[76:79], v[88:103]
    s_nop 0
    v_mfma_f32_32x32x16_bf16 v[88:103], v[68:71], v[84:87], v[88:103]
    s_xor_b32 s3, s25, 1
    s_waitcnt vmcnt(4)
    v_mov_b32_e64 v16, s3
    v_mov_b32 v17, 0
    s_mov_b64 exec, 1
    buffer_atomic_add_x2 v[16:17], off, s[8:11], s31 offset:0 sc1
    s_mov_b64 exec, -1
    s_nop 4
    v_rcp_f32 v7, v100
    v_sub_f32 v20, 1.0, v20
    s_add_u32 s30, s30, 2621440
    v_mul_f32 v16, v7, v20
    v_mul_f32 v104, v16, v88
    v_mul_f32 v105, v16, v89
    v_mul_f32 v106, v16, v90
    v_mul_f32 v107, v16, v91
    v_mul_f32 v108, v16, v92
    v_mul_f32 v109, v16, v93
    v_mul_f32 v110, v16, v94
    v_mul_f32_e64 v111, v16, v95
    v_cvt_pk_bf16_f32 v72, v104, v105
    v_cvt_pk_bf16_f32 v73, v106, v107
    v_cvt_pk_bf16_f32 v74, v108, v109
    v_cvt_pk_bf16_f32 v75, v110, v111
    buffer_store_dwordx4 v[72:75], v1, s[8:11], s30 offen sc1
    v_mul_f32 v112, v16, v96
    v_mul_f32 v113, v16, v97
    v_mul_f32 v114, v16, v98
    v_mul_f32 v115, v16, v99
    v_lshlrev_b32_e64 v7, 3, v0
    v_cvt_pk_bf16_f32 v76, v112, v113
    v_cvt_pk_bf16_f32 v77, v114, v115
    s_mov_b32 exec_hi, 0
    buffer_store_dwordx2 v[76:77], v7, s[8:11], s30 offen offset:1024 sc1
    s_mov_b32 exec_hi, -1
    v_mov_b32_e64 v4, 0
    v_mov_b32 v5, 0
    s_mov_b64 exec, 1
    buffer_atomic_or_x2 v[4:5], off, s[8:11], s35 sc0 sc1
    s_mov_b64 exec, -1
    v_add_co_u32 v2, vcc, 16, v2
    s_nop 1
    v_addc_co_u32 v3, vcc, 0, v3, vcc
    v_and_b32 v18, 15, v0
    v_lshrrev_b32 v16, 5, v0
    v_mul_u32_u24 v16, 1280, v16
    v_bfe_u32 v17, v0, 4, 1
    v_lshl_add_u32 v16, v17, 9, v16
    v_lshl_add_u32 v8, v18, 4, v16
    v_lshrrev_b32_e64 v19, 4, v0
    v_mul_u32_u24 v16, 1280, v19
    v_lshl_add_u32 v9, v18, 3, v16
    s_lshl_b32 s3, s16, 12
    s_add_u32 s3, s3, 131072
    v_lshl_add_u32 v10, v0, 2, s3
    s_and_b32 s3, s16, 3
    s_lshl_b32 s3, s3, 14
    s_add_u32 m0, s3, 0
    s_mul_i32 s69, s90, 0
    s_add_u32 s72, s27, 0
    s_add_u32 s73, s27, 5120
    s_add_u32 s74, s27, 40960
    s_add_u32 s75, s27, 46080
    s_and_b32 s5, s16, 3
    s_lshl_b32 s3, s5, 12
    v_add_u32_e64 v20, s3, v1
    v_add_u32 v21, 65536, v20
    s_lshl_b32 s3, s5, 10
    s_add_u32 s3, s3, 131072
    v_add_u32 v22, s3, v1
    v_bfe_u32 v16, v0, 2, 2
    v_lshl_add_u32 v16, v16, 2, v19
    v_mul_u32_u24 v16, 1280, v16
    v_and_b32_e64 v17, 3, v0
    v_lshl_add_u32 v23, v17, 4, v16
    v_lshl_add_u32 v24, v17, 3, v16
    s_add_u32 s3, s69, s16
    s_and_b32 s3, s3, 3
    s_lshl_b32 s4, s99, 2
    s_add_u32 s3, s3, s4
    s_mul_i32 s3, s3, 20480
    s_mul_i32 s4, s90, 160
    s_add_u32 s68, s3, s4
    s_barrier
    s_setprio 3
    s_waitcnt vmcnt(1)
    v_mov_b32_e64 v16, 1
    v_mov_b32 v17, 0
    s_mov_b64 exec, 1
    buffer_atomic_add_x2 v[16:17], off, s[8:11], s31 offset:128 sc1
    s_mov_b64 exec, -1
    s_setprio 2
    s_waitcnt vmcnt(1)
    v_cmp_eq_u64 vcc, v[4:5], v[2:3]
    s_nop 1
    s_cbranch_vccnz .Lcok_67
    s_mov_b32 s3, 131072
.Lcsp_68:
    v_mov_b32_e64 v4, 0
    v_mov_b32 v5, 0
    s_mov_b64 exec, 1
    buffer_atomic_or_x2 v[4:5], off, s[8:11], s35 sc0 sc1
    s_mov_b64 exec, -1
    s_sub_u32 s3, s3, 1
    s_waitcnt vmcnt(0)
    s_cbranch_scc1 .Lcok_67
    v_cmp_eq_u64 vcc, v[4:5], v[2:3]
    s_nop 1
    s_cbranch_vccz .Lcsp_68
.Lcok_67:
.Lgotearly_66:
    buffer_load_dwordx4 v[32:35], v8, s[8:11], s72 offen offset:0 sc1
    buffer_load_dwordx4 v[36:39], v8, s[8:11], s72 offen offset:2560 sc1
    buffer_load_dwordx4 v[40:43], v8, s[8:11], s73 offen offset:0 sc1
    buffer_load_dwordx4 v[44:47], v8, s[8:11], s73 offen offset:2560 sc1
    buffer_load_dwordx2 v[48:49], v9, s[8:11], s72 offen offset:1024 sc1
    buffer_load_dwordx2 v[50:51], v9, s[8:11], s73 offen offset:1024 sc1
    buffer_load_dwordx4 v[52:55], v8, s[8:11], s72 offen offset:256 sc1
    buffer_load_dwordx4 v[56:59], v8, s[8:11], s72 offen offset:2816 sc1
    buffer_load_dwordx4 v[60:63], v8, s[8:11], s73 offen offset:256 sc1
    buffer_load_dwordx4 v[64:67], v8, s[8:11], s73 offen offset:2816 sc1
    s_setprio 2
    s_waitcnt vmcnt(9)
    v_mfma_f32_16x16x32_bf16 v[112:115], v[32:35], v[156:159], 0
    buffer_load_dwordx2 v[68:69], v9, s[8:11], s72 offen offset:1152 sc1
    v_mfma_f32_16x16x32_bf16 v[116:119], v[32:35], v[160:163], 0
    v_mfma_f32_16x16x32_bf16 v[120:123], v[32:35], v[164:167], 0
    v_mfma_f32_16x16x32_bf16 v[124:127], v[32:35], v[168:171], 0
    v_mfma_f32_16x16x32_bf16 v[128:131], v[32:35], v[172:175], 0
    buffer_load_dwordx2 v[70:71], v9, s[8:11], s73 offen offset:1152 sc1
    s_waitcnt vmcnt(10)
    v_mfma_f32_16x16x32_bf16 v[112:115], v[36:39], v[176:179], v[112:115]
    buffer_load_dwordx4 v[72:75], v8, s[8:11], s74 offen offset:0 sc1
    v_mfma_f32_16x16x32_bf16 v[116:119], v[36:39], v[180:183], v[116:119]
    v_mfma_f32_16x16x32_bf16 v[120:123], v[36:39], v[184:187], v[120:123]
    v_mfma_f32_16x16x32_bf16 v[124:127], v[36:39], v[188:191], v[124:127]
    v_mfma_f32_16x16x32_bf16 v[128:131], v[36:39], v[192:195], v[128:131]
    buffer_load_dwordx4 v[76:79], v8, s[8:11], s74 offen offset:2560 sc1
    s_waitcnt vmcnt(11)
    v_mfma_f32_16x16x32_bf16 v[112:115], v[40:43], v[196:199], v[112:115]
    buffer_load_dwordx4 v[80:83], v8, s[8:11], s75 offen offset:0 sc1
    v_mfma_f32_16x16x32_bf16 v[116:119], v[40:43], v[200:203], v[116:119]
    v_mfma_f32_16x16x32_bf16 v[120:123], v[40:43], v[204:207], v[120:123]
    v_mfma_f32_16x16x32_bf16 v[124:127], v[40:43], v[208:211], v[124:127]
    v_mfma_f32_16x16x32_bf16 v[128:131], v[40:43], v[212:215], v[128:131]
    buffer_load_dwordx4 v[84:87], v8, s[8:11], s75 offen offset:2560 sc1
    s_waitcnt vmcnt(12)
    v_mfma_f32_16x16x32_bf16 v[112:115], v[44:47], v[216:219], v[112:115]
    buffer_load_dwordx2 v[88:89], v9, s[8:11], s74 offen offset:1024 sc1
    v_mfma_f32_16x16x32_bf16 v[116:119], v[44:47], v[220:223], v[116:119]
    v_mfma_f32_16x16x32_bf16 v[120:123], v[44:47], v[224:227], v[120:123]
    v_mfma_f32_16x16x32_bf16 v[124:127], v[44:47], v[228:231], v[124:127]
    v_mfma_f32_16x16x32_bf16 v[128:131], v[44:47], v[232:235], v[128:131]
    buffer_load_dwordx2 v[90:91], v9, s[8:11], s75 offen offset:1024 sc1
    s_waitcnt vmcnt(12)
    v_mfma_f32_16x16x32_bf16 v[112:115], v[48:51], v[236:239], v[112:115]
    buffer_load_dwordx4 v[92:95], v8, s[8:11], s74 offen offset:256 sc1
    v_mfma_f32_16x16x32_bf16 v[116:119], v[48:51], v[240:243], v[116:119]
    v_mfma_f32_16x16x32_bf16 v[120:123], v[48:51], v[244:247], v[120:123]
    v_mfma_f32_16x16x32_bf16 v[124:127], v[48:51], v[248:251], v[124:127]
    v_mfma_f32_16x16x32_bf16 v[128:131], v[48:51], v[252:255], v[128:131]
    buffer_load_dwordx4 v[96:99], v8, s[8:11], s74 offen offset:2816 sc1
    s_waitcnt vmcnt(13) lgkmcnt(8)
    v_mfma_f32_16x16x32_bf16 v[132:135], v[52:55], v[156:159], 0
    buffer_load_dwordx4 v[100:103], v8, s[8:11], s75 offen offset:256 sc1
    v_mfma_f32_16x16x32_bf16 v[136:139], v[52:55], v[160:163], 0
    ds_write_addtid_b32 v112 offset:0
    v_mfma_f32_16x16x32_bf16 v[140:143], v[52:55], v[164:167], 0
    ds_write_addtid_b32 v113 offset:256
    v_mfma_f32_16x16x32_bf16 v[144:147], v[52:55], v[168:171], 0
    ds_write_addtid_b32 v114 offset:512
    v_mfma_f32_16x16x32_bf16 v[148:151], v[52:55], v[172:175], 0
    ds_write_addtid_b32 v115 offset:768
    buffer_load_dwordx4 v[104:107], v8, s[8:11], s75 offen offset:2816 sc1
    s_waitcnt vmcnt(14) lgkmcnt(8)
    v_mfma_f32_16x16x32_bf16 v[132:135], v[56:59], v[176:179], v[132:135]
    buffer_load_dwordx2 v[108:109], v9, s[8:11], s74 offen offset:1152 sc1
    v_mfma_f32_16x16x32_bf16 v[136:139], v[56:59], v[180:183], v[136:139]
    ds_write_addtid_b32 v116 offset:1024
    v_mfma_f32_16x16x32_bf16 v[140:143], v[56:59], v[184:187], v[140:143]
    ds_write_addtid_b32 v117 offset:1280
    v_mfma_f32_16x16x32_bf16 v[144:147], v[56:59], v[188:191], v[144:147]
    ds_write_addtid_b32 v118 offset:1536
    v_mfma_f32_16x16x32_bf16 v[148:151], v[56:59], v[192:195], v[148:151]
    ds_write_addtid_b32 v119 offset:1792
    buffer_load_dwordx2 v[110:111], v9, s[8:11], s75 offen offset:1152 sc1
    s_waitcnt vmcnt(15) lgkmcnt(8)
    v_mfma_f32_16x16x32_bf16 v[132:135], v[60:63], v[196:199], v[132:135]
    v_mfma_f32_16x16x32_bf16 v[136:139], v[60:63], v[200:203], v[136:139]
    ds_write_addtid_b32 v120 offset:2048
    v_mfma_f32_16x16x32_bf16 v[140:143], v[60:63], v[204:207], v[140:143]
    ds_write_addtid_b32 v121 offset:2304
    v_mfma_f32_16x16x32_bf16 v[144:147], v[60:63], v[208:211], v[144:147]
    ds_write_addtid_b32 v122 offset:2560
    v_mfma_f32_16x16x32_bf16 v[148:151], v[60:63], v[212:215], v[148:151]
    ds_write_addtid_b32 v123 offset:2816
    s_waitcnt vmcnt(14) lgkmcnt(8)
    v_mfma_f32_16x16x32_bf16 v[132:135], v[64:67], v[216:219], v[132:135]
    v_mfma_f32_16x16x32_bf16 v[136:139], v[64:67], v[220:223], v[136:139]
    ds_write_addtid_b32 v124 offset:3072
    v_mfma_f32_16x16x32_bf16 v[140:143], v[64:67], v[224:227], v[140:143]
    ds_write_addtid_b32 v125 offset:3328
    v_mfma_f32_16x16x32_bf16 v[144:147], v[64:67], v[228:231], v[144:147]
    ds_write_addtid_b32 v126 offset:3584
    v_mfma_f32_16x16x32_bf16 v[148:151], v[64:67], v[232:235], v[148:151]
    ds_write_addtid_b32 v127 offset:3840
    s_waitcnt vmcnt(12) lgkmcnt(8)
    v_mfma_f32_16x16x32_bf16 v[132:135], v[68:71], v[236:239], v[132:135]
    v_mfma_f32_16x16x32_bf16 v[136:139], v[68:71], v[240:243], v[136:139]
    ds_write_b32 v10, v128 offset:0
    v_mfma_f32_16x16x32_bf16 v[140:143], v[68:71], v[244:247], v[140:143]
    ds_write_b32 v10, v129 offset:256
    v_mfma_f32_16x16x32_bf16 v[144:147], v[68:71], v[248:251], v[144:147]
    ds_write_b32 v10, v130 offset:512
    v_mfma_f32_16x16x32_bf16 v[148:151], v[68:71], v[252:255], v[148:151]
    ds_write_b32 v10, v131 offset:768
    s_waitcnt vmcnt(11) lgkmcnt(8)
    v_mfma_f32_16x16x32_bf16 v[112:115], v[72:75], v[156:159], 0
    v_mfma_f32_16x16x32_bf16 v[116:119], v[72:75], v[160:163], 0
    ds_write_addtid_b32 v132 offset:4096
    v_mfma_f32_16x16x32_bf16 v[120:123], v[72:75], v[164:167], 0
    ds_write_addtid_b32 v133 offset:4352
    v_mfma_f32_16x16x32_bf16 v[124:127], v[72:75], v[168:171], 0
    ds_write_addtid_b32 v134 offset:4608
    v_mfma_f32_16x16x32_bf16 v[128:131], v[72:75], v[172:175], 0
    ds_write_addtid_b32 v135 offset:4864
    s_waitcnt vmcnt(10) lgkmcnt(8)
    v_mfma_f32_16x16x32_bf16 v[112:115], v[76:79], v[176:179], v[112:115]
    v_mfma_f32_16x16x32_bf16 v[116:119], v[76:79], v[180:183], v[116:119]
    ds_write_addtid_b32 v136 offset:5120
    v_mfma_f32_16x16x32_bf16 v[120:123], v[76:79], v[184:187], v[120:123]
    ds_write_addtid_b32 v137 offset:5376
    v_mfma_f32_16x16x32_bf16 v[124:127], v[76:79], v[188:191], v[124:127]
    ds_write_addtid_b32 v138 offset:5632
    v_mfma_f32_16x16x32_bf16 v[128:131], v[76:79], v[192:195], v[128:131]
    ds_write_addtid_b32 v139 offset:5888
    s_waitcnt vmcnt(9) lgkmcnt(8)
    v_mfma_f32_16x16x32_bf16 v[112:115], v[80:83], v[196:199], v[112:115]
    v_mfma_f32_16x16x32_bf16 v[116:119], v[80:83], v[200:203], v[116:119]
    ds_write_addtid_b32 v140 offset:6144
    v_mfma_f32_16x16x32_bf16 v[120:123], v[80:83], v[204:207], v[120:123]
    ds_write_addtid_b32 v141 offset:6400
    v_mfma_f32_16x16x32_bf16 v[124:127], v[80:83], v[208:211], v[124:127]
    ds_write_addtid_b32 v142 offset:6656
    v_mfma_f32_16x16x32_bf16 v[128:131], v[80:83], v[212:215], v[128:131]
    ds_write_addtid_b32 v143 offset:6912
    s_waitcnt vmcnt(8) lgkmcnt(8)
    v_mfma_f32_16x16x32_bf16 v[112:115], v[84:87], v[216:219], v[112:115]
    v_mfma_f32_16x16x32_bf16 v[116:119], v[84:87], v[220:223], v[116:119]
    ds_write_addtid_b32 v144 offset:7168
    v_mfma_f32_16x16x32_bf16 v[120:123], v[84:87], v[224:227], v[120:123]
    ds_write_addtid_b32 v145 offset:7424
    v_mfma_f32_16x16x32_bf16 v[124:127], v[84:87], v[228:231], v[124:127]
    ds_write_addtid_b32 v146 offset:7680
    v_mfma_f32_16x16x32_bf16 v[128:131], v[84:87], v[232:235], v[128:131]
    ds_write_addtid_b32 v147 offset:7936
    s_waitcnt vmcnt(6) lgkmcnt(8)
    v_mfma_f32_16x16x32_bf16 v[112:115], v[88:91], v[236:239], v[112:115]
    v_mfma_f32_16x16x32_bf16 v[116:119], v[88:91], v[240:243], v[116:119]
    ds_write_b32 v10, v148 offset:1024
    v_mfma_f32_16x16x32_bf16 v[120:123], v[88:91], v[244:247], v[120:123]
    ds_write_b32 v10, v149 offset:1280
    v_mfma_f32_16x16x32_bf16 v[124:127], v[88:91], v[248:251], v[124:127]
    ds_write_b32 v10, v150 offset:1536
    v_mfma_f32_16x16x32_bf16 v[128:131], v[88:91], v[252:255], v[128:131]
    ds_write_b32 v10, v151 offset:1792
    s_waitcnt vmcnt(5) lgkmcnt(8)
    v_mfma_f32_16x16x32_bf16 v[132:135], v[92:95], v[156:159], 0
    v_mfma_f32_16x16x32_bf16 v[136:139], v[92:95], v[160:163], 0
    ds_write_addtid_b32 v112 offset:8192
    v_mfma_f32_16x16x32_bf16 v[140:143], v[92:95], v[164:167], 0
    ds_write_addtid_b32 v113 offset:8448
    v_mfma_f32_16x16x32_bf16 v[144:147], v[92:95], v[168:171], 0
    ds_write_addtid_b32 v114 offset:8704
    v_mfma_f32_16x16x32_bf16 v[148:151], v[92:95], v[172:175], 0
    ds_write_addtid_b32 v115 offset:8960
    s_waitcnt vmcnt(4) lgkmcnt(8)
    v_mfma_f32_16x16x32_bf16 v[132:135], v[96:99], v[176:179], v[132:135]
    v_mfma_f32_16x16x32_bf16 v[136:139], v[96:99], v[180:183], v[136:139]
    ds_write_addtid_b32 v116 offset:9216
    v_mfma_f32_16x16x32_bf16 v[140:143], v[96:99], v[184:187], v[140:143]
    ds_write_addtid_b32 v117 offset:9472
    v_mfma_f32_16x16x32_bf16 v[144:147], v[96:99], v[188:191], v[144:147]
    ds_write_addtid_b32 v118 offset:9728
    v_mfma_f32_16x16x32_bf16 v[148:151], v[96:99], v[192:195], v[148:151]
    ds_write_addtid_b32 v119 offset:9984
    s_waitcnt vmcnt(3) lgkmcnt(8)
    v_mfma_f32_16x16x32_bf16 v[132:135], v[100:103], v[196:199], v[132:135]
    v_mfma_f32_16x16x32_bf16 v[136:139], v[100:103], v[200:203], v[136:139]
    ds_write_addtid_b32 v120 offset:10240
    v_mfma_f32_16x16x32_bf16 v[140:143], v[100:103], v[204:207], v[140:143]
    ds_write_addtid_b32 v121 offset:10496
    v_mfma_f32_16x16x32_bf16 v[144:147], v[100:103], v[208:211], v[144:147]
    ds_write_addtid_b32 v122 offset:10752
    v_mfma_f32_16x16x32_bf16 v[148:151], v[100:103], v[212:215], v[148:151]
    ds_write_addtid_b32 v123 offset:11008
    s_waitcnt vmcnt(2) lgkmcnt(8)
    v_mfma_f32_16x16x32_bf16 v[132:135], v[104:107], v[216:219], v[132:135]
    v_mfma_f32_16x16x32_bf16 v[136:139], v[104:107], v[220:223], v[136:139]
    ds_write_addtid_b32 v124 offset:11264
    v_mfma_f32_16x16x32_bf16 v[140:143], v[104:107], v[224:227], v[140:143]
    ds_write_addtid_b32 v125 offset:11520
    v_mfma_f32_16x16x32_bf16 v[144:147], v[104:107], v[228:231], v[144:147]
    ds_write_addtid_b32 v126 offset:11776
    v_mfma_f32_16x16x32_bf16 v[148:151], v[104:107], v[232:235], v[148:151]
    ds_write_addtid_b32 v127 offset:12032
    s_waitcnt vmcnt(0) lgkmcnt(8)
    v_mfma_f32_16x16x32_bf16 v[132:135], v[108:111], v[236:239], v[132:135]
    v_mfma_f32_16x16x32_bf16 v[136:139], v[108:111], v[240:243], v[136:139]
    ds_write_b32 v10, v128 offset:2048
    v_mfma_f32_16x16x32_bf16 v[140:143], v[108:111], v[244:247], v[140:143]
    ds_write_b32 v10, v129 offset:2304
    v_mfma_f32_16x16x32_bf16 v[144:147], v[108:111], v[248:251], v[144:147]
    ds_write_b32 v10, v130 offset:2560
    v_mfma_f32_16x16x32_bf16 v[148:151], v[108:111], v[252:255], v[148:151]
    ds_write_b32 v10, v131 offset:2816
    ds_write_addtid_b32 v132 offset:12288
    ds_write_addtid_b32 v133 offset:12544
    ds_write_addtid_b32 v134 offset:12800
    ds_write_addtid_b32 v135 offset:13056
    s_waitcnt lgkmcnt(4)
    ds_write_addtid_b32 v136 offset:13312
    ds_write_addtid_b32 v137 offset:13568
    ds_write_addtid_b32 v138 offset:13824
    ds_write_addtid_b32 v139 offset:14080
    ds_write_addtid_b32 v140 offset:14336
    ds_write_addtid_b32 v141 offset:14592
    ds_write_addtid_b32 v142 offset:14848
    ds_write_addtid_b32 v143 offset:15104
    s_waitcnt lgkmcnt(4)
    ds_write_addtid_b32 v144 offset:15360
    ds_write_addtid_b32 v145 offset:15616
    ds_write_addtid_b32 v146 offset:15872
    ds_write_addtid_b32 v147 offset:16128
    ds_write_b32 v10, v148 offset:3072
    ds_write_b32 v10, v149 offset:3328
    ds_write_b32 v10, v150 offset:3584
    ds_write_b32 v10, v151 offset:3840
    s_waitcnt lgkmcnt(0)
    s_barrier
    ds_read_b128 v[32:35], v20 offset:0
    ds_read_b128 v[36:39], v20 offset:16384
    ds_read_b128 v[40:43], v20 offset:32768
    ds_read_b128 v[44:47], v20 offset:49152
    ds_read_b128 v[48:51], v21 offset:0
    ds_read_b128 v[52:55], v21 offset:16384
    ds_read_b128 v[56:59], v21 offset:32768
    ds_read_b128 v[60:63], v21 offset:49152
    ds_read_b128 v[64:67], v20 offset:1024
    ds_read_b128 v[68:71], v20 offset:17408
    ds_read_b128 v[72:75], v20 offset:33792
    ds_read_b128 v[76:79], v20 offset:50176
    s_waitcnt lgkmcnt(8)
    ds_read_b128 v[80:83], v21 offset:1024
    ds_read_b128 v[84:87], v21 offset:17408
    ds_read_b128 v[88:91], v21 offset:33792
    ds_read_b128 v[92:95], v21 offset:50176
    v_pk_add_f32 v[32:33], v[32:33], v[36:37]
    v_pk_add_f32 v[34:35], v[34:35], v[38:39]
    v_pk_add_f32 v[40:41], v[40:41], v[44:45]
    v_pk_add_f32 v[42:43], v[42:43], v[46:47]
    v_pk_add_f32 v[32:33], v[32:33], v[40:41]
    v_pk_add_f32 v[34:35], v[34:35], v[42:43]
    s_waitcnt lgkmcnt(8)
    ds_read_b128 v[96:99], v22 offset:0
    ds_read_b128 v[100:103], v22 offset:4096
    ds_read_b128 v[104:107], v22 offset:8192
    ds_read_b128 v[108:111], v22 offset:12288
    v_pk_add_f32 v[48:49], v[48:49], v[52:53]
    v_pk_add_f32 v[50:51], v[50:51], v[54:55]
    v_pk_add_f32 v[56:57], v[56:57], v[60:61]
    v_pk_add_f32 v[58:59], v[58:59], v[62:63]
    v_pk_add_f32 v[48:49], v[48:49], v[56:57]
    v_pk_add_f32 v[50:51], v[50:51], v[58:59]
    v_pk_add_f32 v[32:33], v[32:33], v[48:49]
    v_pk_add_f32 v[34:35], v[34:35], v[50:51]
    v_cvt_pk_bf16_f32 v136, v32, v33
    v_cvt_pk_bf16_f32 v137, v34, v35
    s_waitcnt lgkmcnt(8)
    ds_read_b128 v[112:115], v22 offset:16384
    ds_read_b128 v[116:119], v22 offset:20480
    ds_read_b128 v[120:123], v22 offset:24576
    ds_read_b128 v[124:127], v22 offset:28672
    v_pk_add_f32 v[64:65], v[64:65], v[68:69]
    v_pk_add_f32 v[66:67], v[66:67], v[70:71]
    v_pk_add_f32 v[72:73], v[72:73], v[76:77]
    v_pk_add_f32 v[74:75], v[74:75], v[78:79]
    v_pk_add_f32 v[64:65], v[64:65], v[72:73]
    v_pk_add_f32 v[66:67], v[66:67], v[74:75]
    s_waitcnt lgkmcnt(8)
    v_pk_add_f32 v[80:81], v[80:81], v[84:85]
    v_pk_add_f32 v[82:83], v[82:83], v[86:87]
    v_pk_add_f32 v[88:89], v[88:89], v[92:93]
    v_pk_add_f32 v[90:91], v[90:91], v[94:95]
    v_pk_add_f32 v[80:81], v[80:81], v[88:89]
    v_pk_add_f32 v[82:83], v[82:83], v[90:91]
    v_pk_add_f32 v[64:65], v[64:65], v[80:81]
    v_pk_add_f32 v[66:67], v[66:67], v[82:83]
    v_cvt_pk_bf16_f32 v138, v64, v65
    v_cvt_pk_bf16_f32 v139, v66, v67
    buffer_store_dwordx4 v[136:139], v23, s[12:15], s68 offen offset:0
    s_waitcnt lgkmcnt(4)
    v_pk_add_f32 v[96:97], v[96:97], v[100:101]
    v_pk_add_f32 v[98:99], v[98:99], v[102:103]
    v_pk_add_f32 v[104:105], v[104:105], v[108:109]
    v_pk_add_f32 v[106:107], v[106:107], v[110:111]
    v_pk_add_f32 v[96:97], v[96:97], v[104:105]
    v_pk_add_f32 v[98:99], v[98:99], v[106:107]
    s_waitcnt lgkmcnt(0)
    v_pk_add_f32 v[112:113], v[112:113], v[116:117]
    v_pk_add_f32 v[114:115], v[114:115], v[118:119]
    v_pk_add_f32 v[120:121], v[120:121], v[124:125]
    v_pk_add_f32 v[122:123], v[122:123], v[126:127]
    v_pk_add_f32 v[112:113], v[112:113], v[120:121]
    v_pk_add_f32 v[114:115], v[114:115], v[122:123]
    v_pk_add_f32 v[96:97], v[96:97], v[112:113]
    v_pk_add_f32 v[98:99], v[98:99], v[114:115]
    v_cvt_pk_bf16_f32 v144, v96, v97
    v_cvt_pk_bf16_f32 v145, v98, v99
    buffer_store_dwordx2 v[144:145], v24, s[12:15], s68 offen offset:128
    s_endpgm
.Lnsp_10:
    s_mov_b32 s3, 131072
.Lnsp_69:
    buffer_load_dwordx2 v[94:95], off, s[32:35], 0 sc1
    s_sub_u32 s3, s3, 1
    s_waitcnt vmcnt(0)
    s_cbranch_scc1 .Lnok_9
    v_cmp_eq_u32 vcc, 0, v94
    s_nop 1
    s_cbranch_vccnz .Lnsp_69
    s_branch .Lnok_9
.Lredo_13:
    s_lshl_b32 s5, s16, 3
    s_add_u32 s5, s5, s90
    s_mul_i32 s5, s5, 25600
    s_add_u32 s24, s5, 21577728
    buffer_load_dwordx4 v[156:159], v1, s[8:11], s24 offen offset:0 sc1
    buffer_load_dwordx4 v[160:163], v1, s[8:11], s24 offen offset:1024 sc1
    buffer_load_dwordx4 v[164:167], v1, s[8:11], s24 offen offset:2048 sc1
    buffer_load_dwordx4 v[168:171], v1, s[8:11], s24 offen offset:3072 sc1
    s_waitcnt vmcnt(0)
    s_branch .Lredone_14
.Lchance_17:
    s_mov_b64 exec, vcc
    buffer_load_dwordx2 v[4:5], v12, s[8:11], 0 offen sc1
    s_mov_b64 exec, -1
    s_branch .Lchback_18
.Lchance_19:
    s_waitcnt vmcnt(0)
    v_cmp_ne_u64 vcc, v[4:5], v[2:3]
    s_nop 1
    s_cbranch_vccnz .Lnotyet_70
    s_mov_b32 s25, 0
    s_add_u32 s5, s28, 163840
    s_add_u32 s6, s29, 163840
    buffer_load_dwordx4 v[152:155], v30, s[8:11], s28 offen sc1
    s_mov_b32 exec_hi, 0
    buffer_load_dwordx2 v[18:19], v31, s[8:11], s28 offen sc1
    s_mov_b32 exec_hi, -1
    buffer_load_dwordx4 v[144:147], v30, s[8:11], s5 offen sc1
    buffer_load_dwordx2 v[148:149], v31, s[8:11], s5 offen sc1
    s_mov_b32 exec_lo, 0xffff0000
    s_mov_b32 exec_hi, 0xffff0000
    buffer_load_dwordx4 v[136:139], v30, s[8:11], s6 offen sc1
    buffer_load_dwordx2 v[140:141], v31, s[8:11], s6 offen sc1
    s_mov_b32 exec_hi, -1
    s_mul_i32 s4, s16, 3328
    s_add_u32 m0, s4, 33344
    s_add_u32 s3, s29, 327680
    buffer_load_dwordx4 v15, s[8:11], s3 offen sc1 lds
    s_add_u32 m0, s4, 34432
    s_add_u32 s3, s29, 329728
    buffer_load_dwordx4 v15, s[8:11], s3 offen sc1 lds
    s_add_u32 m0, s4, 35520
    s_add_u32 s3, s29, 331776
    buffer_load_dwordx4 v15, s[8:11], s3 offen sc1 lds
    s_mov_b32 exec_lo, -1
    s_branch .Lchback_20
.Lnotyet_70:
    s_mov_b64 exec, vcc
    buffer_load_dwordx2 v[4:5], v12, s[8:11], 0 offen sc1
    s_mov_b64 exec, -1
    s_branch .Lchback_20
.Lchance_21:
    s_waitcnt vmcnt(0)
    v_cmp_ne_u64 vcc, v[4:5], v[2:3]
    s_nop 1
    s_cbranch_vccnz .Lnotyet_71
    s_mov_b32 s25, 0
    s_add_u32 s5, s28, 163840
    s_add_u32 s6, s29, 163840
    buffer_load_dwordx4 v[152:155], v30, s[8:11], s28 offen sc1
    s_mov_b32 exec_hi, 0
    buffer_load_dwordx2 v[18:19], v31, s[8:11], s28 offen sc1
    s_mov_b32 exec_hi, -1
    buffer_load_dwordx4 v[144:147], v30, s[8:11], s5 offen sc1
    buffer_load_dwordx2 v[148:149], v31, s[8:11], s5 offen sc1
    s_mov_b32 exec_lo, 0xffff0000
    s_mov_b32 exec_hi, 0xffff0000
    buffer_load_dwordx4 v[136:139], v30, s[8:11], s6 offen sc1
    buffer_load_dwordx2 v[140:141], v31, s[8:11], s6 offen sc1
    s_mov_b32 exec_hi, -1
    s_mul_i32 s4, s16, 3328
    s_add_u32 m0, s4, 33344
    s_add_u32 s3, s29, 327680
    buffer_load_dwordx4 v15, s[8:11], s3 offen sc1 lds
    s_add_u32 m0, s4, 34432
    s_add_u32 s3, s29, 329728
    buffer_load_dwordx4 v15, s[8:11], s3 offen sc1 lds
    s_add_u32 m0, s4, 35520
    s_add_u32 s3, s29, 331776
    buffer_load_dwordx4 v15, s[8:11], s3 offen sc1 lds
    s_mov_b32 exec_lo, -1
    s_branch .Lchback_22
.Lnotyet_71:
    s_mov_b64 exec, vcc
    buffer_load_dwordx2 v[4:5], v12, s[8:11], 0 offen sc1
    s_mov_b64 exec, -1
    s_branch .Lchback_22
.Lchance_23:
    s_waitcnt vmcnt(0)
    v_cmp_ne_u64 vcc, v[4:5], v[2:3]
    s_nop 1
    s_cbranch_vccnz .Lnotyet_72
    s_mov_b32 s25, 0
    s_add_u32 s5, s28, 163840
    s_add_u32 s6, s29, 163840
    buffer_load_dwordx4 v[152:155], v30, s[8:11], s28 offen sc1
    s_mov_b32 exec_hi, 0
    buffer_load_dwordx2 v[18:19], v31, s[8:11], s28 offen sc1
    s_mov_b32 exec_hi, -1
    buffer_load_dwordx4 v[144:147], v30, s[8:11], s5 offen sc1
    buffer_load_dwordx2 v[148:149], v31, s[8:11], s5 offen sc1
    s_mov_b32 exec_lo, 0xffff0000
    s_mov_b32 exec_hi, 0xffff0000
    buffer_load_dwordx4 v[136:139], v30, s[8:11], s6 offen sc1
    buffer_load_dwordx2 v[140:141], v31, s[8:11], s6 offen sc1
    s_mov_b32 exec_hi, -1
    s_mul_i32 s4, s16, 3328
    s_add_u32 m0, s4, 33344
    s_add_u32 s3, s29, 327680
    buffer_load_dwordx4 v15, s[8:11], s3 offen sc1 lds
    s_add_u32 m0, s4, 34432
    s_add_u32 s3, s29, 329728
    buffer_load_dwordx4 v15, s[8:11], s3 offen sc1 lds
    s_add_u32 m0, s4, 35520
    s_add_u32 s3, s29, 331776
    buffer_load_dwordx4 v15, s[8:11], s3 offen sc1 lds
    s_mov_b32 exec_lo, -1
    s_branch .Lchback_24
.Lnotyet_72:
    s_branch .Lchback_24
.Llate_27:
    s_waitcnt vmcnt(2)
    s_mov_b64 exec, 0x1ff5
    buffer_load_dwordx2 v[4:5], v12, s[8:11], 0 offen sc1
    s_mov_b64 exec, -1
    s_waitcnt vmcnt(0)
    v_cmp_ne_u64 vcc, v[4:5], v[2:3]
    s_nop 1
    s_cbranch_vccz .Lpok_73
    s_mov_b32 s3, 131072
.Lpsp_74:
    s_nop 0
    s_mov_b64 exec, vcc
    buffer_load_dwordx2 v[4:5], v12, s[8:11], 0 offen sc1
    s_mov_b64 exec, -1
    s_sub_u32 s3, s3, 1
    s_waitcnt vmcnt(0)
    s_cbranch_scc1 .Lpok_73
    v_cmp_ne_u64 vcc, v[4:5], v[2:3]
    s_nop 1
    s_cbranch_vccnz .Lpsp_74
.Lpok_73:
    s_add_u32 s5, s28, 163840
    s_add_u32 s6, s29, 163840
    buffer_load_dwordx4 v[152:155], v30, s[8:11], s28 offen sc1
    s_mov_b32 exec_hi, 0
    buffer_load_dwordx2 v[18:19], v31, s[8:11], s28 offen sc1
    s_mov_b32 exec_hi, -1
    buffer_load_dwordx4 v[144:147], v30, s[8:11], s5 offen sc1
    buffer_load_dwordx2 v[148:149], v31, s[8:11], s5 offen sc1
    s_mov_b32 exec_lo, 0xffff0000
    s_mov_b32 exec_hi, 0xffff0000
    buffer_load_dwordx4 v[136:139], v30, s[8:11], s6 offen sc1
    buffer_load_dwordx2 v[140:141], v31, s[8:11], s6 offen sc1
    s_mov_b32 exec_hi, -1
    s_mul_i32 s4, s16, 3328
    s_add_u32 m0, s4, 33344
    s_add_u32 s3, s29, 327680
    buffer_load_dwordx4 v15, s[8:11], s3 offen sc1 lds
    s_add_u32 m0, s4, 34432
    s_add_u32 s3, s29, 329728
    buffer_load_dwordx4 v15, s[8:11], s3 offen sc1 lds
    s_add_u32 m0, s4, 35520
    s_add_u32 s3, s29, 331776
    buffer_load_dwordx4 v15, s[8:11], s3 offen sc1 lds
    s_mov_b32 exec_lo, -1
    v_mov_b32 v16, 1
    v_mov_b32 v17, 0
    s_mov_b64 exec, 1
    buffer_atomic_add_x2 v[16:17], off, s[8:11], s31 offset:0 sc1
    s_mov_b64 exec, -1
    s_waitcnt vmcnt(0)
    s_branch .Llateb_28
.Lnsp_35:
    s_mov_b32 s3, 131072
.Lnsp_75:
    buffer_load_dwordx2 v[2:3], off, s[32:35], 0 sc1
    s_sub_u32 s3, s3, 1
    s_waitcnt vmcnt(0)
    s_cbranch_scc1 .Lnok_34
    v_cmp_eq_u32 vcc, 0, v2
    s_nop 1
    s_cbranch_vccnz .Lnsp_75
    s_branch .Lnok_34
.Lvbfirst_40:
    s_and_b64 s[68:69], s[68:69], s[36:37]
    s_and_b64 s[70:71], s[70:71], s[40:41]
    s_and_b64 s[72:73], s[72:73], s[44:45]
    s_and_b64 s[74:75], s[74:75], s[48:49]
    s_and_b64 s[76:77], s[76:77], s[52:53]
    s_and_b64 s[78:79], s[78:79], s[56:57]
    s_and_b64 s[80:81], s[80:81], s[60:61]
    s_and_b64 s[82:83], s[82:83], s[64:65]
    s_branch .Lvbok_39
.Lnsp_47:
    s_mov_b32 s3, 131072
.Lnsp_76:
    buffer_load_dwordx2 v[2:3], off, s[32:35], 0 sc1
    s_sub_u32 s3, s3, 1
    s_waitcnt vmcnt(0)
    s_cbranch_scc1 .Lnok_46
    v_cmp_eq_u32 vcc, 0, v2
    s_nop 1
    s_cbranch_vccnz .Lnsp_76
    s_branch .Lnok_46
.Lcinit_48:
    v_mov_b32 v12, v2
    v_mov_b32 v13, v3
    v_mov_b32 v14, v2
    v_mov_b32 v15, v3
    v_lshlrev_b32 v7, 4, v0
    buffer_store_dwordx4 v[12:15], v7, s[8:11], s74 offen sc1
    s_branch .Lcinited_49
.Lvbfirst_51:
    s_and_b64 s[68:69], s[68:69], s[36:37]
    s_and_b64 s[70:71], s[70:71], s[40:41]
    s_and_b64 s[72:73], s[72:73], s[44:45]
    s_and_b64 s[74:75], s[74:75], s[48:49]
    s_and_b64 s[76:77], s[76:77], s[52:53]
    s_and_b64 s[78:79], s[78:79], s[56:57]
    s_and_b64 s[80:81], s[80:81], s[60:61]
    s_and_b64 s[82:83], s[82:83], s[64:65]
    s_branch .Lvbok_50
.Lchance_54:
    s_mov_b64 exec, vcc
    buffer_load_dwordx2 v[4:5], v12, s[8:11], 0 offen sc1
    s_mov_b64 exec, -1
    s_branch .Lchback_55
.Lchance_56:
    s_waitcnt vmcnt(0)
    v_cmp_ne_u64 vcc, v[4:5], v[2:3]
    s_nop 1
    s_cbranch_vccnz .Lnotyet_77
    s_mov_b32 s25, 0
    s_add_u32 s5, s28, 163840
    s_add_u32 s6, s29, 163840
    buffer_load_dwordx4 v[152:155], v30, s[8:11], s28 offen sc1
    s_mov_b32 exec_hi, 0
    buffer_load_dwordx2 v[18:19], v31, s[8:11], s28 offen sc1
    s_mov_b32 exec_hi, -1
    buffer_load_dwordx4 v[144:147], v30, s[8:11], s5 offen sc1
    buffer_load_dwordx2 v[148:149], v31, s[8:11], s5 offen sc1
    s_mov_b32 exec_lo, 0xffff0000
    s_mov_b32 exec_hi, 0xffff0000
    buffer_load_dwordx4 v[136:139], v30, s[8:11], s6 offen sc1
    buffer_load_dwordx2 v[140:141], v31, s[8:11], s6 offen sc1
    s_mov_b32 exec_hi, -1
    s_mul_i32 s4, s16, 3328
    s_add_u32 m0, s4, 33344
    s_add_u32 s3, s29, 327680
    buffer_load_dwordx4 v15, s[8:11], s3 offen sc1 lds
    s_add_u32 m0, s4, 34432
    s_add_u32 s3, s29, 329728
    buffer_load_dwordx4 v15, s[8:11], s3 offen sc1 lds
    s_add_u32 m0, s4, 35520
    s_add_u32 s3, s29, 331776
    buffer_load_dwordx4 v15, s[8:11], s3 offen sc1 lds
    s_mov_b32 exec_lo, -1
    s_branch .Lchback_57
.Lnotyet_77:
    s_mov_b64 exec, vcc
    buffer_load_dwordx2 v[4:5], v12, s[8:11], 0 offen sc1
    s_mov_b64 exec, -1
    s_branch .Lchback_57
.Lchance_58:
    s_waitcnt vmcnt(0)
    v_cmp_ne_u64 vcc, v[4:5], v[2:3]
    s_nop 1
    s_cbranch_vccnz .Lnotyet_78
    s_mov_b32 s25, 0
    s_add_u32 s5, s28, 163840
    s_add_u32 s6, s29, 163840
    buffer_load_dwordx4 v[152:155], v30, s[8:11], s28 offen sc1
    s_mov_b32 exec_hi, 0
    buffer_load_dwordx2 v[18:19], v31, s[8:11], s28 offen sc1
    s_mov_b32 exec_hi, -1
    buffer_load_dwordx4 v[144:147], v30, s[8:11], s5 offen sc1
    buffer_load_dwordx2 v[148:149], v31, s[8:11], s5 offen sc1
    s_mov_b32 exec_lo, 0xffff0000
    s_mov_b32 exec_hi, 0xffff0000
    buffer_load_dwordx4 v[136:139], v30, s[8:11], s6 offen sc1
    buffer_load_dwordx2 v[140:141], v31, s[8:11], s6 offen sc1
    s_mov_b32 exec_hi, -1
    s_mul_i32 s4, s16, 3328
    s_add_u32 m0, s4, 33344
    s_add_u32 s3, s29, 327680
    buffer_load_dwordx4 v15, s[8:11], s3 offen sc1 lds
    s_add_u32 m0, s4, 34432
    s_add_u32 s3, s29, 329728
    buffer_load_dwordx4 v15, s[8:11], s3 offen sc1 lds
    s_add_u32 m0, s4, 35520
    s_add_u32 s3, s29, 331776
    buffer_load_dwordx4 v15, s[8:11], s3 offen sc1 lds
    s_mov_b32 exec_lo, -1
    s_branch .Lchback_59
.Lnotyet_78:
    s_mov_b64 exec, vcc
    buffer_load_dwordx2 v[4:5], v12, s[8:11], 0 offen sc1
    s_mov_b64 exec, -1
    s_branch .Lchback_59
.Lchance_60:
    s_waitcnt vmcnt(0)
    v_cmp_ne_u64 vcc, v[4:5], v[2:3]
    s_nop 1
    s_cbranch_vccnz .Lnotyet_79
    s_mov_b32 s25, 0
    s_add_u32 s5, s28, 163840
    s_add_u32 s6, s29, 163840
    buffer_load_dwordx4 v[152:155], v30, s[8:11], s28 offen sc1
    s_mov_b32 exec_hi, 0
    buffer_load_dwordx2 v[18:19], v31, s[8:11], s28 offen sc1
    s_mov_b32 exec_hi, -1
    buffer_load_dwordx4 v[144:147], v30, s[8:11], s5 offen sc1
    buffer_load_dwordx2 v[148:149], v31, s[8:11], s5 offen sc1
    s_mov_b32 exec_lo, 0xffff0000
    s_mov_b32 exec_hi, 0xffff0000
    buffer_load_dwordx4 v[136:139], v30, s[8:11], s6 offen sc1
    buffer_load_dwordx2 v[140:141], v31, s[8:11], s6 offen sc1
    s_mov_b32 exec_hi, -1
    s_mul_i32 s4, s16, 3328
    s_add_u32 m0, s4, 33344
    s_add_u32 s3, s29, 327680
    buffer_load_dwordx4 v15, s[8:11], s3 offen sc1 lds
    s_add_u32 m0, s4, 34432
    s_add_u32 s3, s29, 329728
    buffer_load_dwordx4 v15, s[8:11], s3 offen sc1 lds
    s_add_u32 m0, s4, 35520
    s_add_u32 s3, s29, 331776
    buffer_load_dwordx4 v15, s[8:11], s3 offen sc1 lds
    s_mov_b32 exec_lo, -1
    s_branch .Lchback_61
.Lnotyet_79:
    s_branch .Lchback_61
.Llate_64:
    s_waitcnt vmcnt(2)
    s_mov_b64 exec, 0x1ff5
    buffer_load_dwordx2 v[4:5], v12, s[8:11], 0 offen sc1
    s_mov_b64 exec, -1
    s_waitcnt vmcnt(0)
    v_cmp_ne_u64 vcc, v[4:5], v[2:3]
    s_nop 1
    s_cbranch_vccz .Lpok_80
    s_mov_b32 s3, 131072
.Lpsp_81:
    s_nop 0
    s_mov_b64 exec, vcc
    buffer_load_dwordx2 v[4:5], v12, s[8:11], 0 offen sc1
    s_mov_b64 exec, -1
    s_sub_u32 s3, s3, 1
    s_waitcnt vmcnt(0)
    s_cbranch_scc1 .Lpok_80
    v_cmp_ne_u64 vcc, v[4:5], v[2:3]
    s_nop 1
    s_cbranch_vccnz .Lpsp_81
.Lpok_80:
    s_add_u32 s5, s28, 163840
    s_add_u32 s6, s29, 163840
    buffer_load_dwordx4 v[152:155], v30, s[8:11], s28 offen sc1
    s_mov_b32 exec_hi, 0
    buffer_load_dwordx2 v[18:19], v31, s[8:11], s28 offen sc1
    s_mov_b32 exec_hi, -1
    buffer_load_dwordx4 v[144:147], v30, s[8:11], s5 offen sc1
    buffer_load_dwordx2 v[148:149], v31, s[8:11], s5 offen sc1
    s_mov_b32 exec_lo, 0xffff0000
    s_mov_b32 exec_hi, 0xffff0000
    buffer_load_dwordx4 v[136:139], v30, s[8:11], s6 offen sc1
    buffer_load_dwordx2 v[140:141], v31, s[8:11], s6 offen sc1
    s_mov_b32 exec_hi, -1
    s_mul_i32 s4, s16, 3328
    s_add_u32 m0, s4, 33344
    s_add_u32 s3, s29, 327680
    buffer_load_dwordx4 v15, s[8:11], s3 offen sc1 lds
    s_add_u32 m0, s4, 34432
    s_add_u32 s3, s29, 329728
    buffer_load_dwordx4 v15, s[8:11], s3 offen sc1 lds
    s_add_u32 m0, s4, 35520
    s_add_u32 s3, s29, 331776
    buffer_load_dwordx4 v15, s[8:11], s3 offen sc1 lds
    s_mov_b32 exec_lo, -1
    v_mov_b32 v16, 1
    v_mov_b32 v17, 0
    s_mov_b64 exec, 1
    buffer_atomic_add_x2 v[16:17], off, s[8:11], s31 offset:0 sc1
    s_mov_b64 exec, -1
    s_waitcnt vmcnt(0)
    s_branch .Llateb_65
.Lhot_end:
.Lsafe_15:
    v_mov_b32 v7, 0xff800000
    ds_read_b128 v[40:43], v8 offset:0
    ds_read_b64 v[44:45], v9 offset:0
    ds_read_b128 v[48:51], v8 offset:4096
    ds_read_b64 v[52:53], v9 offset:2048
    s_waitcnt lgkmcnt(0)
    v_mfma_f32_32x32x16_bf16 v[104:119], v[40:43], v[24:27], 0
    v_mfma_f32_32x32x8_bf16 v[104:119], v[44:45], v[28:29], v[104:119]
    v_mfma_f32_32x32x16_bf16 v[120:135], v[48:51], v[24:27], 0
    v_mfma_f32_32x32x8_bf16 v[120:135], v[52:53], v[28:29], v[120:135]
    s_cmp_lg_u32 s19, 0
    s_cbranch_scc1 .Lhasold_82
    s_nop 7
    v_mov_b32 v104, v7
    v_mov_b32 v105, v7
    v_mov_b32 v106, v7
    v_mov_b32 v107, v7
    v_mov_b32 v108, v7
    v_mov_b32 v109, v7
    v_mov_b32 v110, v7
    v_mov_b32 v111, v7
    v_mov_b32 v112, v7
    v_mov_b32 v113, v7
    v_mov_b32 v114, v7
    v_mov_b32 v115, v7
    v_mov_b32 v116, v7
    v_mov_b32 v117, v7
    v_mov_b32 v118, v7
    v_mov_b32 v119, v7
.Lhasold_82:
    s_nop 9
    v_cndmask_b32 v120, v104, v120, s[36:37]
    v_cndmask_b32 v121, v105, v121, s[38:39]
    v_cndmask_b32 v122, v106, v122, s[40:41]
    v_cndmask_b32 v123, v107, v123, s[42:43]
    v_cndmask_b32 v124, v108, v124, s[44:45]
    v_cndmask_b32 v125, v109, v125, s[46:47]
    v_cndmask_b32 v126, v110, v126, s[48:49]
    v_cndmask_b32 v127, v111, v127, s[50:51]
    v_cndmask_b32 v128, v112, v128, s[52:53]
    v_cndmask_b32 v129, v113, v129, s[54:55]
    v_cndmask_b32 v130, v114, v130, s[56:57]
    v_cndmask_b32 v131, v115, v131, s[58:59]
    v_cndmask_b32 v132, v116, v132, s[60:61]
    v_cndmask_b32 v133, v117, v133, s[62:63]
    v_cndmask_b32 v134, v118, v134, s[64:65]
    v_cndmask_b32 v135, v119, v135, s[66:67]
    v_max_f32 v16, v120, v121
    v_max3_f32 v16, v16, v122, v123
    v_max3_f32 v16, v16, v124, v125
    v_max3_f32 v16, v16, v126, v127
    v_max3_f32 v16, v16, v128, v129
    v_max3_f32 v16, v16, v130, v131
    v_max3_f32 v16, v16, v132, v133
    v_max3_f32 v16, v16, v134, v135
    s_cmp_gt_u32 s26, 1
    s_cbranch_scc1 .Lskip_83
    ds_read_b128 v[40:43], v8 offset:512
    ds_read_b64 v[44:45], v9 offset:256
    s_waitcnt lgkmcnt(0)
    v_mfma_f32_32x32x16_bf16 v[104:119], v[40:43], v[24:27], 0
    v_mfma_f32_32x32x8_bf16 v[104:119], v[44:45], v[28:29], v[104:119]
    s_nop 11
    v_max3_f32 v16, v16, v104, v105
    v_max3_f32 v16, v16, v106, v107
    v_max3_f32 v16, v16, v108, v109
    v_max3_f32 v16, v16, v110, v111
    v_max3_f32 v16, v16, v112, v113
    v_max3_f32 v16, v16, v114, v115
    v_max3_f32 v16, v16, v116, v117
    v_max3_f32 v16, v16, v118, v119
.Lskip_83:
    s_cmp_gt_u32 s26, 2
    s_cbranch_scc1 .Lskip_84
    ds_read_b128 v[40:43], v8 offset:1024
    ds_read_b64 v[44:45], v9 offset:512
    s_waitcnt lgkmcnt(0)
    v_mfma_f32_32x32x16_bf16 v[104:119], v[40:43], v[24:27], 0
    v_mfma_f32_32x32x8_bf16 v[104:119], v[44:45], v[28:29], v[104:119]
    s_nop 11
    v_max3_f32 v16, v16, v104, v105
    v_max3_f32 v16, v16, v106, v107
    v_max3_f32 v16, v16, v108, v109
    v_max3_f32 v16, v16, v110, v111
    v_max3_f32 v16, v16, v112, v113
    v_max3_f32 v16, v16, v114, v115
    v_max3_f32 v16, v16, v116, v117
    v_max3_f32 v16, v16, v118, v119
.Lskip_84:
    s_cmp_gt_u32 s26, 3
    s_cbranch_scc1 .Lskip_85
    ds_read_b128 v[40:43], v8 offset:1536
    ds_read_b64 v[44:45], v9 offset:768
    s_waitcnt lgkmcnt(0)
    v_mfma_f32_32x32x16_bf16 v[104:119], v[40:43], v[24:27], 0
    v_mfma_f32_32x32x8_bf16 v[104:119], v[44:45], v[28:29], v[104:119]
    s_nop 11
    v_max3_f32 v16, v16, v104, v105
    v_max3_f32 v16, v16, v106, v107
    v_max3_f32 v16, v16, v108, v109
    v_max3_f32 v16, v16, v110, v111
    v_max3_f32 v16, v16, v112, v113
    v_max3_f32 v16, v16, v114, v115
    v_max3_f32 v16, v16, v116, v117
    v_max3_f32 v16, v16, v118, v119
.Lskip_85:
    s_cmp_gt_u32 s26, 4
    s_cbranch_scc1 .Lskip_86
    ds_read_b128 v[40:43], v8 offset:2048
    ds_read_b64 v[44:45], v9 offset:1024
    s_waitcnt lgkmcnt(0)
    v_mfma_f32_32x32x16_bf16 v[104:119], v[40:43], v[24:27], 0
    v_mfma_f32_32x32x8_bf16 v[104:119], v[44:45], v[28:29], v[104:119]
    s_nop 11
    v_max3_f32 v16, v16, v104, v105
    v_max3_f32 v16, v16, v106, v107
    v_max3_f32 v16, v16, v108, v109
    v_max3_f32 v16, v16, v110, v111
    v_max3_f32 v16, v16, v112, v113
    v_max3_f32 v16, v16, v114, v115
    v_max3_f32 v16, v16, v116, v117
    v_max3_f32 v16, v16, v118, v119
.Lskip_86:
    s_cmp_gt_u32 s26, 5
    s_cbranch_scc1 .Lskip_87
    ds_read_b128 v[40:43], v8 offset:2560
    ds_read_b64 v[44:45], v9 offset:1280
    s_waitcnt lgkmcnt(0)
    v_mfma_f32_32x32x16_bf16 v[104:119], v[40:43], v[24:27], 0
    v_mfma_f32_32x32x8_bf16 v[104:119], v[44:45], v[28:29], v[104:119]
    s_nop 11
    v_max3_f32 v16, v16, v104, v105
    v_max3_f32 v16, v16, v106, v107
    v_max3_f32 v16, v16, v108, v109
    v_max3_f32 v16, v16, v110, v111
    v_max3_f32 v16, v16, v112, v113
    v_max3_f32 v16, v16, v114, v115
    v_max3_f32 v16, v16, v116, v117
    v_max3_f32 v16, v16, v118, v119
.Lskip_87:
    s_cmp_gt_u32 s26, 6
    s_cbranch_scc1 .Lskip_88
    ds_read_b128 v[40:43], v8 offset:3072
    ds_read_b64 v[44:45], v9 offset:1536
    s_waitcnt lgkmcnt(0)
    v_mfma_f32_32x32x16_bf16 v[104:119], v[40:43], v[24:27], 0
    v_mfma_f32_32x32x8_bf16 v[104:119], v[44:45], v[28:29], v[104:119]
    s_nop 11
    v_max3_f32 v16, v16, v104, v105
    v_max3_f32 v16, v16, v106, v107
    v_max3_f32 v16, v16, v108, v109
    v_max3_f32 v16, v16, v110, v111
    v_max3_f32 v16, v16, v112, v113
    v_max3_f32 v16, v16, v114, v115
    v_max3_f32 v16, v16, v116, v117
    v_max3_f32 v16, v16, v118, v119
.Lskip_88:
    s_cmp_gt_u32 s26, 7
    s_cbranch_scc1 .Lskip_89
    ds_read_b128 v[40:43], v8 offset:3584
    ds_read_b64 v[44:45], v9 offset:1792
    s_waitcnt lgkmcnt(0)
    v_mfma_f32_32x32x16_bf16 v[104:119], v[40:43], v[24:27], 0
    v_mfma_f32_32x32x8_bf16 v[104:119], v[44:45], v[28:29], v[104:119]
    s_nop 11
    v_max3_f32 v16, v16, v104, v105
    v_max3_f32 v16, v16, v106, v107
    v_max3_f32 v16, v16, v108, v109
    v_max3_f32 v16, v16, v110, v111
    v_max3_f32 v16, v16, v112, v113
    v_max3_f32 v16, v16, v114, v115
    v_max3_f32 v16, v16, v116, v117
    v_max3_f32 v16, v16, v118, v119
.Lskip_89:
    v_mov_b32 v17, v16
    s_nop 1
    v_permlane32_swap_b32 v16, v17
    v_max_f32 v16, v16, v17
    ds_read_b64_tr_b16 v[56:57], v13 offset:4096
    ds_read_b64_tr_b16 v[58:59], v13 offset:4224
    ds_read_b64_tr_b16 v[60:61], v13 offset:4352
    ds_read_b64_tr_b16 v[62:63], v13 offset:4480
    ds_read_b64_tr_b16 v[64:65], v13 offset:0
    ds_read_b64_tr_b16 v[66:67], v13 offset:128
    ds_read_b64_tr_b16 v[68:69], v13 offset:256
    ds_read_b64_tr_b16 v[70:71], v13 offset:384
    v_sub_f32 v120, v120, v16
    v_sub_f32 v121, v121, v16
    v_sub_f32 v122, v122, v16
    v_sub_f32 v123, v123, v16
    v_sub_f32 v124, v124, v16
    v_sub_f32 v125, v125, v16
    v_sub_f32 v126, v126, v16
    v_sub_f32 v127, v127, v16
    v_sub_f32 v128, v128, v16
    v_sub_f32 v129, v129, v16
    v_sub_f32 v130, v130, v16
    v_sub_f32 v131, v131, v16
    v_sub_f32 v132, v132, v16
    v_sub_f32 v133, v133, v16
    v_sub_f32 v134, v134, v16
    v_sub_f32 v135, v135, v16
    v_exp_f32 v120, v120
    v_exp_f32 v121, v121
    v_exp_f32 v122, v122
    v_exp_f32 v123, v123
    v_exp_f32 v124, v124
    v_exp_f32 v125, v125
    v_exp_f32 v126, v126
    v_exp_f32 v127, v127
    v_exp_f32 v128, v128
    v_exp_f32 v129, v129
    v_exp_f32 v130, v130
    v_exp_f32 v131, v131
    v_exp_f32 v132, v132
    v_exp_f32 v133, v133
    v_exp_f32 v134, v134
    v_exp_f32 v135, v135
    v_cvt_pk_bf16_f32 v80, v120, v121
    v_cvt_pk_bf16_f32 v81, v122, v123
    v_cvt_pk_bf16_f32 v82, v124, v125
    v_cvt_pk_bf16_f32 v83, v126, v127
    v_cvt_pk_bf16_f32 v84, v128, v129
    v_cvt_pk_bf16_f32 v85, v130, v131
    v_cvt_pk_bf16_f32 v86, v132, v133
    v_cvt_pk_bf16_f32 v87, v134, v135
    v_and_b32 v72, v80, v32
    v_and_b32 v73, v81, v33
    v_and_b32 v74, v82, v34
    v_and_b32 v75, v83, v35
    v_and_b32 v76, v84, v36
    v_and_b32 v77, v85, v37
    v_and_b32 v78, v86, v38
    v_and_b32 v79, v87, v39
    v_xor_b32 v80, v80, v72
    v_xor_b32 v81, v81, v73
    v_xor_b32 v82, v82, v74
    v_xor_b32 v83, v83, v75
    v_xor_b32 v84, v84, v76
    v_xor_b32 v85, v85, v77
    v_xor_b32 v86, v86, v78
    v_xor_b32 v87, v87, v79
    s_waitcnt lgkmcnt(0)
    v_mfma_f32_32x32x16_bf16 v[88:103], v[56:59], v[72:75], 0
    v_mfma_f32_32x32x16_bf16 v[88:103], v[60:63], v[76:79], v[88:103]
    v_mfma_f32_32x32x16_bf16 v[88:103], v[64:67], v[80:83], v[88:103]
    v_mfma_f32_32x32x16_bf16 v[88:103], v[68:71], v[84:87], v[88:103]
    s_cmp_gt_u32 s26, 1
    s_cbranch_scc1 .Lskip_90
    ds_read_b128 v[40:43], v8 offset:512
    ds_read_b64 v[44:45], v9 offset:256
    ds_read_b64_tr_b16 v[56:57], v13 offset:512
    ds_read_b64_tr_b16 v[58:59], v13 offset:640
    ds_read_b64_tr_b16 v[60:61], v13 offset:768
    ds_read_b64_tr_b16 v[62:63], v13 offset:896
    s_waitcnt lgkmcnt(0)
    v_mfma_f32_32x32x16_bf16 v[104:119], v[40:43], v[24:27], 0
    v_mfma_f32_32x32x8_bf16 v[104:119], v[44:45], v[28:29], v[104:119]
    s_nop 11
    v_sub_f32 v104, v104, v16
    v_sub_f32 v105, v105, v16
    v_sub_f32 v106, v106, v16
    v_sub_f32 v107, v107, v16
    v_sub_f32 v108, v108, v16
    v_sub_f32 v109, v109, v16
    v_sub_f32 v110, v110, v16
    v_sub_f32 v111, v111, v16
    v_sub_f32 v112, v112, v16
    v_sub_f32 v113, v113, v16
    v_sub_f32 v114, v114, v16
    v_sub_f32 v115, v115, v16
    v_sub_f32 v116, v116, v16
    v_sub_f32 v117, v117, v16
    v_sub_f32 v118, v118, v16
    v_sub_f32 v119, v119, v16
    v_exp_f32 v104, v104
    v_exp_f32 v105, v105
    v_exp_f32 v106, v106
    v_exp_f32 v107, v107
    v_exp_f32 v108, v108
    v_exp_f32 v109, v109
    v_exp_f32 v110, v110
    v_exp_f32 v111, v111
    v_exp_f32 v112, v112
    v_exp_f32 v113, v113
    v_exp_f32 v114, v114
    v_exp_f32 v115, v115
    v_exp_f32 v116, v116
    v_exp_f32 v117, v117
    v_exp_f32 v118, v118
    v_exp_f32 v119, v119
    v_cvt_pk_bf16_f32 v72, v104, v105
    v_cvt_pk_bf16_f32 v73, v106, v107
    v_cvt_pk_bf16_f32 v74, v108, v109
    v_cvt_pk_bf16_f32 v75, v110, v111
    v_cvt_pk_bf16_f32 v76, v112, v113
    v_cvt_pk_bf16_f32 v77, v114, v115
    v_cvt_pk_bf16_f32 v78, v116, v117
    v_cvt_pk_bf16_f32 v79, v118, v119
    v_mfma_f32_32x32x16_bf16 v[88:103], v[56:59], v[72:75], v[88:103]
    s_nop 0
    v_mfma_f32_32x32x16_bf16 v[88:103], v[60:63], v[76:79], v[88:103]
.Lskip_90:
    s_cmp_gt_u32 s26, 2
    s_cbranch_scc1 .Lskip_91
    ds_read_b128 v[40:43], v8 offset:1024
    ds_read_b64 v[44:45], v9 offset:512
    ds_read_b64_tr_b16 v[56:57], v13 offset:1024
    ds_read_b64_tr_b16 v[58:59], v13 offset:1152
    ds_read_b64_tr_b16 v[60:61], v13 offset:1280
    ds_read_b64_tr_b16 v[62:63], v13 offset:1408
    s_waitcnt lgkmcnt(0)
    v_mfma_f32_32x32x16_bf16 v[104:119], v[40:43], v[24:27], 0
    v_mfma_f32_32x32x8_bf16 v[104:119], v[44:45], v[28:29], v[104:119]
    s_nop 11
    v_sub_f32 v104, v104, v16
    v_sub_f32 v105, v105, v16
    v_sub_f32 v106, v106, v16
    v_sub_f32 v107, v107, v16
    v_sub_f32 v108, v108, v16
    v_sub_f32 v109, v109, v16
    v_sub_f32 v110, v110, v16
    v_sub_f32 v111, v111, v16
    v_sub_f32 v112, v112, v16
    v_sub_f32 v113, v113, v16
    v_sub_f32 v114, v114, v16
    v_sub_f32 v115, v115, v16
    v_sub_f32 v116, v116, v16
    v_sub_f32 v117, v117, v16
    v_sub_f32 v118, v118, v16
    v_sub_f32 v119, v119, v16
    v_exp_f32 v104, v104
    v_exp_f32 v105, v105
    v_exp_f32 v106, v106
    v_exp_f32 v107, v107
    v_exp_f32 v108, v108
    v_exp_f32 v109, v109
    v_exp_f32 v110, v110
    v_exp_f32 v111, v111
    v_exp_f32 v112, v112
    v_exp_f32 v113, v113
    v_exp_f32 v114, v114
    v_exp_f32 v115, v115
    v_exp_f32 v116, v116
    v_exp_f32 v117, v117
    v_exp_f32 v118, v118
    v_exp_f32 v119, v119
    v_cvt_pk_bf16_f32 v72, v104, v105
    v_cvt_pk_bf16_f32 v73, v106, v107
    v_cvt_pk_bf16_f32 v74, v108, v109
    v_cvt_pk_bf16_f32 v75, v110, v111
    v_cvt_pk_bf16_f32 v76, v112, v113
    v_cvt_pk_bf16_f32 v77, v114, v115
    v_cvt_pk_bf16_f32 v78, v116, v117
    v_cvt_pk_bf16_f32 v79, v118, v119
    v_mfma_f32_32x32x16_bf16 v[88:103], v[56:59], v[72:75], v[88:103]
    s_nop 0
    v_mfma_f32_32x32x16_bf16 v[88:103], v[60:63], v[76:79], v[88:103]
.Lskip_91:
    s_cmp_gt_u32 s26, 3
    s_cbranch_scc1 .Lskip_92
    ds_read_b128 v[40:43], v8 offset:1536
    ds_read_b64 v[44:45], v9 offset:768
    ds_read_b64_tr_b16 v[56:57], v13 offset:1536
    ds_read_b64_tr_b16 v[58:59], v13 offset:1664
    ds_read_b64_tr_b16 v[60:61], v13 offset:1792
    ds_read_b64_tr_b16 v[62:63], v13 offset:1920
    s_waitcnt lgkmcnt(0)
    v_mfma_f32_32x32x16_bf16 v[104:119], v[40:43], v[24:27], 0
    v_mfma_f32_32x32x8_bf16 v[104:119], v[44:45], v[28:29], v[104:119]
    s_nop 11
    v_sub_f32 v104, v104, v16
    v_sub_f32 v105, v105, v16
    v_sub_f32 v106, v106, v16
    v_sub_f32 v107, v107, v16
    v_sub_f32 v108, v108, v16
    v_sub_f32 v109, v109, v16
    v_sub_f32 v110, v110, v16
    v_sub_f32 v111, v111, v16
    v_sub_f32 v112, v112, v16
    v_sub_f32 v113, v113, v16
    v_sub_f32 v114, v114, v16
    v_sub_f32 v115, v115, v16
    v_sub_f32 v116, v116, v16
    v_sub_f32 v117, v117, v16
    v_sub_f32 v118, v118, v16
    v_sub_f32 v119, v119, v16
    v_exp_f32 v104, v104
    v_exp_f32 v105, v105
    v_exp_f32 v106, v106
    v_exp_f32 v107, v107
    v_exp_f32 v108, v108
    v_exp_f32 v109, v109
    v_exp_f32 v110, v110
    v_exp_f32 v111, v111
    v_exp_f32 v112, v112
    v_exp_f32 v113, v113
    v_exp_f32 v114, v114
    v_exp_f32 v115, v115
    v_exp_f32 v116, v116
    v_exp_f32 v117, v117
    v_exp_f32 v118, v118
    v_exp_f32 v119, v119
    v_cvt_pk_bf16_f32 v72, v104, v105
    v_cvt_pk_bf16_f32 v73, v106, v107
    v_cvt_pk_bf16_f32 v74, v108, v109
    v_cvt_pk_bf16_f32 v75, v110, v111
    v_cvt_pk_bf16_f32 v76, v112, v113
    v_cvt_pk_bf16_f32 v77, v114, v115
    v_cvt_pk_bf16_f32 v78, v116, v117
    v_cvt_pk_bf16_f32 v79, v118, v119
    v_mfma_f32_32x32x16_bf16 v[88:103], v[56:59], v[72:75], v[88:103]
    s_nop 0
    v_mfma_f32_32x32x16_bf16 v[88:103], v[60:63], v[76:79], v[88:103]
.Lskip_92:
    s_cmp_gt_u32 s26, 4
    s_cbranch_scc1 .Lskip_93
    ds_read_b128 v[40:43], v8 offset:2048
    ds_read_b64 v[44:45], v9 offset:1024
    ds_read_b64_tr_b16 v[56:57], v13 offset:2048
    ds_read_b64_tr_b16 v[58:59], v13 offset:2176
    ds_read_b64_tr_b16 v[60:61], v13 offset:2304
    ds_read_b64_tr_b16 v[62:63], v13 offset:2432
    s_waitcnt lgkmcnt(0)
    v_mfma_f32_32x32x16_bf16 v[104:119], v[40:43], v[24:27], 0
    v_mfma_f32_32x32x8_bf16 v[104:119], v[44:45], v[28:29], v[104:119]
    s_nop 11
    v_sub_f32 v104, v104, v16
    v_sub_f32 v105, v105, v16
    v_sub_f32 v106, v106, v16
    v_sub_f32 v107, v107, v16
    v_sub_f32 v108, v108, v16
    v_sub_f32 v109, v109, v16
    v_sub_f32 v110, v110, v16
    v_sub_f32 v111, v111, v16
    v_sub_f32 v112, v112, v16
    v_sub_f32 v113, v113, v16
    v_sub_f32 v114, v114, v16
    v_sub_f32 v115, v115, v16
    v_sub_f32 v116, v116, v16
    v_sub_f32 v117, v117, v16
    v_sub_f32 v118, v118, v16
    v_sub_f32 v119, v119, v16
    v_exp_f32 v104, v104
    v_exp_f32 v105, v105
    v_exp_f32 v106, v106
    v_exp_f32 v107, v107
    v_exp_f32 v108, v108
    v_exp_f32 v109, v109
    v_exp_f32 v110, v110
    v_exp_f32 v111, v111
    v_exp_f32 v112, v112
    v_exp_f32 v113, v113
    v_exp_f32 v114, v114
    v_exp_f32 v115, v115
    v_exp_f32 v116, v116
    v_exp_f32 v117, v117
    v_exp_f32 v118, v118
    v_exp_f32 v119, v119
    v_cvt_pk_bf16_f32 v72, v104, v105
    v_cvt_pk_bf16_f32 v73, v106, v107
    v_cvt_pk_bf16_f32 v74, v108, v109
    v_cvt_pk_bf16_f32 v75, v110, v111
    v_cvt_pk_bf16_f32 v76, v112, v113
    v_cvt_pk_bf16_f32 v77, v114, v115
    v_cvt_pk_bf16_f32 v78, v116, v117
    v_cvt_pk_bf16_f32 v79, v118, v119
    v_mfma_f32_32x32x16_bf16 v[88:103], v[56:59], v[72:75], v[88:103]
    s_nop 0
    v_mfma_f32_32x32x16_bf16 v[88:103], v[60:63], v[76:79], v[88:103]
.Lskip_93:
    s_cmp_gt_u32 s26, 5
    s_cbranch_scc1 .Lskip_94
    ds_read_b128 v[40:43], v8 offset:2560
    ds_read_b64 v[44:45], v9 offset:1280
    ds_read_b64_tr_b16 v[56:57], v13 offset:2560
    ds_read_b64_tr_b16 v[58:59], v13 offset:2688
    ds_read_b64_tr_b16 v[60:61], v13 offset:2816
    ds_read_b64_tr_b16 v[62:63], v13 offset:2944
    s_waitcnt lgkmcnt(0)
    v_mfma_f32_32x32x16_bf16 v[104:119], v[40:43], v[24:27], 0
    v_mfma_f32_32x32x8_bf16 v[104:119], v[44:45], v[28:29], v[104:119]
    s_nop 11
    v_sub_f32 v104, v104, v16
    v_sub_f32 v105, v105, v16
    v_sub_f32 v106, v106, v16
    v_sub_f32 v107, v107, v16
    v_sub_f32 v108, v108, v16
    v_sub_f32 v109, v109, v16
    v_sub_f32 v110, v110, v16
    v_sub_f32 v111, v111, v16
    v_sub_f32 v112, v112, v16
    v_sub_f32 v113, v113, v16
    v_sub_f32 v114, v114, v16
    v_sub_f32 v115, v115, v16
    v_sub_f32 v116, v116, v16
    v_sub_f32 v117, v117, v16
    v_sub_f32 v118, v118, v16
    v_sub_f32 v119, v119, v16
    v_exp_f32 v104, v104
    v_exp_f32 v105, v105
    v_exp_f32 v106, v106
    v_exp_f32 v107, v107
    v_exp_f32 v108, v108
    v_exp_f32 v109, v109
    v_exp_f32 v110, v110
    v_exp_f32 v111, v111
    v_exp_f32 v112, v112
    v_exp_f32 v113, v113
    v_exp_f32 v114, v114
    v_exp_f32 v115, v115
    v_exp_f32 v116, v116
    v_exp_f32 v117, v117
    v_exp_f32 v118, v118
    v_exp_f32 v119, v119
    v_cvt_pk_bf16_f32 v72, v104, v105
    v_cvt_pk_bf16_f32 v73, v106, v107
    v_cvt_pk_bf16_f32 v74, v108, v109
    v_cvt_pk_bf16_f32 v75, v110, v111
    v_cvt_pk_bf16_f32 v76, v112, v113
    v_cvt_pk_bf16_f32 v77, v114, v115
    v_cvt_pk_bf16_f32 v78, v116, v117
    v_cvt_pk_bf16_f32 v79, v118, v119
    v_mfma_f32_32x32x16_bf16 v[88:103], v[56:59], v[72:75], v[88:103]
    s_nop 0
    v_mfma_f32_32x32x16_bf16 v[88:103], v[60:63], v[76:79], v[88:103]
.Lskip_94:
    s_cmp_gt_u32 s26, 6
    s_cbranch_scc1 .Lskip_95
    ds_read_b128 v[40:43], v8 offset:3072
    ds_read_b64 v[44:45], v9 offset:1536
    ds_read_b64_tr_b16 v[56:57], v13 offset:3072
    ds_read_b64_tr_b16 v[58:59], v13 offset:3200
    ds_read_b64_tr_b16 v[60:61], v13 offset:3328
    ds_read_b64_tr_b16 v[62:63], v13 offset:3456
    s_waitcnt lgkmcnt(0)
    v_mfma_f32_32x32x16_bf16 v[104:119], v[40:43], v[24:27], 0
    v_mfma_f32_32x32x8_bf16 v[104:119], v[44:45], v[28:29], v[104:119]
    s_nop 11
    v_sub_f32 v104, v104, v16
    v_sub_f32 v105, v105, v16
    v_sub_f32 v106, v106, v16
    v_sub_f32 v107, v107, v16
    v_sub_f32 v108, v108, v16
    v_sub_f32 v109, v109, v16
    v_sub_f32 v110, v110, v16
    v_sub_f32 v111, v111, v16
    v_sub_f32 v112, v112, v16
    v_sub_f32 v113, v113, v16
    v_sub_f32 v114, v114, v16
    v_sub_f32 v115, v115, v16
    v_sub_f32 v116, v116, v16
    v_sub_f32 v117, v117, v16
    v_sub_f32 v118, v118, v16
    v_sub_f32 v119, v119, v16
    v_exp_f32 v104, v104
    v_exp_f32 v105, v105
    v_exp_f32 v106, v106
    v_exp_f32 v107, v107
    v_exp_f32 v108, v108
    v_exp_f32 v109, v109
    v_exp_f32 v110, v110
    v_exp_f32 v111, v111
    v_exp_f32 v112, v112
    v_exp_f32 v113, v113
    v_exp_f32 v114, v114
    v_exp_f32 v115, v115
    v_exp_f32 v116, v116
    v_exp_f32 v117, v117
    v_exp_f32 v118, v118
    v_exp_f32 v119, v119
    v_cvt_pk_bf16_f32 v72, v104, v105
    v_cvt_pk_bf16_f32 v73, v106, v107
    v_cvt_pk_bf16_f32 v74, v108, v109
    v_cvt_pk_bf16_f32 v75, v110, v111
    v_cvt_pk_bf16_f32 v76, v112, v113
    v_cvt_pk_bf16_f32 v77, v114, v115
    v_cvt_pk_bf16_f32 v78, v116, v117
    v_cvt_pk_bf16_f32 v79, v118, v119
    v_mfma_f32_32x32x16_bf16 v[88:103], v[56:59], v[72:75], v[88:103]
    s_nop 0
    v_mfma_f32_32x32x16_bf16 v[88:103], v[60:63], v[76:79], v[88:103]
.Lskip_95:
    s_cmp_gt_u32 s26, 7
    s_cbranch_scc1 .Lskip_96
    ds_read_b128 v[40:43], v8 offset:3584
    ds_read_b64 v[44:45], v9 offset:1792
    ds_read_b64_tr_b16 v[56:57], v13 offset:3584
    ds_read_b64_tr_b16 v[58:59], v13 offset:3712
    ds_read_b64_tr_b16 v[60:61], v13 offset:3840
    ds_read_b64_tr_b16 v[62:63], v13 offset:3968
    s_waitcnt lgkmcnt(0)
    v_mfma_f32_32x32x16_bf16 v[104:119], v[40:43], v[24:27], 0
    v_mfma_f32_32x32x8_bf16 v[104:119], v[44:45], v[28:29], v[104:119]
    s_nop 11
    v_sub_f32 v104, v104, v16
    v_sub_f32 v105, v105, v16
    v_sub_f32 v106, v106, v16
    v_sub_f32 v107, v107, v16
    v_sub_f32 v108, v108, v16
    v_sub_f32 v109, v109, v16
    v_sub_f32 v110, v110, v16
    v_sub_f32 v111, v111, v16
    v_sub_f32 v112, v112, v16
    v_sub_f32 v113, v113, v16
    v_sub_f32 v114, v114, v16
    v_sub_f32 v115, v115, v16
    v_sub_f32 v116, v116, v16
    v_sub_f32 v117, v117, v16
    v_sub_f32 v118, v118, v16
    v_sub_f32 v119, v119, v16
    v_exp_f32 v104, v104
    v_exp_f32 v105, v105
    v_exp_f32 v106, v106
    v_exp_f32 v107, v107
    v_exp_f32 v108, v108
    v_exp_f32 v109, v109
    v_exp_f32 v110, v110
    v_exp_f32 v111, v111
    v_exp_f32 v112, v112
    v_exp_f32 v113, v113
    v_exp_f32 v114, v114
    v_exp_f32 v115, v115
    v_exp_f32 v116, v116
    v_exp_f32 v117, v117
    v_exp_f32 v118, v118
    v_exp_f32 v119, v119
    v_cvt_pk_bf16_f32 v72, v104, v105
    v_cvt_pk_bf16_f32 v73, v106, v107
    v_cvt_pk_bf16_f32 v74, v108, v109
    v_cvt_pk_bf16_f32 v75, v110, v111
    v_cvt_pk_bf16_f32 v76, v112, v113
    v_cvt_pk_bf16_f32 v77, v114, v115
    v_cvt_pk_bf16_f32 v78, v116, v117
    v_cvt_pk_bf16_f32 v79, v118, v119
    v_mfma_f32_32x32x16_bf16 v[88:103], v[56:59], v[72:75], v[88:103]
    s_nop 0
    v_mfma_f32_32x32x16_bf16 v[88:103], v[60:63], v[76:79], v[88:103]
.Lskip_96:
    s_waitcnt vmcnt(0)
    s_nop 10
    v_rcp_f32 v7, v100
    s_nop 0
    v_mul_f32 v16, v7, v20
    v_mul_f32 v104, v16, v88
    v_mul_f32 v105, v16, v89
    v_mul_f32 v106, v16, v90
    v_mul_f32 v107, v16, v91
    v_mul_f32 v108, v16, v92
    v_mul_f32 v109, v16, v93
    v_mul_f32 v110, v16, v94
    v_mul_f32 v111, v16, v95
    v_cvt_pk_bf16_f32 v72, v104, v105
    v_cvt_pk_bf16_f32 v73, v106, v107
    v_cvt_pk_bf16_f32 v74, v108, v109
    v_cvt_pk_bf16_f32 v75, v110, v111
    buffer_store_dwordx4 v[72:75], v1, s[8:11], s30 offen sc1
    v_mul_f32 v112, v16, v96
    v_mul_f32 v113, v16, v97
    v_mul_f32 v114, v16, v98
    v_mul_f32 v115, v16, v99
    v_lshlrev_b32 v7, 3, v0
    v_cvt_pk_bf16_f32 v76, v112, v113
    v_cvt_pk_bf16_f32 v77, v114, v115
    s_mov_b32 exec_hi, 0
    buffer_store_dwordx2 v[76:77], v7, s[8:11], s30 offen offset:1024 sc1
    s_mov_b32 exec_hi, -1
    s_branch .Lback_16
.Lsafe_52:
    v_mov_b32 v7, 0xff800000
    ds_read_b128 v[40:43], v8 offset:0
    ds_read_b64 v[44:45], v9 offset:0
    ds_read_b128 v[48:51], v8 offset:4096
    ds_read_b64 v[52:53], v9 offset:2048
    s_waitcnt lgkmcnt(0)
    v_mfma_f32_32x32x16_bf16 v[104:119], v[40:43], v[24:27], 0
    v_mfma_f32_32x32x8_bf16 v[104:119], v[44:45], v[28:29], v[104:119]
    v_mfma_f32_32x32x16_bf16 v[120:135], v[48:51], v[24:27], 0
    v_mfma_f32_32x32x8_bf16 v[120:135], v[52:53], v[28:29], v[120:135]
    s_cmp_lg_u32 s19, 0
    s_cbranch_scc1 .Lhasold_97
    s_nop 7
    v_mov_b32 v104, v7
    v_mov_b32 v105, v7
    v_mov_b32 v106, v7
    v_mov_b32 v107, v7
    v_mov_b32 v108, v7
    v_mov_b32 v109, v7
    v_mov_b32 v110, v7
    v_mov_b32 v111, v7
    v_mov_b32 v112, v7
    v_mov_b32 v113, v7
    v_mov_b32 v114, v7
    v_mov_b32 v115, v7
    v_mov_b32 v116, v7
    v_mov_b32 v117, v7
    v_mov_b32 v118, v7
    v_mov_b32 v119, v7
.Lhasold_97:
    s_nop 9
    v_cndmask_b32 v120, v104, v120, s[36:37]
    v_cndmask_b32 v121, v105, v121, s[38:39]
    v_cndmask_b32 v122, v106, v122, s[40:41]
    v_cndmask_b32 v123, v107, v123, s[42:43]
    v_cndmask_b32 v124, v108, v124, s[44:45]
    v_cndmask_b32 v125, v109, v125, s[46:47]
    v_cndmask_b32 v126, v110, v126, s[48:49]
    v_cndmask_b32 v127, v111, v127, s[50:51]
    v_cndmask_b32 v128, v112, v128, s[52:53]
    v_cndmask_b32 v129, v113, v129, s[54:55]
    v_cndmask_b32 v130, v114, v130, s[56:57]
    v_cndmask_b32 v131, v115, v131, s[58:59]
    v_cndmask_b32 v132, v116, v132, s[60:61]
    v_cndmask_b32 v133, v117, v133, s[62:63]
    v_cndmask_b32 v134, v118, v134, s[64:65]
    v_cndmask_b32 v135, v119, v135, s[66:67]
    v_max_f32 v16, v120, v121
    v_max3_f32 v16, v16, v122, v123
    v_max3_f32 v16, v16, v124, v125
    v_max3_f32 v16, v16, v126, v127
    v_max3_f32 v16, v16, v128, v129
    v_max3_f32 v16, v16, v130, v131
    v_max3_f32 v16, v16, v132, v133
    v_max3_f32 v16, v16, v134, v135
    s_cmp_gt_u32 s26, 1
    s_cbranch_scc1 .Lskip_98
    ds_read_b128 v[40:43], v8 offset:512
    ds_read_b64 v[44:45], v9 offset:256
    s_waitcnt lgkmcnt(0)
    v_mfma_f32_32x32x16_bf16 v[104:119], v[40:43], v[24:27], 0
    v_mfma_f32_32x32x8_bf16 v[104:119], v[44:45], v[28:29], v[104:119]
    s_nop 11
    v_max3_f32 v16, v16, v104, v105
    v_max3_f32 v16, v16, v106, v107
    v_max3_f32 v16, v16, v108, v109
    v_max3_f32 v16, v16, v110, v111
    v_max3_f32 v16, v16, v112, v113
    v_max3_f32 v16, v16, v114, v115
    v_max3_f32 v16, v16, v116, v117
    v_max3_f32 v16, v16, v118, v119
.Lskip_98:
    s_cmp_gt_u32 s26, 2
    s_cbranch_scc1 .Lskip_99
    ds_read_b128 v[40:43], v8 offset:1024
    ds_read_b64 v[44:45], v9 offset:512
    s_waitcnt lgkmcnt(0)
    v_mfma_f32_32x32x16_bf16 v[104:119], v[40:43], v[24:27], 0
    v_mfma_f32_32x32x8_bf16 v[104:119], v[44:45], v[28:29], v[104:119]
    s_nop 11
    v_max3_f32 v16, v16, v104, v105
    v_max3_f32 v16, v16, v106, v107
    v_max3_f32 v16, v16, v108, v109
    v_max3_f32 v16, v16, v110, v111
    v_max3_f32 v16, v16, v112, v113
    v_max3_f32 v16, v16, v114, v115
    v_max3_f32 v16, v16, v116, v117
    v_max3_f32 v16, v16, v118, v119
.Lskip_99:
    s_cmp_gt_u32 s26, 3
    s_cbranch_scc1 .Lskip_100
    ds_read_b128 v[40:43], v8 offset:1536
    ds_read_b64 v[44:45], v9 offset:768
    s_waitcnt lgkmcnt(0)
    v_mfma_f32_32x32x16_bf16 v[104:119], v[40:43], v[24:27], 0
    v_mfma_f32_32x32x8_bf16 v[104:119], v[44:45], v[28:29], v[104:119]
    s_nop 11
    v_max3_f32 v16, v16, v104, v105
    v_max3_f32 v16, v16, v106, v107
    v_max3_f32 v16, v16, v108, v109
    v_max3_f32 v16, v16, v110, v111
    v_max3_f32 v16, v16, v112, v113
    v_max3_f32 v16, v16, v114, v115
    v_max3_f32 v16, v16, v116, v117
    v_max3_f32 v16, v16, v118, v119
.Lskip_100:
    s_cmp_gt_u32 s26, 4
    s_cbranch_scc1 .Lskip_101
    ds_read_b128 v[40:43], v8 offset:2048
    ds_read_b64 v[44:45], v9 offset:1024
    s_waitcnt lgkmcnt(0)
    v_mfma_f32_32x32x16_bf16 v[104:119], v[40:43], v[24:27], 0
    v_mfma_f32_32x32x8_bf16 v[104:119], v[44:45], v[28:29], v[104:119]
    s_nop 11
    v_max3_f32 v16, v16, v104, v105
    v_max3_f32 v16, v16, v106, v107
    v_max3_f32 v16, v16, v108, v109
    v_max3_f32 v16, v16, v110, v111
    v_max3_f32 v16, v16, v112, v113
    v_max3_f32 v16, v16, v114, v115
    v_max3_f32 v16, v16, v116, v117
    v_max3_f32 v16, v16, v118, v119
.Lskip_101:
    s_cmp_gt_u32 s26, 5
    s_cbranch_scc1 .Lskip_102
    ds_read_b128 v[40:43], v8 offset:2560
    ds_read_b64 v[44:45], v9 offset:1280
    s_waitcnt lgkmcnt(0)
    v_mfma_f32_32x32x16_bf16 v[104:119], v[40:43], v[24:27], 0
    v_mfma_f32_32x32x8_bf16 v[104:119], v[44:45], v[28:29], v[104:119]
    s_nop 11
    v_max3_f32 v16, v16, v104, v105
    v_max3_f32 v16, v16, v106, v107
    v_max3_f32 v16, v16, v108, v109
    v_max3_f32 v16, v16, v110, v111
    v_max3_f32 v16, v16, v112, v113
    v_max3_f32 v16, v16, v114, v115
    v_max3_f32 v16, v16, v116, v117
    v_max3_f32 v16, v16, v118, v119
.Lskip_102:
    s_cmp_gt_u32 s26, 6
    s_cbranch_scc1 .Lskip_103
    ds_read_b128 v[40:43], v8 offset:3072
    ds_read_b64 v[44:45], v9 offset:1536
    s_waitcnt lgkmcnt(0)
    v_mfma_f32_32x32x16_bf16 v[104:119], v[40:43], v[24:27], 0
    v_mfma_f32_32x32x8_bf16 v[104:119], v[44:45], v[28:29], v[104:119]
    s_nop 11
    v_max3_f32 v16, v16, v104, v105
    v_max3_f32 v16, v16, v106, v107
    v_max3_f32 v16, v16, v108, v109
    v_max3_f32 v16, v16, v110, v111
    v_max3_f32 v16, v16, v112, v113
    v_max3_f32 v16, v16, v114, v115
    v_max3_f32 v16, v16, v116, v117
    v_max3_f32 v16, v16, v118, v119
.Lskip_103:
    s_cmp_gt_u32 s26, 7
    s_cbranch_scc1 .Lskip_104
    ds_read_b128 v[40:43], v8 offset:3584
    ds_read_b64 v[44:45], v9 offset:1792
    s_waitcnt lgkmcnt(0)
    v_mfma_f32_32x32x16_bf16 v[104:119], v[40:43], v[24:27], 0
    v_mfma_f32_32x32x8_bf16 v[104:119], v[44:45], v[28:29], v[104:119]
    s_nop 11
    v_max3_f32 v16, v16, v104, v105
    v_max3_f32 v16, v16, v106, v107
    v_max3_f32 v16, v16, v108, v109
    v_max3_f32 v16, v16, v110, v111
    v_max3_f32 v16, v16, v112, v113
    v_max3_f32 v16, v16, v114, v115
    v_max3_f32 v16, v16, v116, v117
    v_max3_f32 v16, v16, v118, v119
.Lskip_104:
    v_mov_b32 v17, v16
    s_nop 1
    v_permlane32_swap_b32 v16, v17
    v_max_f32 v16, v16, v17
    ds_read_b64_tr_b16 v[56:57], v13 offset:4096
    ds_read_b64_tr_b16 v[58:59], v13 offset:4224
    ds_read_b64_tr_b16 v[60:61], v13 offset:4352
    ds_read_b64_tr_b16 v[62:63], v13 offset:4480
    ds_read_b64_tr_b16 v[64:65], v13 offset:0
    ds_read_b64_tr_b16 v[66:67], v13 offset:128
    ds_read_b64_tr_b16 v[68:69], v13 offset:256
    ds_read_b64_tr_b16 v[70:71], v13 offset:384
    v_sub_f32 v120, v120, v16
    v_sub_f32 v121, v121, v16
    v_sub_f32 v122, v122, v16
    v_sub_f32 v123, v123, v16
    v_sub_f32 v124, v124, v16
    v_sub_f32 v125, v125, v16
    v_sub_f32 v126, v126, v16
    v_sub_f32 v127, v127, v16
    v_sub_f32 v128, v128, v16
    v_sub_f32 v129, v129, v16
    v_sub_f32 v130, v130, v16
    v_sub_f32 v131, v131, v16
    v_sub_f32 v132, v132, v16
    v_sub_f32 v133, v133, v16
    v_sub_f32 v134, v134, v16
    v_sub_f32 v135, v135, v16
    v_exp_f32 v120, v120
    v_exp_f32 v121, v121
    v_exp_f32 v122, v122
    v_exp_f32 v123, v123
    v_exp_f32 v124, v124
    v_exp_f32 v125, v125
    v_exp_f32 v126, v126
    v_exp_f32 v127, v127
    v_exp_f32 v128, v128
    v_exp_f32 v129, v129
    v_exp_f32 v130, v130
    v_exp_f32 v131, v131
    v_exp_f32 v132, v132
    v_exp_f32 v133, v133
    v_exp_f32 v134, v134
    v_exp_f32 v135, v135
    v_cvt_pk_bf16_f32 v80, v120, v121
    v_cvt_pk_bf16_f32 v81, v122, v123
    v_cvt_pk_bf16_f32 v82, v124, v125
    v_cvt_pk_bf16_f32 v83, v126, v127
    v_cvt_pk_bf16_f32 v84, v128, v129
    v_cvt_pk_bf16_f32 v85, v130, v131
    v_cvt_pk_bf16_f32 v86, v132, v133
    v_cvt_pk_bf16_f32 v87, v134, v135
    v_and_b32 v72, v80, v32
    v_and_b32 v73, v81, v33
    v_and_b32 v74, v82, v34
    v_and_b32 v75, v83, v35
    v_and_b32 v76, v84, v36
    v_and_b32 v77, v85, v37
    v_and_b32 v78, v86, v38
    v_and_b32 v79, v87, v39
    v_xor_b32 v80, v80, v72
    v_xor_b32 v81, v81, v73
    v_xor_b32 v82, v82, v74
    v_xor_b32 v83, v83, v75
    v_xor_b32 v84, v84, v76
    v_xor_b32 v85, v85, v77
    v_xor_b32 v86, v86, v78
    v_xor_b32 v87, v87, v79
    s_waitcnt lgkmcnt(0)
    v_mfma_f32_32x32x16_bf16 v[88:103], v[56:59], v[72:75], 0
    v_mfma_f32_32x32x16_bf16 v[88:103], v[60:63], v[76:79], v[88:103]
    v_mfma_f32_32x32x16_bf16 v[88:103], v[64:67], v[80:83], v[88:103]
    v_mfma_f32_32x32x16_bf16 v[88:103], v[68:71], v[84:87], v[88:103]
    s_cmp_gt_u32 s26, 1
    s_cbranch_scc1 .Lskip_105
    ds_read_b128 v[40:43], v8 offset:512
    ds_read_b64 v[44:45], v9 offset:256
    ds_read_b64_tr_b16 v[56:57], v13 offset:512
    ds_read_b64_tr_b16 v[58:59], v13 offset:640
    ds_read_b64_tr_b16 v[60:61], v13 offset:768
    ds_read_b64_tr_b16 v[62:63], v13 offset:896
    s_waitcnt lgkmcnt(0)
    v_mfma_f32_32x32x16_bf16 v[104:119], v[40:43], v[24:27], 0
    v_mfma_f32_32x32x8_bf16 v[104:119], v[44:45], v[28:29], v[104:119]
    s_nop 11
    v_sub_f32 v104, v104, v16
    v_sub_f32 v105, v105, v16
    v_sub_f32 v106, v106, v16
    v_sub_f32 v107, v107, v16
    v_sub_f32 v108, v108, v16
    v_sub_f32 v109, v109, v16
    v_sub_f32 v110, v110, v16
    v_sub_f32 v111, v111, v16
    v_sub_f32 v112, v112, v16
    v_sub_f32 v113, v113, v16
    v_sub_f32 v114, v114, v16
    v_sub_f32 v115, v115, v16
    v_sub_f32 v116, v116, v16
    v_sub_f32 v117, v117, v16
    v_sub_f32 v118, v118, v16
    v_sub_f32 v119, v119, v16
    v_exp_f32 v104, v104
    v_exp_f32 v105, v105
    v_exp_f32 v106, v106
    v_exp_f32 v107, v107
    v_exp_f32 v108, v108
    v_exp_f32 v109, v109
    v_exp_f32 v110, v110
    v_exp_f32 v111, v111
    v_exp_f32 v112, v112
    v_exp_f32 v113, v113
    v_exp_f32 v114, v114
    v_exp_f32 v115, v115
    v_exp_f32 v116, v116
    v_exp_f32 v117, v117
    v_exp_f32 v118, v118
    v_exp_f32 v119, v119
    v_cvt_pk_bf16_f32 v72, v104, v105
    v_cvt_pk_bf16_f32 v73, v106, v107
    v_cvt_pk_bf16_f32 v74, v108, v109
    v_cvt_pk_bf16_f32 v75, v110, v111
    v_cvt_pk_bf16_f32 v76, v112, v113
    v_cvt_pk_bf16_f32 v77, v114, v115
    v_cvt_pk_bf16_f32 v78, v116, v117
    v_cvt_pk_bf16_f32 v79, v118, v119
    v_mfma_f32_32x32x16_bf16 v[88:103], v[56:59], v[72:75], v[88:103]
    s_nop 0
    v_mfma_f32_32x32x16_bf16 v[88:103], v[60:63], v[76:79], v[88:103]
.Lskip_105:
    s_cmp_gt_u32 s26, 2
    s_cbranch_scc1 .Lskip_106
    ds_read_b128 v[40:43], v8 offset:1024
    ds_read_b64 v[44:45], v9 offset:512
    ds_read_b64_tr_b16 v[56:57], v13 offset:1024
    ds_read_b64_tr_b16 v[58:59], v13 offset:1152
    ds_read_b64_tr_b16 v[60:61], v13 offset:1280
    ds_read_b64_tr_b16 v[62:63], v13 offset:1408
    s_waitcnt lgkmcnt(0)
    v_mfma_f32_32x32x16_bf16 v[104:119], v[40:43], v[24:27], 0
    v_mfma_f32_32x32x8_bf16 v[104:119], v[44:45], v[28:29], v[104:119]
    s_nop 11
    v_sub_f32 v104, v104, v16
    v_sub_f32 v105, v105, v16
    v_sub_f32 v106, v106, v16
    v_sub_f32 v107, v107, v16
    v_sub_f32 v108, v108, v16
    v_sub_f32 v109, v109, v16
    v_sub_f32 v110, v110, v16
    v_sub_f32 v111, v111, v16
    v_sub_f32 v112, v112, v16
    v_sub_f32 v113, v113, v16
    v_sub_f32 v114, v114, v16
    v_sub_f32 v115, v115, v16
    v_sub_f32 v116, v116, v16
    v_sub_f32 v117, v117, v16
    v_sub_f32 v118, v118, v16
    v_sub_f32 v119, v119, v16
    v_exp_f32 v104, v104
    v_exp_f32 v105, v105
    v_exp_f32 v106, v106
    v_exp_f32 v107, v107
    v_exp_f32 v108, v108
    v_exp_f32 v109, v109
    v_exp_f32 v110, v110
    v_exp_f32 v111, v111
    v_exp_f32 v112, v112
    v_exp_f32 v113, v113
    v_exp_f32 v114, v114
    v_exp_f32 v115, v115
    v_exp_f32 v116, v116
    v_exp_f32 v117, v117
    v_exp_f32 v118, v118
    v_exp_f32 v119, v119
    v_cvt_pk_bf16_f32 v72, v104, v105
    v_cvt_pk_bf16_f32 v73, v106, v107
    v_cvt_pk_bf16_f32 v74, v108, v109
    v_cvt_pk_bf16_f32 v75, v110, v111
    v_cvt_pk_bf16_f32 v76, v112, v113
    v_cvt_pk_bf16_f32 v77, v114, v115
    v_cvt_pk_bf16_f32 v78, v116, v117
    v_cvt_pk_bf16_f32 v79, v118, v119
    v_mfma_f32_32x32x16_bf16 v[88:103], v[56:59], v[72:75], v[88:103]
    s_nop 0
    v_mfma_f32_32x32x16_bf16 v[88:103], v[60:63], v[76:79], v[88:103]
.Lskip_106:
    s_cmp_gt_u32 s26, 3
    s_cbranch_scc1 .Lskip_107
    ds_read_b128 v[40:43], v8 offset:1536
    ds_read_b64 v[44:45], v9 offset:768
    ds_read_b64_tr_b16 v[56:57], v13 offset:1536
    ds_read_b64_tr_b16 v[58:59], v13 offset:1664
    ds_read_b64_tr_b16 v[60:61], v13 offset:1792
    ds_read_b64_tr_b16 v[62:63], v13 offset:1920
    s_waitcnt lgkmcnt(0)
    v_mfma_f32_32x32x16_bf16 v[104:119], v[40:43], v[24:27], 0
    v_mfma_f32_32x32x8_bf16 v[104:119], v[44:45], v[28:29], v[104:119]
    s_nop 11
    v_sub_f32 v104, v104, v16
    v_sub_f32 v105, v105, v16
    v_sub_f32 v106, v106, v16
    v_sub_f32 v107, v107, v16
    v_sub_f32 v108, v108, v16
    v_sub_f32 v109, v109, v16
    v_sub_f32 v110, v110, v16
    v_sub_f32 v111, v111, v16
    v_sub_f32 v112, v112, v16
    v_sub_f32 v113, v113, v16
    v_sub_f32 v114, v114, v16
    v_sub_f32 v115, v115, v16
    v_sub_f32 v116, v116, v16
    v_sub_f32 v117, v117, v16
    v_sub_f32 v118, v118, v16
    v_sub_f32 v119, v119, v16
    v_exp_f32 v104, v104
    v_exp_f32 v105, v105
    v_exp_f32 v106, v106
    v_exp_f32 v107, v107
    v_exp_f32 v108, v108
    v_exp_f32 v109, v109
    v_exp_f32 v110, v110
    v_exp_f32 v111, v111
    v_exp_f32 v112, v112
    v_exp_f32 v113, v113
    v_exp_f32 v114, v114
    v_exp_f32 v115, v115
    v_exp_f32 v116, v116
    v_exp_f32 v117, v117
    v_exp_f32 v118, v118
    v_exp_f32 v119, v119
    v_cvt_pk_bf16_f32 v72, v104, v105
    v_cvt_pk_bf16_f32 v73, v106, v107
    v_cvt_pk_bf16_f32 v74, v108, v109
    v_cvt_pk_bf16_f32 v75, v110, v111
    v_cvt_pk_bf16_f32 v76, v112, v113
    v_cvt_pk_bf16_f32 v77, v114, v115
    v_cvt_pk_bf16_f32 v78, v116, v117
    v_cvt_pk_bf16_f32 v79, v118, v119
    v_mfma_f32_32x32x16_bf16 v[88:103], v[56:59], v[72:75], v[88:103]
    s_nop 0
    v_mfma_f32_32x32x16_bf16 v[88:103], v[60:63], v[76:79], v[88:103]
.Lskip_107:
    s_cmp_gt_u32 s26, 4
    s_cbranch_scc1 .Lskip_108
    ds_read_b128 v[40:43], v8 offset:2048
    ds_read_b64 v[44:45], v9 offset:1024
    ds_read_b64_tr_b16 v[56:57], v13 offset:2048
    ds_read_b64_tr_b16 v[58:59], v13 offset:2176
    ds_read_b64_tr_b16 v[60:61], v13 offset:2304
    ds_read_b64_tr_b16 v[62:63], v13 offset:2432
    s_waitcnt lgkmcnt(0)
    v_mfma_f32_32x32x16_bf16 v[104:119], v[40:43], v[24:27], 0
    v_mfma_f32_32x32x8_bf16 v[104:119], v[44:45], v[28:29], v[104:119]
    s_nop 11
    v_sub_f32 v104, v104, v16
    v_sub_f32 v105, v105, v16
    v_sub_f32 v106, v106, v16
    v_sub_f32 v107, v107, v16
    v_sub_f32 v108, v108, v16
    v_sub_f32 v109, v109, v16
    v_sub_f32 v110, v110, v16
    v_sub_f32 v111, v111, v16
    v_sub_f32 v112, v112, v16
    v_sub_f32 v113, v113, v16
    v_sub_f32 v114, v114, v16
    v_sub_f32 v115, v115, v16
    v_sub_f32 v116, v116, v16
    v_sub_f32 v117, v117, v16
    v_sub_f32 v118, v118, v16
    v_sub_f32 v119, v119, v16
    v_exp_f32 v104, v104
    v_exp_f32 v105, v105
    v_exp_f32 v106, v106
    v_exp_f32 v107, v107
    v_exp_f32 v108, v108
    v_exp_f32 v109, v109
    v_exp_f32 v110, v110
    v_exp_f32 v111, v111
    v_exp_f32 v112, v112
    v_exp_f32 v113, v113
    v_exp_f32 v114, v114
    v_exp_f32 v115, v115
    v_exp_f32 v116, v116
    v_exp_f32 v117, v117
    v_exp_f32 v118, v118
    v_exp_f32 v119, v119
    v_cvt_pk_bf16_f32 v72, v104, v105
    v_cvt_pk_bf16_f32 v73, v106, v107
    v_cvt_pk_bf16_f32 v74, v108, v109
    v_cvt_pk_bf16_f32 v75, v110, v111
    v_cvt_pk_bf16_f32 v76, v112, v113
    v_cvt_pk_bf16_f32 v77, v114, v115
    v_cvt_pk_bf16_f32 v78, v116, v117
    v_cvt_pk_bf16_f32 v79, v118, v119
    v_mfma_f32_32x32x16_bf16 v[88:103], v[56:59], v[72:75], v[88:103]
    s_nop 0
    v_mfma_f32_32x32x16_bf16 v[88:103], v[60:63], v[76:79], v[88:103]
.Lskip_108:
    s_cmp_gt_u32 s26, 5
    s_cbranch_scc1 .Lskip_109
    ds_read_b128 v[40:43], v8 offset:2560
    ds_read_b64 v[44:45], v9 offset:1280
    ds_read_b64_tr_b16 v[56:57], v13 offset:2560
    ds_read_b64_tr_b16 v[58:59], v13 offset:2688
    ds_read_b64_tr_b16 v[60:61], v13 offset:2816
    ds_read_b64_tr_b16 v[62:63], v13 offset:2944
    s_waitcnt lgkmcnt(0)
    v_mfma_f32_32x32x16_bf16 v[104:119], v[40:43], v[24:27], 0
    v_mfma_f32_32x32x8_bf16 v[104:119], v[44:45], v[28:29], v[104:119]
    s_nop 11
    v_sub_f32 v104, v104, v16
    v_sub_f32 v105, v105, v16
    v_sub_f32 v106, v106, v16
    v_sub_f32 v107, v107, v16
    v_sub_f32 v108, v108, v16
    v_sub_f32 v109, v109, v16
    v_sub_f32 v110, v110, v16
    v_sub_f32 v111, v111, v16
    v_sub_f32 v112, v112, v16
    v_sub_f32 v113, v113, v16
    v_sub_f32 v114, v114, v16
    v_sub_f32 v115, v115, v16
    v_sub_f32 v116, v116, v16
    v_sub_f32 v117, v117, v16
    v_sub_f32 v118, v118, v16
    v_sub_f32 v119, v119, v16
    v_exp_f32 v104, v104
    v_exp_f32 v105, v105
    v_exp_f32 v106, v106
    v_exp_f32 v107, v107
    v_exp_f32 v108, v108
    v_exp_f32 v109, v109
    v_exp_f32 v110, v110
    v_exp_f32 v111, v111
    v_exp_f32 v112, v112
    v_exp_f32 v113, v113
    v_exp_f32 v114, v114
    v_exp_f32 v115, v115
    v_exp_f32 v116, v116
    v_exp_f32 v117, v117
    v_exp_f32 v118, v118
    v_exp_f32 v119, v119
    v_cvt_pk_bf16_f32 v72, v104, v105
    v_cvt_pk_bf16_f32 v73, v106, v107
    v_cvt_pk_bf16_f32 v74, v108, v109
    v_cvt_pk_bf16_f32 v75, v110, v111
    v_cvt_pk_bf16_f32 v76, v112, v113
    v_cvt_pk_bf16_f32 v77, v114, v115
    v_cvt_pk_bf16_f32 v78, v116, v117
    v_cvt_pk_bf16_f32 v79, v118, v119
    v_mfma_f32_32x32x16_bf16 v[88:103], v[56:59], v[72:75], v[88:103]
    s_nop 0
    v_mfma_f32_32x32x16_bf16 v[88:103], v[60:63], v[76:79], v[88:103]
.Lskip_109:
    s_cmp_gt_u32 s26, 6
    s_cbranch_scc1 .Lskip_110
    ds_read_b128 v[40:43], v8 offset:3072
    ds_read_b64 v[44:45], v9 offset:1536
    ds_read_b64_tr_b16 v[56:57], v13 offset:3072
    ds_read_b64_tr_b16 v[58:59], v13 offset:3200
    ds_read_b64_tr_b16 v[60:61], v13 offset:3328
    ds_read_b64_tr_b16 v[62:63], v13 offset:3456
    s_waitcnt lgkmcnt(0)
    v_mfma_f32_32x32x16_bf16 v[104:119], v[40:43], v[24:27], 0
    v_mfma_f32_32x32x8_bf16 v[104:119], v[44:45], v[28:29], v[104:119]
    s_nop 11
    v_sub_f32 v104, v104, v16
    v_sub_f32 v105, v105, v16
    v_sub_f32 v106, v106, v16
    v_sub_f32 v107, v107, v16
    v_sub_f32 v108, v108, v16
    v_sub_f32 v109, v109, v16
    v_sub_f32 v110, v110, v16
    v_sub_f32 v111, v111, v16
    v_sub_f32 v112, v112, v16
    v_sub_f32 v113, v113, v16
    v_sub_f32 v114, v114, v16
    v_sub_f32 v115, v115, v16
    v_sub_f32 v116, v116, v16
    v_sub_f32 v117, v117, v16
    v_sub_f32 v118, v118, v16
    v_sub_f32 v119, v119, v16
    v_exp_f32 v104, v104
    v_exp_f32 v105, v105
    v_exp_f32 v106, v106
    v_exp_f32 v107, v107
    v_exp_f32 v108, v108
    v_exp_f32 v109, v109
    v_exp_f32 v110, v110
    v_exp_f32 v111, v111
    v_exp_f32 v112, v112
    v_exp_f32 v113, v113
    v_exp_f32 v114, v114
    v_exp_f32 v115, v115
    v_exp_f32 v116, v116
    v_exp_f32 v117, v117
    v_exp_f32 v118, v118
    v_exp_f32 v119, v119
    v_cvt_pk_bf16_f32 v72, v104, v105
    v_cvt_pk_bf16_f32 v73, v106, v107
    v_cvt_pk_bf16_f32 v74, v108, v109
    v_cvt_pk_bf16_f32 v75, v110, v111
    v_cvt_pk_bf16_f32 v76, v112, v113
    v_cvt_pk_bf16_f32 v77, v114, v115
    v_cvt_pk_bf16_f32 v78, v116, v117
    v_cvt_pk_bf16_f32 v79, v118, v119
    v_mfma_f32_32x32x16_bf16 v[88:103], v[56:59], v[72:75], v[88:103]
    s_nop 0
    v_mfma_f32_32x32x16_bf16 v[88:103], v[60:63], v[76:79], v[88:103]
.Lskip_110:
    s_cmp_gt_u32 s26, 7
    s_cbranch_scc1 .Lskip_111
    ds_read_b128 v[40:43], v8 offset:3584
    ds_read_b64 v[44:45], v9 offset:1792
    ds_read_b64_tr_b16 v[56:57], v13 offset:3584
    ds_read_b64_tr_b16 v[58:59], v13 offset:3712
    ds_read_b64_tr_b16 v[60:61], v13 offset:3840
    ds_read_b64_tr_b16 v[62:63], v13 offset:3968
    s_waitcnt lgkmcnt(0)
    v_mfma_f32_32x32x16_bf16 v[104:119], v[40:43], v[24:27], 0
    v_mfma_f32_32x32x8_bf16 v[104:119], v[44:45], v[28:29], v[104:119]
    s_nop 11
    v_sub_f32 v104, v104, v16
    v_sub_f32 v105, v105, v16
    v_sub_f32 v106, v106, v16
    v_sub_f32 v107, v107, v16
    v_sub_f32 v108, v108, v16
    v_sub_f32 v109, v109, v16
    v_sub_f32 v110, v110, v16
    v_sub_f32 v111, v111, v16
    v_sub_f32 v112, v112, v16
    v_sub_f32 v113, v113, v16
    v_sub_f32 v114, v114, v16
    v_sub_f32 v115, v115, v16
    v_sub_f32 v116, v116, v16
    v_sub_f32 v117, v117, v16
    v_sub_f32 v118, v118, v16
    v_sub_f32 v119, v119, v16
    v_exp_f32 v104, v104
    v_exp_f32 v105, v105
    v_exp_f32 v106, v106
    v_exp_f32 v107, v107
    v_exp_f32 v108, v108
    v_exp_f32 v109, v109
    v_exp_f32 v110, v110
    v_exp_f32 v111, v111
    v_exp_f32 v112, v112
    v_exp_f32 v113, v113
    v_exp_f32 v114, v114
    v_exp_f32 v115, v115
    v_exp_f32 v116, v116
    v_exp_f32 v117, v117
    v_exp_f32 v118, v118
    v_exp_f32 v119, v119
    v_cvt_pk_bf16_f32 v72, v104, v105
    v_cvt_pk_bf16_f32 v73, v106, v107
    v_cvt_pk_bf16_f32 v74, v108, v109
    v_cvt_pk_bf16_f32 v75, v110, v111
    v_cvt_pk_bf16_f32 v76, v112, v113
    v_cvt_pk_bf16_f32 v77, v114, v115
    v_cvt_pk_bf16_f32 v78, v116, v117
    v_cvt_pk_bf16_f32 v79, v118, v119
    v_mfma_f32_32x32x16_bf16 v[88:103], v[56:59], v[72:75], v[88:103]
    s_nop 0
    v_mfma_f32_32x32x16_bf16 v[88:103], v[60:63], v[76:79], v[88:103]
.Lskip_111:
    s_waitcnt vmcnt(0)
    s_nop 10
    v_rcp_f32 v7, v100
    s_nop 0
    v_mul_f32 v16, v7, v20
    v_mul_f32 v104, v16, v88
    v_mul_f32 v105, v16, v89
    v_mul_f32 v106, v16, v90
    v_mul_f32 v107, v16, v91
    v_mul_f32 v108, v16, v92
    v_mul_f32 v109, v16, v93
    v_mul_f32 v110, v16, v94
    v_mul_f32 v111, v16, v95
    v_cvt_pk_bf16_f32 v72, v104, v105
    v_cvt_pk_bf16_f32 v73, v106, v107
    v_cvt_pk_bf16_f32 v74, v108, v109
    v_cvt_pk_bf16_f32 v75, v110, v111
    buffer_store_dwordx4 v[72:75], v1, s[8:11], s30 offen sc1
    v_mul_f32 v112, v16, v96
    v_mul_f32 v113, v16, v97
    v_mul_f32 v114, v16, v98
    v_mul_f32 v115, v16, v99
    v_lshlrev_b32 v7, 3, v0
    v_cvt_pk_bf16_f32 v76, v112, v113
    v_cvt_pk_bf16_f32 v77, v114, v115
    s_mov_b32 exec_hi, 0
    buffer_store_dwordx2 v[76:77], v7, s[8:11], s30 offen offset:1024 sc1
    s_mov_b32 exec_hi, -1
    s_branch .Lback_53
.section .rodata,"a"
.p2align 6
.amdhsa_kernel gated_mix__sliding_block__sliding_local_dilated__prompt_kernel
  .amdhsa_next_free_vgpr 256
  .amdhsa_next_free_sgpr 102
  .amdhsa_accum_offset 256
  .amdhsa_group_segment_fixed_size 0
  .amdhsa_kernarg_size 80
  .amdhsa_user_sgpr_count 2
  .amdhsa_user_sgpr_kernarg_segment_ptr 1
  .amdhsa_system_sgpr_workgroup_id_x 1
.end_amdhsa_kernel
```
